```python
import torch

def _softmax(x, axis=-1):
    return torch.softmax(x, dim=axis)
def _gelu(x):
    return torch.nn.functional.gelu(x, approximate="tanh")
def _silu(x):
    return torch.nn.functional.silu(x)
def _sigmoid(x):
    return torch.sigmoid(x)
def _layernorm(x, axis=-1, eps=1e-5):
    m = x.mean(dim=axis, keepdim=True)
    v = x.var(dim=axis, keepdim=True, unbiased=False)
    return (x - m) / torch.sqrt(v + eps)
def _scatter_add(tgt, idx, src, axis=0):
    return tgt.clone().index_add_(axis, idx, src)
def _segment_sum(src, seg, n):
    out = torch.zeros((n,) + src.shape[1:], dtype=src.dtype)
    return out.index_add_(0, seg, src)
def _pad(x, pw):
    flat = tuple(v for pair in reversed(pw) for v in pair)
    return torch.nn.functional.pad(x, flat)

kernel_name = 'interleave_layers__sliding_block__mixer_s_mlp__prompt'

def setup_inputs():

    _w = (lambda a: (lambda t: t.to(torch.bfloat16) if t.is_floating_point() else t)(torch.as_tensor(a)))
    def _A_setup():
        B, S, D = 1, 2048, 512
        return {
            "x": _w((lambda *s: torch.randn(*s, dtype=torch.bfloat16) * 0.05)(B, S, D)),
            "wqkv": _w((lambda *s: torch.randn(*s, dtype=torch.bfloat16) * 0.1)(D, 3 * D)),
            "wo": _w((lambda *s: torch.randn(*s, dtype=torch.bfloat16) * 0.1)(D, D)),
        }
    _A_in = _A_setup()

    def _B_setup():
        B, S, D, F = 1, 2048, 512, 1792
        return {
            "x":  _w((lambda *s: torch.randn(*s, dtype=torch.bfloat16) * 0.05)(B, S, D)),
            "w1": _w((lambda *s: torch.randn(*s, dtype=torch.bfloat16) * 3.2)(D, D) * (D ** -0.5)),
            "w2": _w((lambda *s: torch.randn(*s, dtype=torch.bfloat16) * 3.2)(D, D) * (D ** -0.5)),
            "w3": _w((lambda *s: torch.randn(*s, dtype=torch.bfloat16) * 3.2)(D, F) * (D ** -0.5)),
            "w4": _w((lambda *s: torch.randn(*s, dtype=torch.bfloat16) * 3.2)(F, D) * (F ** -0.5)),
        }
    _B_in = _B_setup()

    return {
        "A_x": _A_in["x"],
        "A_wqkv": _A_in["wqkv"],
        "A_wo": _A_in["wo"],
        "B_x": _B_in["x"],
        "B_w1": _B_in["w1"],
        "B_w2": _B_in["w2"],
        "B_w3": _B_in["w3"],
        "B_w4": _B_in["w4"],
    }

def reference(A_x, A_wqkv, A_wo, B_x, B_w1, B_w2, B_w3, B_w4):
    def _A_ref(x, wqkv, wo):
        B, S, D = x.shape
        H = 32; Dh = D // H; W = 256
        qkv = (lambda x, *d: x.permute(*d))((x @ wqkv).reshape(B, S, 3, H, Dh), 2, 0, 3, 1, 4)
        q, k, v = qkv[0], qkv[1], qkv[2]
        scores = torch.einsum("bhqd,bhkd->bhqk", q, k) * (Dh ** -0.5)
        idx = torch.arange(S)
        mask = (idx[:, None] - idx[None, :] >= 0) & (idx[:, None] - idx[None, :] < W)
        scores = torch.where(mask[None, None], scores, -1e9)
        p = _softmax(scores, axis=-1)
        o = torch.einsum("bhqk,bhkd->bhqd", p, v)
        return (lambda x, *d: x.permute(*d))(o, 0, 2, 1, 3).reshape(B, S, D) @ wo

    def _B_ref(x, w1, w2, w3, w4):
        B, S, D = x.shape
        h = _gelu(_layernorm(x, axis=-1) @ w1)
        c = D // 4
        g0 = _pad(h[:, :, 0*c:1*c], ((0, 0), (1, 0), (0, 0)))[:, :S, :]
        g1 = _pad(h[:, :, 1*c:2*c], ((0, 0), (0, 1), (0, 0)))[:, 1:, :]
        g2 = _pad(h[:, :, 2*c:3*c], ((0, 0), (2, 0), (0, 0)))[:, :S, :]
        g3 = _pad(h[:, :, 3*c:   ], ((0, 0), (0, 2), (0, 0)))[:, 2:, :]
        hs = torch.concatenate([g0, g1, g2, g3], axis=-1) @ w2
        x1 = x + hs
        h2 = _gelu(_layernorm(x1, axis=-1) @ w3) @ w4
        return x1 + h2

    x = A_x
    x = x + _A_ref(_layernorm(x, axis=-1), A_wqkv, A_wo)
    x = x + _B_ref(_layernorm(x, axis=-1), B_w1, B_w2, B_w3, B_w4)
    x = x + _A_ref(_layernorm(x, axis=-1), A_wqkv, A_wo)
    x = x + _B_ref(_layernorm(x, axis=-1), B_w1, B_w2, B_w3, B_w4)
    return x
```

```asm
; @launch grid=(256,1,1) block=(256,1,1) lds=163840
.amdgcn_target "amdgcn-amd-amdhsa--gfx950"
.text
.globl interleave_layers__sliding_block__mixer_s_mlp__prompt_kernel
.p2align 8
.type interleave_layers__sliding_block__mixer_s_mlp__prompt_kernel,@function
interleave_layers__sliding_block__mixer_s_mlp__prompt_kernel:
    s_cmp_ge_u32 s2, 0x100
    s_cbranch_scc1 bail
    s_load_dwordx2 s[36:37], s[0:1], 0
    s_load_dwordx2 s[12:13], s[0:1], 8
    s_load_dwordx2 s[8:9], s[0:1], 80
    s_getpc_b64 s[60:61]
pc_1:
    s_lshr_b32 s76, s2, 3
    s_mul_i32 s76, s76, 1280
    v_lshl_add_u32 v19, v0, 7, s76
    v_min_u32 v19, text_end-pc_1-4, v19
    v_mov_b32 v21, s61
    v_add_co_u32 v20, vcc, s60, v19
    s_nop 1
    v_addc_co_u32 v21, vcc, 0, v21, vcc
    v_cmp_gt_u32 vcc, 10, v0
    s_or_b32 vcc_lo, vcc_lo, 1
    s_mov_b64 exec, vcc
    global_load_dword v255, v[20:21], off
    s_mov_b64 exec, -1
    v_lshrrev_b32 v1, 6, v0
    v_and_b32 v0, 63, v0
    v_readfirstlane_b32 s44, v1
    s_and_b32 s45, s2, 7
    s_lshr_b32 s3, s2, 3
    s_lshr_b32 s47, s2, 5
    s_xor_b32 s47, s47, 0
    s_and_b32 s61, s3, 3
    s_lshl2_add_u32 s61, s61, s44
    s_lshl4_add_u32 s49, s45, s61
    v_and_b32 v57, 15, v0
    v_lshrrev_b32 v58, 4, v0
    s_lshl_b32 s60, s49, 14
    s_lshl_b32 s61, s47, 7
    s_add_u32 s60, s60, s61
    v_lshlrev_b32 v56, 10, v57
    v_lshl_add_u32 v56, v58, 3, v56
    s_mov_b32 s38, 2097152
    s_mov_b32 s39, 0x20000
    s_waitcnt lgkmcnt(0)
    buffer_load_dwordx2 v[64:65], v56, s[36:39], s60 offen offset:0
    buffer_load_dwordx2 v[66:67], v56, s[36:39], s60 offen offset:32
    buffer_load_dwordx2 v[68:69], v56, s[36:39], s60 offen offset:64
    buffer_load_dwordx2 v[70:71], v56, s[36:39], s60 offen offset:96
    s_load_dwordx2 s[64:65], s[8:9], 524288
    s_load_dwordx2 s[40:41], s[0:1], 72
    s_load_dwordx2 s[16:17], s[0:1], 16
    s_load_dwordx2 s[20:21], s[0:1], 32
    s_load_dwordx2 s[24:25], s[0:1], 40
    s_load_dwordx2 s[28:29], s[0:1], 48
    s_load_dwordx2 s[32:33], s[0:1], 56
    s_load_dwordx2 s[62:63], s[0:1], 64
    s_mov_b32 s14, 1572864
    s_mov_b32 s15, 0x20000
    s_mov_b32 s6, 22151168
    s_mov_b32 s7, 0x20000
    s_add_u32 s4, s8, 589824
    s_addc_u32 s5, s9, 0
    s_mov_b32 s57, 173056
    s_mul_i32 s77, s49, s57
    buffer_load_dword v255, off, s[4:7], s77 sc1
    s_lshr_b32 s85, s2, 3
    s_lshl2_add_u32 s85, s85, s44
    s_mul_i32 s85, s85, 12288
    s_add_u32 s85, s85, 384
    v_lshlrev_b32 v59, 10, v0
    v_add_u32 v59, s85, v59
    s_mov_b64 exec, 4095
    buffer_load_dword v255, v59, s[12:15], 0 offen
    s_mov_b64 exec, -1
    s_lshr_b32 s46, s2, 4
    s_and_b32 s82, s3, 3
    s_lshl_b32 s82, s82, 1
    s_and_b32 s61, s2, 1
    s_or_b32 s82, s82, s61
    s_lshl_b32 s68, s44, 10
    s_lshl_b32 s84, s82, 12
    s_add_u32 s84, s84, s68
    s_lshl_b32 s83, s84, 1
    s_bitset1_b32 s84, 16
    v_lshrrev_b32 v59, 2, v0
    v_mul_u32_u24 v59, 3072, v59
    v_and_b32 v60, 3, v0
    v_lshl_add_u32 v59, v60, 4, v59
    s_mul_i32 s60, s44, 49152
    s_lshl_b32 s61, s46, 6
    s_add_u32 s60, s60, s61
    v_add_u32 v7, s60, v59
    s_and_b32 s81, s3, 1
    s_lshl_b32 s60, s45, 3
    s_lshl_b32 s61, s81, 2
    s_add_u32 s60, s60, s61
    s_add_u32 s48, s60, s44
    s_sub_u32 s80, s60, 1
    s_andn2_b32 s75, s48, 2
    s_min_u32 s75, s75, 8
    s_mov_b32 s53, 4096
    s_mov_b32 s54, 8192
    s_mov_b32 s55, 12288
    s_mov_b32 s56, 32768
    v_lshlrev_b32 v13, 4, v0
    s_waitcnt lgkmcnt(0)
    s_mov_b32 s10, 524544
    s_mov_b32 s11, 0x20000
    s_mov_b32 s42, 256
    s_mov_b32 s43, 0x20000
    s_mov_b32 s18, 524288
    s_mov_b32 s19, 0x20000
    s_mov_b32 s22, 524288
    s_mov_b32 s23, 0x20000
    s_mov_b32 s26, 524288
    s_mov_b32 s27, 0x20000
    s_mov_b32 s30, 1835008
    s_mov_b32 s31, 0x20000
    s_mov_b32 s34, 1835008
    s_mov_b32 s35, 0x20000
    s_mul_i32 s60, s49, s57
    v_add_u32 v1, s60, v13
    s_lshl_b32 s61, s47, 11
    v_add_u32 v2, s61, v1
    s_lshr_b32 s61, s47, 1
    s_lshl_b32 s61, s61, 8
    s_add_u32 s60, s60, s61
    s_and_b32 s61, s47, 1
    s_lshl_b32 s61, s61, 3
    s_add_u32 s60, s60, s61
    v_lshrrev_b32 v59, 5, v0
    v_lshlrev_b32 v60, 4, v57
    v_lshl_add_u32 v61, v59, 2, v60
    v_add_u32 v5, s60, v61
    s_mul_i32 s60, s48, 346112
    v_add_u32 v4, s60, v13
    v_and_b32 v61, 1, v58
    v_mul_u32_u24 v62, 173056, v61
    v_lshl_add_u32 v62, v59, 8, v62
    v_add3_u32 v3, v62, v60, s60
    s_lshr_b32 s61, s46, 3
    s_mul_i32 s61, s61, s57
    s_and_b32 s76, s46, 7
    s_lshl_b32 s76, s76, 12
    s_add_u32 s61, s61, s76
    s_add_u32 s61, s61, 107520
    s_add_u32 s73, s60, s61
    s_mul_i32 s60, s80, 346112
    s_add_u32 s81, s61, s68
    s_add_u32 s74, s60, s81
    v_lshrrev_b32 v62, 2, v57
    v_and_b32 v63, 3, v0
    v_lshl_add_u32 v72, v59, 2, v62
    v_lshl_add_u32 v73, v61, 2, v63
    v_lshlrev_b32 v73, 3, v73
    v_lshl_add_u32 v12, v72, 6, v73
    v_lshl_add_u32 v72, v61, 2, v62
    v_lshlrev_b32 v73, 10, v59
    v_lshl_add_u32 v73, v72, 7, v73
    v_lshl_add_u32 v73, v63, 3, v73
    v_lshrrev_b32 v72, 1, v72
    v_lshl_add_u32 v8, v72, 5, v73
    v_xor_b32 v9, 32, v8
    v_xor_b32 v10, 64, v8
    v_xor_b32 v11, 0x60, v8
    v_lshrrev_b32 v72, 3, v0
    v_and_b32 v73, 7, v0
    v_lshlrev_b32 v74, 1, v58
    v_xor_b32 v74, v74, v73
    v_lshlrev_b32 v74, 4, v74
    v_lshl_add_u32 v74, v72, 10, v74
    s_lshl_b32 s60, s44, 13
    s_lshl_b32 s61, s47, 7
    s_add_u32 s60, s60, s61
    v_add_u32 v6, s60, v74
    s_lshl_b32 s77, s45, 13
    s_and_b32 s60, s49, 15
    s_lshl_b32 s61, s60, 7
    s_add_u32 s61, s61, s77
    v_lshl_add_u32 v15, v73, 3, s61
    s_lshl_b32 s76, s47, 3
    s_add_u32 s69, s61, s76
    s_add_u32 s70, s69, 2048
    s_and_b32 s60, s60, 10
    s_lshl_b32 s60, s60, 6
    s_add_u32 s60, s60, s77
    s_add_u32 s60, s60, 4096
    v_lshl_add_u32 v16, v57, 3, s60
    v_lshl_add_u32 v16, v59, 8, v16
    s_and_b32 s60, s48, 7
    s_lshl_b32 s61, s60, 8
    s_add_u32 s61, s61, s77
    v_and_b32 v74, 1, v72
    v_lshlrev_b32 v74, 7, v74
    v_lshl_add_u32 v74, v73, 3, v74
    v_add_u32 v14, s61, v74
    s_lshl_b32 s61, s60, 7
    s_lshl_b32 s76, s46, 3
    s_add_u32 s61, s61, s76
    s_add_u32 s61, s61, s77
    s_add_u32 s71, s61, 4096
    s_lshl_b32 s76, s46, 7
    s_add_u32 s76, s76, 131072
    s_lshl_b32 s60, s48, 11
    s_add_u32 s72, s60, s76
    v_sub_u32 v74, s80, v73
    v_mov_b32 v75, s48
    v_cmp_gt_i32 vcc, 0, v74
    s_nop 1
    v_cndmask_b32 v74, v74, v75, vcc
    v_lshl_add_u32 v18, v74, 11, s76
    v_min_u32 v74, 2, v72
    s_sub_u32 s60, s49, 1
    v_add_u32 v74, s60, v74
    v_max_i32 v74, 0, v74
    v_min_i32 v74, 0x7f, v74
    v_add_u32 v76, 1, v74
    v_and_b32 v76, 14, v76
    v_cmp_eq_u32 vcc, 0, v76
    v_lshrrev_b32 v76, 3, v74
    v_lshl_add_u32 v76, v76, 3, v73
    v_lshlrev_b32 v76, 7, v76
    v_add_u32 v76, 65536, v76
    v_lshrrev_b32 v75, 4, v74
    v_and_b32 v74, 15, v74
    v_lshlrev_b32 v75, 13, v75
    v_lshl_add_u32 v75, v74, 7, v75
    v_lshl_add_u32 v75, v73, 3, v75
    v_add_u32 v75, 2048, v75
    v_cndmask_b32 v17, v75, v76, vcc
    s_and_b32 s60, s46, 1
    s_mul_i32 s61, s46, 7
    s_add_u32 s76, s61, s60
    s_lshl_b32 s76, s76, 9
    s_add_u32 s78, s76, 17408
    s_mul_i32 s60, s60, 4088
    s_add_u32 s79, s78, 3072
    s_sub_u32 s79, s79, s60
    s_mov_b32 s50, 0
    s_mov_b32 s98, 74752
    s_mul_i32 s99, s47, 7168
    s_add_u32 s99, s99, 17408
    s_mov_b32 s100, 112
    s_mov_b32 s51, 0
    s_mov_b32 s52, 0
    s_getreg_b32 s76, hwreg(HW_REG_XCC_ID, 0, 4)
    s_and_b32 s76, s76, 7
    s_lshl_b32 s76, s76, 3
    s_lshl_b64 s[66:67], 32, s76
    s_and_b32 s61, s49, -8
    s_add_u32 s61, s61, s47
    s_lshl_b32 s61, s61, 7
    s_add_u32 s61, s61, 65536
    s_add_u32 s60, s49, 1
    s_and_b32 s60, s60, 14
    s_cselect_b32 s89, 1, 0
    s_cselect_b32 s70, s70, s61
    s_mul_i32 s87, s44, 7168
    s_mul_i32 s88, s44, 114688
    s_mul_i32 s76, s46, 224
    s_add_u32 s88, s88, s76
    v_add_u32 v72, 0, v0
    v_mul_u32_u24 v72, 4682, v72
    v_lshrrev_b32 v72, 16, v72
    v_mul_u32_u24 v72, 3360, v72
    v_add_u32 v248, v72, v13
    v_add_u32 v72, 64, v0
    v_mul_u32_u24 v72, 4682, v72
    v_lshrrev_b32 v72, 16, v72
    v_mul_u32_u24 v72, 3360, v72
    v_add_u32 v249, v72, v13
    v_add_u32 v72, 128, v0
    v_mul_u32_u24 v72, 4682, v72
    v_lshrrev_b32 v72, 16, v72
    v_mul_u32_u24 v72, 3360, v72
    v_add_u32 v250, v72, v13
    v_add_u32 v72, 192, v0
    v_mul_u32_u24 v72, 4682, v72
    v_lshrrev_b32 v72, 16, v72
    v_mul_u32_u24 v72, 3360, v72
    v_add_u32 v251, v72, v13
    v_add_u32 v72, 256, v0
    v_mul_u32_u24 v72, 4682, v72
    v_lshrrev_b32 v72, 16, v72
    v_mul_u32_u24 v72, 3360, v72
    v_add_u32 v252, v72, v13
    v_add_u32 v72, 320, v0
    v_mul_u32_u24 v72, 4682, v72
    v_lshrrev_b32 v72, 16, v72
    v_mul_u32_u24 v72, 3360, v72
    v_add_u32 v253, v72, v13
    v_add_u32 v72, 384, v0
    v_mul_u32_u24 v72, 4682, v72
    v_lshrrev_b32 v72, 16, v72
    v_mul_u32_u24 v72, 3360, v72
    v_add_u32 v254, v72, v13
    s_xor_b32 s65, s65, 0x5bd1e995
    s_waitcnt vmcnt(2)
    v_lshlrev_b32 v24, 16, v64
    v_and_b32 v25, 0xffff0000, v64
    v_lshlrev_b32 v26, 16, v65
    v_and_b32 v27, 0xffff0000, v65
    v_lshlrev_b32 v28, 16, v66
    v_and_b32 v29, 0xffff0000, v66
    v_lshlrev_b32 v30, 16, v67
    v_and_b32 v31, 0xffff0000, v67
    v_lshlrev_b32 v32, 16, v68
    v_and_b32 v33, 0xffff0000, v68
    v_lshlrev_b32 v34, 16, v69
    v_and_b32 v35, 0xffff0000, v69
    v_lshlrev_b32_e64 v36, 16, v70
    v_and_b32 v37, 0xffff0000, v70
    v_lshlrev_b32 v38, 16, v71
    v_and_b32 v39, 0xffff0000, v71
    s_mov_b32 s36, s62
    s_mov_b32 s37, s63
layer:
    s_mov_b32 s60, 0
    s_mov_b32 s61, 16384
    v_cvt_pk_bf16_f32 v56, v24, v25
    v_cvt_pk_bf16_f32 v57, v26, v27
    v_cvt_pk_bf16_f32 v58, v28, v29
    v_cvt_pk_bf16_f32 v59, v30, v31
    v_cvt_pk_bf16_f32 v60, v32, v33
    v_cvt_pk_bf16_f32 v61, v34, v35
    v_cvt_pk_bf16_f32 v62, v36, v37
    v_cvt_pk_bf16_f32 v63, v38, v39
    s_cmp_eq_u32 s51, 0
    s_cbranch_scc1 sc_2
    buffer_store_dwordx4 v[56:59], v2, s[4:7], s60 offen offset:0
    buffer_store_dwordx4 v[60:63], v2, s[4:7], s60 offen offset:1024
scb_3:
    v_pk_add_f32 v[64:65], v[24:25], v[26:27]
    v_pk_mul_f32 v[66:67], v[24:25], v[24:25]
    v_pk_fma_f32 v[66:67], v[26:27], v[26:27], v[66:67]
    v_pk_add_f32 v[64:65], v[64:65], v[28:29]
    v_pk_fma_f32 v[66:67], v[28:29], v[28:29], v[66:67]
    v_pk_add_f32 v[64:65], v[64:65], v[30:31]
    v_pk_fma_f32 v[66:67], v[30:31], v[30:31], v[66:67]
    v_pk_add_f32 v[64:65], v[64:65], v[32:33]
    v_pk_fma_f32 v[66:67], v[32:33], v[32:33], v[66:67]
    v_pk_add_f32 v[64:65], v[64:65], v[34:35]
    v_pk_fma_f32 v[66:67], v[34:35], v[34:35], v[66:67]
    v_pk_add_f32 v[64:65], v[64:65], v[36:37]
    v_pk_fma_f32 v[66:67], v[36:37], v[36:37], v[66:67]
    v_pk_add_f32 v[64:65], v[64:65], v[38:39]
    v_pk_fma_f32 v[66:67], v[38:39], v[38:39], v[66:67]
    v_add_f32 v64, v64, v65
    v_add_f32 v65, v66, v67
    s_nop 1
    v_permlane32_swap_b32 v64, v65
    v_add_f32 v64, v64, v65
    v_mov_b32 v65, v64
    s_nop 1
    v_permlane16_swap_b32 v64, v65
    v_add_f32 v64, v64, v65
    s_cmp_eq_u32 s51, 0
    s_cbranch_scc1 sc_4
    buffer_store_dword v64, v5, s[4:7], s61 offen
scb_5:
    s_xor_b32 m0, s83, 24576
    s_xor_b32 s58, s82, 3
    s_mul_i32 s58, s58, 196608
    s_bitset1_b32 s58, 10
    buffer_load_dwordx4 v7, s[12:15], s58 offen lds
    buffer_load_dwordx4 v7, s[12:15], s58 offen offset:1024 lds
    s_add_u32 s64, s64, 1
    v_mov_b32 v21, s65
    v_mov_b32 v20, s64
    s_mov_b64 exec, 1
    s_waitcnt vmcnt(2)
    s_cmp_eq_u32 s51, 0
    s_cbranch_scc1 sc_6
    buffer_store_dwordx2 v[20:21], off, s[8:11], s69
scb_7:
    s_mov_b64 exec, -1
    s_cmp_lg_u32 s50, 0
    s_cbranch_scc1 l0_8
    s_barrier
    s_cmp_lg_u32 s44, 0
    s_cbranch_scc1 cnt_9
    s_lshr_b64 s[60:61], s[66:67], 5
    v_mov_b32 v56, s60
    v_mov_b32 v57, s61
    s_lshl_b32 s76, s45, 5
    s_mov_b64 exec, 1
    buffer_atomic_add_x2 v[56:57], off, s[40:43], s76 sc1
    s_mov_b64 exec, -1
cnt_9:
    s_xor_b32 m0, s83, 0
    s_xor_b32 s58, s82, 0
    s_mul_i32 s58, s58, 196608
    s_bitset1_b32 s58, 10
    buffer_load_dwordx4 v7, s[12:15], s58 offen lds
    buffer_load_dwordx4 v7, s[12:15], s58 offen offset:1024 lds
    s_xor_b32 m0, s83, 8192
    s_xor_b32 s58, s82, 1
    s_mul_i32 s58, s58, 196608
    s_bitset1_b32 s58, 10
    buffer_load_dwordx4 v7, s[12:15], s58 offen lds
    buffer_load_dwordx4 v7, s[12:15], s58 offen offset:1024 lds
    s_xor_b32 m0, s83, 16384
    s_xor_b32 s58, s82, 2
    s_mul_i32 s58, s58, 196608
    s_bitset1_b32 s58, 10
    buffer_load_dwordx4 v7, s[12:15], s58 offen lds
    buffer_load_dwordx4 v7, s[12:15], s58 offen offset:1024 lds
l0_8:
    s_lshl2_add_u32 s85, s2, s44
    v_lshlrev_b32 v19, 6, v0
    s_mul_i32 s86, s85, 1792
    s_lshl_b32 s85, s85, 9
    s_mov_b32 exec_hi, 0
    s_cmp_eq_u32 s50, 0
    s_cselect_b32 exec_lo, 255, 1
    buffer_load_dword v255, v19, s[16:19], s85 offen
    buffer_load_dword v255, v19, s[20:23], s85 offen
    buffer_load_dword v255, v19, s[24:27], s85 offen
    s_cselect_b32 exec_lo, 268435455, 1
    buffer_load_dword v255, v19, s[28:31], s86 offen
    buffer_load_dword v255, v19, s[32:35], s86 offen
    s_mov_b64 exec, -1
    s_xor_b32 m0, s83, 32768
    s_xor_b32 s58, s82, 4
    s_mul_i32 s58, s58, 196608
    s_bitset1_b32 s58, 10
    buffer_load_dwordx4 v7, s[12:15], s58 offen lds
    buffer_load_dwordx4 v7, s[12:15], s58 offen offset:1024 lds
    s_xor_b32 m0, s83, 40960
    s_xor_b32 s58, s82, 5
    s_mul_i32 s58, s58, 196608
    s_bitset1_b32 s58, 10
    buffer_load_dwordx4 v7, s[12:15], s58 offen lds
    buffer_load_dwordx4 v7, s[12:15], s58 offen offset:1024 lds
    s_xor_b32 m0, s83, 49152
    s_xor_b32 s58, s82, 6
    s_mul_i32 s58, s58, 196608
    s_bitset1_b32 s58, 10
    buffer_load_dwordx4 v7, s[12:15], s58 offen lds
    buffer_load_dwordx4 v7, s[12:15], s58 offen offset:1024 lds
    s_xor_b32 m0, s83, 57344
    s_xor_b32 s58, s82, 7
    s_mul_i32 s58, s58, 196608
    s_bitset1_b32 s58, 10
    buffer_load_dwordx4 v7, s[12:15], s58 offen lds
    buffer_load_dwordx4 v7, s[12:15], s58 offen offset:1024 lds
    v_add_u32 v240, 0x10000, v12
    v_lshrrev_b32 v19, 2, v0
    v_xor_b32 v19, v19, v0
    v_and_b32 v19, 4, v19
    v_cmp_eq_u32 vcc, 0, v19
    v_mov_b32 v19, 0x3f803f80
    s_nop 0
    v_cndmask_b32 v196, 0, v19, vcc
    v_mov_b32 v197, v196
    v_mov_b32 v198, v196
    v_mov_b32 v199, v196
    v_lshrrev_b32 v20, 5, v0
    v_lshlrev_b32 v241, 4, v20
    v_add_u32 v241, 161792, v241
    v_lshlrev_b32 v20, 6, v20
    v_xor_b32 v242, v20, v13
    v_xor_b32 v243, 0x80, v242
    s_lshl_b32 s60, s44, 12
    s_add_u32 s60, s60, 145408
    v_add_u32 v244, s60, v13
    v_add_u32 v245, s60, v242
    v_add_u32 v246, s60, v243
    s_mov_b32 s61, 16384
    s_and_b32 s76, s44, 2
    s_and_b32 s77, s44, 1
    s_lshl_b32 s77, s77, 12
    s_add_u32 s77, s77, 112640
    v_bfe_u32 v236, v0, 4, 1
    v_bfe_u32 v192, v0, 1, 1
    v_lshl_add_u32 v19, v236, 1, v192
    v_xor_b32 v19, s76, v19
    v_cmp_eq_u32 vcc, 0, v236
    v_lshrrev_b32 v192, 5, v0
    v_xor_b32 v192, v192, v19
    v_lshlrev_b32 v19, 9, v19
    v_lshl_add_u32 v19, v192, 6, v19
    v_bfe_u32 v192, v0, 2, 2
    v_lshl_add_u32 v19, v192, 4, v19
    v_and_b32 v192, 1, v0
    v_lshl_add_u32 v19, v192, 3, v19
    v_and_b32 v192, 0xff, v19
    v_add_u32 v192, 112128, v192
    v_add_u32 v19, s77, v19
    v_add_u32 v19, 43008, v19
    v_cndmask_b32 v193, v192, v19, vcc
    v_xor_b32 v236, 1, v236
    v_lshlrev_b32 v236, 12, v236
    v_mov_b32 v238, 0x3f803f80
    v_mov_b32 v239, 0x3f803f80
    v_lshlrev_b32 v237, 3, v0
    v_add_u32 v237, 112128, v237
    v_xor_b32 v194, 0x80, v193
    v_lshlrev_b32 v19, v0, -2
    v_lshrrev_b32_e64 v192, 3, v0
    v_and_b32_e64 v192, 4, v192
    v_lshrrev_b32_e64 v19, v192, v19
    s_lshl_b32 s76, s76, 9
    s_add_u32 s77, s77, s76
    v_add_u32_e64 v192, s77, v13
    s_add_u32 s77, s68, 112640
    v_add_u32_e64 v247, s77, v13
    v_lshl_add_u32 v195, s76, 1, v247
    v_bfe_i32 v40, v19, 0, 1
    v_and_b32 v40, 4051697664, v40
    v_bfe_i32 v41, v19, 1, 1
    v_and_b32 v41, 4051697664, v41
    v_bfe_i32 v42, v19, 2, 1
    v_and_b32 v42, 4051697664, v42
    v_bfe_i32 v43, v19, 3, 1
    v_and_b32 v43, 4051697664, v43
    v_bfe_i32 v44, v19, 8, 1
    v_and_b32 v44, 4051697664, v44
    v_bfe_i32 v45, v19, 9, 1
    v_and_b32 v45, 4051697664, v45
    v_bfe_i32 v46, v19, 10, 1
    v_and_b32 v46, 4051697664, v46
    v_bfe_i32 v47, v19, 11, 1
    v_and_b32 v47, 4051697664, v47
    v_bfe_i32 v48, v19, 16, 1
    v_and_b32 v48, 4051697664, v48
    v_bfe_i32 v49, v19, 17, 1
    v_and_b32 v49, 4051697664, v49
    v_bfe_i32 v50, v19, 18, 1
    v_and_b32 v50, 4051697664, v50
    v_bfe_i32 v51, v19, 19, 1
    v_and_b32 v51, 4051697664, v51
    v_bfe_i32 v52, v19, 24, 1
    v_and_b32 v52, 4051697664, v52
    v_bfe_i32 v53, v19, 25, 1
    v_and_b32 v53, 4051697664, v53
    v_bfe_i32 v54, v19, 26, 1
    v_and_b32 v54, 4051697664, v54
    v_bfe_i32 v55, v19, 27, 1
    v_and_b32 v55, 4051697664, v55
    s_mov_b32 s59, 0x8000
poll_10:
    buffer_load_dwordx2 v[20:21], v14, s[8:11], 0 offen sc1
    s_sub_u32 s59, s59, 1
    s_cbranch_scc1 bail
    s_waitcnt vmcnt(0)
    v_cmp_ne_u64 vcc, s[64:65], v[20:21]
    s_cbranch_vccnz poll_10
    buffer_load_dwordx4 v[160:163], v3, s[4:7], s61 offen offset:0 sc1
    buffer_load_dwordx4 v[164:167], v3, s[4:7], s61 offen offset:512 sc1
    buffer_load_dwordx4 a[0:3], v3, s[4:7], 0 offen offset:0 sc1
    buffer_load_dwordx4 a[4:7], v3, s[4:7], 0 offen offset:512 sc1
    buffer_load_dwordx4 a[8:11], v3, s[4:7], 0 offen offset:1024 sc1
    s_nop 0
    buffer_load_dwordx4 a[12:15], v3, s[4:7], 0 offen offset:1536 sc1
    buffer_load_dwordx4 a[16:19], v3, s[4:7], 0 offen offset:2048 sc1
    buffer_load_dwordx4 a[20:23], v3, s[4:7], 0 offen offset:2560 sc1
    buffer_load_dwordx4 a[24:27], v3, s[4:7], 0 offen offset:3072 sc1
    buffer_load_dwordx4 a[28:31], v3, s[4:7], 0 offen offset:3584 sc1
    buffer_load_dwordx4 a[32:35], v3, s[4:7], s53 offen offset:0 sc1
    buffer_load_dwordx4 a[36:39], v3, s[4:7], s53 offen offset:512 sc1
    buffer_load_dwordx4 a[40:43], v3, s[4:7], s53 offen offset:1024 sc1
    buffer_load_dwordx4 a[44:47], v3, s[4:7], s53 offen offset:1536 sc1
    s_cmp_lg_u32 s50, 0
    s_cbranch_scc1 l0_11
    v_lshl_add_u32 v20, s44, 11, v12
    ds_read_b64_tr_b16 v[104:105], v20 offset:0
    ds_read_b64_tr_b16 v[106:107], v20 offset:512
    ds_read_b64_tr_b16 v[108:109], v20 offset:1024
    ds_read_b64_tr_b16 v[110:111], v20 offset:1536
    ds_read_b64_tr_b16 v[112:113], v20 offset:8192
    ds_read_b64_tr_b16 v[114:115], v20 offset:8704
    ds_read_b64_tr_b16 v[116:117], v20 offset:9216
    ds_read_b64_tr_b16 v[118:119], v20 offset:9728
    ds_read_b64_tr_b16 v[120:121], v20 offset:16384
    ds_read_b64_tr_b16 v[122:123], v20 offset:16896
    ds_read_b64_tr_b16 v[124:125], v20 offset:17408
    ds_read_b64_tr_b16 v[126:127], v20 offset:17920
    s_waitcnt lgkmcnt(10)
    v_mfma_f32_16x16x32_bf16 v[56:59], v[196:199], v[104:107], 0
    ds_read_b64_tr_b16 v[104:105], v20 offset:24576
    ds_read_b64_tr_b16 v[106:107], v20 offset:25088
    s_waitcnt lgkmcnt(10)
    v_mfma_f32_16x16x32_bf16 v[60:63], v[196:199], v[108:111], 0
    ds_read_b64_tr_b16 v[108:109], v20 offset:25600
    ds_read_b64_tr_b16 v[110:111], v20 offset:26112
    s_waitcnt lgkmcnt(10)
    v_mfma_f32_16x16x32_bf16 v[56:59], v[196:199], v[112:115], v[56:59]
    ds_read_b64_tr_b16 v[112:113], v20 offset:32768
    ds_read_b64_tr_b16 v[114:115], v20 offset:33280
    s_waitcnt lgkmcnt(10)
    v_mfma_f32_16x16x32_bf16 v[60:63], v[196:199], v[116:119], v[60:63]
    ds_read_b64_tr_b16 v[116:117], v20 offset:33792
    ds_read_b64_tr_b16 v[118:119], v20 offset:34304
    s_waitcnt lgkmcnt(10)
    v_mfma_f32_16x16x32_bf16 v[56:59], v[196:199], v[120:123], v[56:59]
    ds_read_b64_tr_b16 v[120:121], v20 offset:40960
    ds_read_b64_tr_b16 v[122:123], v20 offset:41472
    s_waitcnt lgkmcnt(10)
    v_mfma_f32_16x16x32_bf16 v[60:63], v[196:199], v[124:127], v[60:63]
    ds_read_b64_tr_b16 v[124:125], v20 offset:41984
    ds_read_b64_tr_b16 v[126:127], v20 offset:42496
    s_waitcnt lgkmcnt(10)
    v_mfma_f32_16x16x32_bf16 v[56:59], v[196:199], v[104:107], v[56:59]
    ds_read_b64_tr_b16 v[104:105], v20 offset:49152
    ds_read_b64_tr_b16 v[106:107], v20 offset:49664
    s_waitcnt lgkmcnt(10)
    v_mfma_f32_16x16x32_bf16 v[60:63], v[196:199], v[108:111], v[60:63]
    ds_read_b64_tr_b16 v[108:109], v20 offset:50176
    ds_read_b64_tr_b16 v[110:111], v20 offset:50688
    s_waitcnt lgkmcnt(10)
    v_mfma_f32_16x16x32_bf16 v[56:59], v[196:199], v[112:115], v[56:59]
    ds_read_b64_tr_b16 v[112:113], v20 offset:57344
    ds_read_b64_tr_b16 v[114:115], v20 offset:57856
    s_waitcnt lgkmcnt(10)
    v_mfma_f32_16x16x32_bf16 v[60:63], v[196:199], v[116:119], v[60:63]
    ds_read_b64_tr_b16 v[116:117], v20 offset:58368
    ds_read_b64_tr_b16 v[118:119], v20 offset:58880
    s_waitcnt lgkmcnt(10)
    v_mfma_f32_16x16x32_bf16 v[56:59], v[196:199], v[120:123], v[56:59]
    s_waitcnt lgkmcnt(8)
    v_mfma_f32_16x16x32_bf16 v[60:63], v[196:199], v[124:127], v[60:63]
    s_waitcnt lgkmcnt(6)
    v_mfma_f32_16x16x32_bf16 v[56:59], v[196:199], v[104:107], v[56:59]
    s_waitcnt lgkmcnt(4)
    v_mfma_f32_16x16x32_bf16 v[60:63], v[196:199], v[108:111], v[60:63]
    s_waitcnt lgkmcnt(2)
    v_mfma_f32_16x16x32_bf16 v[56:59], v[196:199], v[112:115], v[56:59]
    s_waitcnt lgkmcnt(0)
    v_mfma_f32_16x16x32_bf16 v[60:63], v[196:199], v[116:119], v[60:63]
    s_mul_i32 s60, s44, 384
    s_add_u32 s60, s60, 110592
    v_and_b32_e64 v20, 31, v0
    v_lshl_add_u32 v20, v20, 2, s60
    s_nop 1
    ds_write_b32 v20, v56 offset:128
    s_nop 0
    ds_write_b32 v20, v60 offset:256
    s_waitcnt lgkmcnt(0)
l0_11:
    s_barrier
    s_cmp_lg_u32 s50, 0
    s_cbranch_scc1 l0_12
    v_min_u32 v19, 15, v0
    v_lshlrev_b32 v19, 4, v19
    v_add_u32 v19, 110720, v19
    ds_read_b128 v[128:131], v19 offset:0
    ds_read_b128 v[132:135], v19 offset:384
    ds_read_b128 v[136:139], v19 offset:768
    ds_read_b128 v[140:143], v19 offset:1152
    s_waitcnt lgkmcnt(0)
    v_pk_add_f32 v[128:129], v[128:129], v[132:133]
    v_pk_add_f32 v[130:131], v[130:131], v[134:135]
    v_pk_add_f32 v[128:129], v[128:129], v[136:137]
    v_pk_add_f32 v[130:131], v[130:131], v[138:139]
    v_pk_add_f32 v[128:129], v[128:129], v[140:141]
    v_pk_add_f32 v[130:131], v[130:131], v[142:143]
    ds_write_b128 v19, v[128:131] offset:51200
    s_waitcnt lgkmcnt(0)
l0_12:
    ds_read_b64_tr_b16 v[104:105], v12 offset:0
    ds_read_b64_tr_b16 v[106:107], v12 offset:2048
    ds_read_b64_tr_b16 v[108:109], v12 offset:1024
    ds_read_b64_tr_b16 v[110:111], v12 offset:3072
    ds_read_b64_tr_b16 v[112:113], v12 offset:512
    ds_read_b64_tr_b16 v[114:115], v12 offset:2560
    ds_read_b64_tr_b16 v[116:117], v12 offset:1536
    ds_read_b64_tr_b16 v[118:119], v12 offset:3584
    ds_read_b128 v[128:131], v241 offset:128
    ds_read_b128 v[132:135], v241 offset:160
    ds_read_b128 v[136:139], v241 offset:192
    ds_read_b128 v[140:143], v241 offset:224
    ds_read_b128 v[144:147], v241 offset:256
    ds_read_b128 v[148:151], v241 offset:288
    ds_read_b128 v[152:155], v241 offset:320
    ds_read_b128 v[156:159], v241 offset:352
    s_waitcnt vmcnt(11) lgkmcnt(12)
    v_mfma_f32_32x32x16_bf16 v[56:71], v[104:107], a[0:3], 0
    buffer_load_dwordx4 a[48:51], v3, s[4:7], s53 offen offset:2048 sc1
    ds_read_b64_tr_b16 v[120:121], v12 offset:4096
    ds_read_b64_tr_b16 v[122:123], v12 offset:6144
    v_mfma_f32_32x32x16_bf16 v[72:87], v[108:111], a[0:3], 0
    ds_read_b64_tr_b16 v[124:125], v12 offset:5120
    ds_read_b64_tr_b16 v[126:127], v12 offset:7168
    s_waitcnt vmcnt(11) lgkmcnt(12)
    v_mfma_f32_32x32x16_bf16 v[56:71], v[112:115], a[4:7], v[56:71]
    buffer_load_dwordx4 a[52:55], v3, s[4:7], s53 offen offset:2560 sc1
    ds_read_b64_tr_b16 v[104:105], v12 offset:4608
    ds_read_b64_tr_b16 v[106:107], v12 offset:6656
    v_mfma_f32_32x32x16_bf16 v[72:87], v[116:119], a[4:7], v[72:87]
    ds_read_b64_tr_b16 v[108:109], v12 offset:5632
    ds_read_b64_tr_b16 v[110:111], v12 offset:7680
    s_waitcnt vmcnt(11) lgkmcnt(4)
    v_mfma_f32_32x32x16_bf16 v[56:71], v[120:123], a[8:11], v[56:71]
    buffer_load_dwordx4 a[56:59], v3, s[4:7], s53 offen offset:3072 sc1
    ds_read_b64_tr_b16 v[112:113], v12 offset:8192
    ds_read_b64_tr_b16 v[114:115], v12 offset:10240
    v_add_f32 v160, v160, v162
    v_mfma_f32_32x32x16_bf16 v[72:87], v[124:127], a[8:11], v[72:87]
    ds_read_b64_tr_b16 v[116:117], v12 offset:9216
    ds_read_b64_tr_b16 v[118:119], v12 offset:11264
    v_add_f32 v164, v164, v166
    s_waitcnt vmcnt(11) lgkmcnt(4)
    v_mfma_f32_32x32x16_bf16 v[56:71], v[104:107], a[12:15], v[56:71]
    buffer_load_dwordx4 a[60:63], v3, s[4:7], s53 offen offset:3584 sc1
    ds_read_b64_tr_b16 v[120:121], v12 offset:8704
    ds_read_b64_tr_b16 v[122:123], v12 offset:10752
    v_add_f32 v161, v161, v163
    v_mfma_f32_32x32x16_bf16 v[72:87], v[108:111], a[12:15], v[72:87]
    ds_read_b64_tr_b16 v[124:125], v12 offset:9728
    ds_read_b64_tr_b16 v[126:127], v12 offset:11776
    v_add_f32 v165, v165, v167
    s_waitcnt vmcnt(11) lgkmcnt(4)
    v_mfma_f32_32x32x16_bf16 v[56:71], v[112:115], a[16:19], v[56:71]
    buffer_load_dwordx4 a[64:67], v3, s[4:7], s54 offen offset:0 sc1
    ds_read_b64_tr_b16 v[104:105], v12 offset:12288
    ds_read_b64_tr_b16 v[106:107], v12 offset:14336
    v_add_f32 v160, v160, v164
    v_mfma_f32_32x32x16_bf16 v[72:87], v[116:119], a[16:19], v[72:87]
    ds_read_b64_tr_b16 v[108:109], v12 offset:13312
    ds_read_b64_tr_b16 v[110:111], v12 offset:15360
    v_add_f32 v161, v161, v165
    s_waitcnt vmcnt(11) lgkmcnt(4)
    v_mfma_f32_32x32x16_bf16 v[56:71], v[120:123], a[20:23], v[56:71]
    buffer_load_dwordx4 a[68:71], v3, s[4:7], s54 offen offset:512 sc1
    ds_read_b64_tr_b16 v[112:113], v12 offset:12800
    ds_read_b64_tr_b16 v[114:115], v12 offset:14848
    v_permlane32_swap_b32 v160, v161
    v_mfma_f32_32x32x16_bf16 v[72:87], v[124:127], a[20:23], v[72:87]
    ds_read_b64_tr_b16 v[116:117], v12 offset:13824
    ds_read_b64_tr_b16 v[118:119], v12 offset:15872
    v_add_f32 v160, v160, v161
    s_waitcnt vmcnt(11) lgkmcnt(4)
    v_mfma_f32_32x32x16_bf16 v[56:71], v[104:107], a[24:27], v[56:71]
    buffer_load_dwordx4 a[72:75], v3, s[4:7], s54 offen offset:1024 sc1
    ds_read_b64_tr_b16 v[120:121], v12 offset:16384
    ds_read_b64_tr_b16 v[122:123], v12 offset:18432
    v_mov_b32 v161, v160
    v_mfma_f32_32x32x16_bf16 v[72:87], v[108:111], a[24:27], v[72:87]
    ds_read_b64_tr_b16 v[124:125], v12 offset:17408
    ds_read_b64_tr_b16 v[126:127], v12 offset:19456
    v_permlane32_swap_b32 v160, v161
    s_waitcnt vmcnt(11) lgkmcnt(4)
    v_mfma_f32_32x32x16_bf16 v[56:71], v[112:115], a[28:31], v[56:71]
    buffer_load_dwordx4 a[76:79], v3, s[4:7], s54 offen offset:1536 sc1
    ds_read_b64_tr_b16 v[104:105], v12 offset:16896
    ds_read_b64_tr_b16 v[106:107], v12 offset:18944
    v_mul_f32 v169, 0xbb000000, v160
    v_mfma_f32_32x32x16_bf16 v[72:87], v[116:119], a[28:31], v[72:87]
    ds_read_b64_tr_b16 v[108:109], v12 offset:17920
    ds_read_b64_tr_b16 v[110:111], v12 offset:19968
    v_mul_f32 v161, 0x3b000000, v161
    s_waitcnt vmcnt(11) lgkmcnt(4)
    v_mfma_f32_32x32x16_bf16 v[56:71], v[120:123], a[32:35], v[56:71]
    buffer_load_dwordx4 a[80:83], v3, s[4:7], s54 offen offset:2048 sc1
    ds_read_b64_tr_b16 v[112:113], v12 offset:20480
    ds_read_b64_tr_b16 v[114:115], v12 offset:22528
    v_fma_f32 v161, -v169, v169, v161
    v_mfma_f32_32x32x16_bf16 v[72:87], v[124:127], a[32:35], v[72:87]
    ds_read_b64_tr_b16 v[116:117], v12 offset:21504
    ds_read_b64_tr_b16 v[118:119], v12 offset:23552
    v_max_f32 v170, 0, v161
    s_waitcnt vmcnt(11) lgkmcnt(4)
    v_mfma_f32_32x32x16_bf16 v[56:71], v[104:107], a[36:39], v[56:71]
    buffer_load_dwordx4 a[84:87], v3, s[4:7], s54 offen offset:2560 sc1
    ds_read_b64_tr_b16 v[120:121], v12 offset:20992
    ds_read_b64_tr_b16 v[122:123], v12 offset:23040
    v_add_f32 v161, 0x3727c5ac, v170
    v_mfma_f32_32x32x16_bf16 v[72:87], v[108:111], a[36:39], v[72:87]
    ds_read_b64_tr_b16 v[124:125], v12 offset:22016
    ds_read_b64_tr_b16 v[126:127], v12 offset:24064
    v_rsq_f32 v168, v161
    s_waitcnt vmcnt(11) lgkmcnt(4)
    v_mfma_f32_32x32x16_bf16 v[56:71], v[112:115], a[40:43], v[56:71]
    buffer_load_dwordx4 a[88:91], v3, s[4:7], s54 offen offset:3072 sc1
    ds_read_b64_tr_b16 v[104:105], v12 offset:24576
    ds_read_b64_tr_b16 v[106:107], v12 offset:26624
    v_mul_f32 v169, v168, v169
    v_mfma_f32_32x32x16_bf16 v[72:87], v[116:119], a[40:43], v[72:87]
    ds_read_b64_tr_b16 v[108:109], v12 offset:25600
    ds_read_b64_tr_b16 v[110:111], v12 offset:27648
    v_mul_f32 v128, v169, v128
    s_waitcnt vmcnt(11) lgkmcnt(4)
    v_mfma_f32_32x32x16_bf16 v[56:71], v[120:123], a[44:47], v[56:71]
    buffer_load_dwordx4 a[92:95], v3, s[4:7], s54 offen offset:3584 sc1
    ds_read_b64_tr_b16 v[112:113], v12 offset:25088
    ds_read_b64_tr_b16 v[114:115], v12 offset:27136
    v_mul_f32 v129, v169, v129
    v_mfma_f32_32x32x16_bf16 v[72:87], v[124:127], a[44:47], v[72:87]
    ds_read_b64_tr_b16 v[116:117], v12 offset:26112
    ds_read_b64_tr_b16 v[118:119], v12 offset:28160
    v_mul_f32 v130, v169, v130
    s_waitcnt vmcnt(11) lgkmcnt(4)
    v_mfma_f32_32x32x16_bf16 v[56:71], v[104:107], a[48:51], v[56:71]
    buffer_load_dwordx4 a[96:99], v3, s[4:7], s55 offen offset:0 sc1
    ds_read_b64_tr_b16 v[120:121], v12 offset:28672
    ds_read_b64_tr_b16 v[122:123], v12 offset:30720
    v_mul_f32 v131, v169, v131
    v_mfma_f32_32x32x16_bf16 v[72:87], v[108:111], a[48:51], v[72:87]
    ds_read_b64_tr_b16 v[124:125], v12 offset:29696
    ds_read_b64_tr_b16 v[126:127], v12 offset:31744
    v_mul_f32 v132, v169, v132
    s_waitcnt vmcnt(11) lgkmcnt(4)
    v_mfma_f32_32x32x16_bf16 v[56:71], v[112:115], a[52:55], v[56:71]
    buffer_load_dwordx4 a[100:103], v3, s[4:7], s55 offen offset:512 sc1
    ds_read_b64_tr_b16 v[104:105], v12 offset:29184
    ds_read_b64_tr_b16 v[106:107], v12 offset:31232
    v_mul_f32 v133, v169, v133
    v_mfma_f32_32x32x16_bf16 v[72:87], v[116:119], a[52:55], v[72:87]
    ds_read_b64_tr_b16 v[108:109], v12 offset:30208
    ds_read_b64_tr_b16 v[110:111], v12 offset:32256
    v_mul_f32 v134, v169, v134
    s_waitcnt vmcnt(11) lgkmcnt(4)
    v_mfma_f32_32x32x16_bf16 v[56:71], v[120:123], a[56:59], v[56:71]
    buffer_load_dwordx4 a[104:107], v3, s[4:7], s55 offen offset:1024 sc1
    ds_read_b64_tr_b16 v[112:113], v12 offset:32768
    ds_read_b64_tr_b16 v[114:115], v12 offset:34816
    v_mul_f32 v135, v169, v135
    v_mfma_f32_32x32x16_bf16 v[72:87], v[124:127], a[56:59], v[72:87]
    ds_read_b64_tr_b16 v[116:117], v12 offset:33792
    ds_read_b64_tr_b16 v[118:119], v12 offset:35840
    v_mul_f32 v136, v169, v136
    s_waitcnt vmcnt(11) lgkmcnt(4)
    v_mfma_f32_32x32x16_bf16 v[56:71], v[104:107], a[60:63], v[56:71]
    buffer_load_dwordx4 a[108:111], v3, s[4:7], s55 offen offset:1536 sc1
    ds_read_b64_tr_b16 v[120:121], v12 offset:33280
    ds_read_b64_tr_b16 v[122:123], v12 offset:35328
    v_mul_f32 v137, v169, v137
    v_mfma_f32_32x32x16_bf16 v[72:87], v[108:111], a[60:63], v[72:87]
    ds_read_b64_tr_b16 v[124:125], v12 offset:34304
    ds_read_b64_tr_b16 v[126:127], v12 offset:36352
    v_mul_f32 v138, v169, v138
    s_waitcnt vmcnt(11) lgkmcnt(4)
    v_mfma_f32_32x32x16_bf16 v[56:71], v[112:115], a[64:67], v[56:71]
    buffer_load_dwordx4 a[112:115], v3, s[4:7], s55 offen offset:2048 sc1
    ds_read_b64_tr_b16 v[104:105], v12 offset:36864
    ds_read_b64_tr_b16 v[106:107], v12 offset:38912
    v_mul_f32 v139, v169, v139
    v_mfma_f32_32x32x16_bf16 v[72:87], v[116:119], a[64:67], v[72:87]
    ds_read_b64_tr_b16 v[108:109], v12 offset:37888
    ds_read_b64_tr_b16 v[110:111], v12 offset:39936
    v_mul_f32 v140, v169, v140
    s_waitcnt vmcnt(11) lgkmcnt(4)
    v_mfma_f32_32x32x16_bf16 v[56:71], v[120:123], a[68:71], v[56:71]
    buffer_load_dwordx4 a[116:119], v3, s[4:7], s55 offen offset:2560 sc1
    ds_read_b64_tr_b16 v[112:113], v12 offset:37376
    ds_read_b64_tr_b16 v[114:115], v12 offset:39424
    v_mul_f32 v141, v169, v141
    v_mfma_f32_32x32x16_bf16 v[72:87], v[124:127], a[68:71], v[72:87]
    ds_read_b64_tr_b16 v[116:117], v12 offset:38400
    ds_read_b64_tr_b16 v[118:119], v12 offset:40448
    v_mul_f32 v142, v169, v142
    s_waitcnt vmcnt(11) lgkmcnt(4)
    v_mfma_f32_32x32x16_bf16 v[56:71], v[104:107], a[72:75], v[56:71]
    buffer_load_dwordx4 a[120:123], v3, s[4:7], s55 offen offset:3072 sc1
    ds_read_b64_tr_b16 v[120:121], v12 offset:40960
    ds_read_b64_tr_b16 v[122:123], v12 offset:43008
    v_mul_f32 v143, v169, v143
    v_mfma_f32_32x32x16_bf16 v[72:87], v[108:111], a[72:75], v[72:87]
    ds_read_b64_tr_b16 v[124:125], v12 offset:41984
    ds_read_b64_tr_b16 v[126:127], v12 offset:44032
    v_mul_f32 v144, v169, v144
    s_waitcnt vmcnt(11) lgkmcnt(4)
    v_mfma_f32_32x32x16_bf16 v[56:71], v[112:115], a[76:79], v[56:71]
    buffer_load_dwordx4 a[124:127], v3, s[4:7], s55 offen offset:3584 sc1
    ds_read_b64_tr_b16 v[104:105], v12 offset:41472
    ds_read_b64_tr_b16 v[106:107], v12 offset:43520
    v_mul_f32 v145, v169, v145
    v_mfma_f32_32x32x16_bf16 v[72:87], v[116:119], a[76:79], v[72:87]
    ds_read_b64_tr_b16 v[108:109], v12 offset:42496
    ds_read_b64_tr_b16 v[110:111], v12 offset:44544
    v_mul_f32 v146, v169, v146
    s_waitcnt vmcnt(11) lgkmcnt(4)
    v_mfma_f32_32x32x16_bf16 v[56:71], v[120:123], a[80:83], v[56:71]
    s_xor_b32 m0, s84, 0
    s_xor_b32 s58, s82, 0
    s_mul_i32 s58, s58, 196608
    buffer_load_dwordx4 v7, s[12:15], s58 offen lds
    ds_read_b64_tr_b16 v[112:113], v12 offset:45056
    ds_read_b64_tr_b16 v[114:115], v12 offset:47104
    v_mul_f32 v147, v169, v147
    v_mfma_f32_32x32x16_bf16 v[72:87], v[124:127], a[80:83], v[72:87]
    ds_read_b64_tr_b16 v[116:117], v12 offset:46080
    ds_read_b64_tr_b16 v[118:119], v12 offset:48128
    v_mul_f32 v148, v169, v148
    s_waitcnt vmcnt(11) lgkmcnt(4)
    v_mfma_f32_32x32x16_bf16 v[56:71], v[104:107], a[84:87], v[56:71]
    s_xor_b32 m0, s84, 4096
    s_xor_b32 s58, s82, 1
    s_mul_i32 s58, s58, 196608
    buffer_load_dwordx4 v7, s[12:15], s58 offen lds
    ds_read_b64_tr_b16 v[120:121], v12 offset:45568
    ds_read_b64_tr_b16 v[122:123], v12 offset:47616
    v_mul_f32 v149, v169, v149
    v_mfma_f32_32x32x16_bf16 v[72:87], v[108:111], a[84:87], v[72:87]
    ds_read_b64_tr_b16 v[124:125], v12 offset:46592
    ds_read_b64_tr_b16 v[126:127], v12 offset:48640
    v_mul_f32 v150, v169, v150
    s_waitcnt vmcnt(11) lgkmcnt(4)
    v_mfma_f32_32x32x16_bf16 v[56:71], v[112:115], a[88:91], v[56:71]
    s_xor_b32 m0, s84, 8192
    s_xor_b32 s58, s82, 2
    s_mul_i32 s58, s58, 196608
    buffer_load_dwordx4 v7, s[12:15], s58 offen lds
    ds_read_b64_tr_b16 v[104:105], v12 offset:49152
    ds_read_b64_tr_b16 v[106:107], v12 offset:51200
    v_mul_f32 v151, v169, v151
    v_mfma_f32_32x32x16_bf16 v[72:87], v[116:119], a[88:91], v[72:87]
    ds_read_b64_tr_b16 v[108:109], v12 offset:50176
    ds_read_b64_tr_b16 v[110:111], v12 offset:52224
    v_mul_f32_e64 v152, v169, v152
    s_waitcnt vmcnt(11) lgkmcnt(4)
    v_mfma_f32_32x32x16_bf16 v[56:71], v[120:123], a[92:95], v[56:71]
    s_xor_b32 m0, s84, 12288
    s_xor_b32 s58, s82, 3
    s_mul_i32 s58, s58, 196608
    buffer_load_dwordx4 v7, s[12:15], s58 offen lds
    ds_read_b64_tr_b16 v[112:113], v12 offset:49664
    ds_read_b64_tr_b16 v[114:115], v12 offset:51712
    v_mul_f32_e64 v153, v169, v153
    v_mfma_f32_32x32x16_bf16 v[72:87], v[124:127], a[92:95], v[72:87]
    ds_read_b64_tr_b16 v[116:117], v12 offset:50688
    ds_read_b64_tr_b16 v[118:119], v12 offset:52736
    v_mul_f32_e64 v154, v169, v154
    s_waitcnt vmcnt(11) lgkmcnt(4)
    v_mfma_f32_32x32x16_bf16 v[56:71], v[104:107], a[96:99], v[56:71]
    s_xor_b32 m0, s84, 16384
    s_xor_b32 s58, s82, 4
    s_mul_i32 s58, s58, 196608
    buffer_load_dwordx4 v7, s[12:15], s58 offen lds
    ds_read_b64_tr_b16 v[120:121], v12 offset:53248
    ds_read_b64_tr_b16 v[122:123], v12 offset:55296
    v_mul_f32_e64 v155, v169, v155
    v_mfma_f32_32x32x16_bf16 v[72:87], v[108:111], a[96:99], v[72:87]
    ds_read_b64_tr_b16 v[124:125], v12 offset:54272
    ds_read_b64_tr_b16 v[126:127], v12 offset:56320
    v_mul_f32_e64 v156, v169, v156
    s_waitcnt vmcnt(11) lgkmcnt(4)
    v_mfma_f32_32x32x16_bf16 v[56:71], v[112:115], a[100:103], v[56:71]
    s_xor_b32 m0, s84, 20480
    s_xor_b32 s58, s82, 5
    s_mul_i32 s58, s58, 196608
    buffer_load_dwordx4 v7, s[12:15], s58 offen lds
    ds_read_b64_tr_b16 v[104:105], v12 offset:53760
    ds_read_b64_tr_b16 v[106:107], v12 offset:55808
    v_mul_f32_e64 v157, v169, v157
    v_mfma_f32_32x32x16_bf16 v[72:87], v[116:119], a[100:103], v[72:87]
    ds_read_b64_tr_b16 v[108:109], v12 offset:54784
    ds_read_b64_tr_b16 v[110:111], v12 offset:56832
    v_mul_f32_e64 v158, v169, v158
    s_waitcnt vmcnt(11) lgkmcnt(4)
    v_mfma_f32_32x32x16_bf16 v[56:71], v[120:123], a[104:107], v[56:71]
    s_xor_b32 m0, s84, 24576
    s_xor_b32 s58, s82, 6
    s_mul_i32 s58, s58, 196608
    buffer_load_dwordx4 v7, s[12:15], s58 offen lds
    ds_read_b64_tr_b16 v[112:113], v12 offset:57344
    ds_read_b64_tr_b16 v[114:115], v12 offset:59392
    v_mul_f32 v159, v169, v159
    v_mfma_f32_32x32x16_bf16 v[72:87], v[124:127], a[104:107], v[72:87]
    ds_read_b64_tr_b16 v[116:117], v12 offset:58368
    ds_read_b64_tr_b16 v[118:119], v12 offset:60416
    s_waitcnt vmcnt(11) lgkmcnt(4)
    v_mfma_f32_32x32x16_bf16 v[56:71], v[104:107], a[108:111], v[56:71]
    s_xor_b32 m0, s84, 28672
    s_xor_b32 s58, s82, 7
    s_mul_i32 s58, s58, 196608
    buffer_load_dwordx4 v7, s[12:15], s58 offen lds
    ds_read_b64_tr_b16 v[120:121], v12 offset:57856
    ds_read_b64_tr_b16 v[122:123], v12 offset:59904
    v_mfma_f32_32x32x16_bf16 v[72:87], v[108:111], a[108:111], v[72:87]
    ds_read_b64_tr_b16 v[124:125], v12 offset:58880
    ds_read_b64_tr_b16 v[126:127], v12 offset:60928
    s_waitcnt vmcnt(11) lgkmcnt(4)
    v_mfma_f32_32x32x16_bf16 v[56:71], v[112:115], a[112:115], v[56:71]
    ds_read_b64_tr_b16 v[104:105], v12 offset:61440
    ds_read_b64_tr_b16 v[106:107], v12 offset:63488
    v_mfma_f32_32x32x16_bf16 v[72:87], v[116:119], a[112:115], v[72:87]
    ds_read_b64_tr_b16 v[108:109], v12 offset:62464
    ds_read_b64_tr_b16 v[110:111], v12 offset:64512
    s_waitcnt vmcnt(10) lgkmcnt(4)
    v_mfma_f32_32x32x16_bf16 v[56:71], v[120:123], a[116:119], v[56:71]
    ds_read_b64_tr_b16 v[112:113], v12 offset:61952
    ds_read_b64_tr_b16 v[114:115], v12 offset:64000
    v_mfma_f32_32x32x16_bf16 v[72:87], v[124:127], a[116:119], v[72:87]
    ds_read_b64_tr_b16 v[116:117], v12 offset:62976
    ds_read_b64_tr_b16 v[118:119], v12 offset:65024
    s_waitcnt vmcnt(9) lgkmcnt(4)
    v_mfma_f32_32x32x16_bf16 v[56:71], v[104:107], a[120:123], v[56:71]
    v_mfma_f32_32x32x16_bf16 v[72:87], v[108:111], a[120:123], v[72:87]
    s_waitcnt vmcnt(8) lgkmcnt(0)
    v_mfma_f32_32x32x16_bf16 v[56:71], v[112:115], a[124:127], v[56:71]
    v_mfma_f32_32x32x16_bf16 v[72:87], v[116:119], a[124:127], v[72:87]
    s_cmp_eq_u32 s50, 0
    s_cselect_b32 s14, s14, 0
    s_nop 8
    v_pk_fma_f32 v[56:57], v[56:57], v[168:169], v[128:129] op_sel:[0,0,0] op_sel_hi:[1,0,1]
    v_pk_fma_f32 v[58:59], v[58:59], v[168:169], v[130:131] op_sel:[0,0,0] op_sel_hi:[1,0,1]
    v_pk_fma_f32 v[60:61], v[60:61], v[168:169], v[132:133] op_sel:[0,0,0] op_sel_hi:[1,0,1]
    v_pk_fma_f32 v[62:63], v[62:63], v[168:169], v[134:135] op_sel:[0,0,0] op_sel_hi:[1,0,1]
    v_cvt_pk_bf16_f32 v208, v56, v57
    v_cvt_pk_bf16_f32 v209, v58, v59
    v_cvt_pk_bf16_f32 v210, v60, v61
    v_cvt_pk_bf16_f32 v211, v62, v63
    buffer_store_dwordx4 v[208:211], v13, s[4:7], s73 offen offset:0 sc1
    ds_write_b128 v244, v[208:211] offset:0
    v_pk_fma_f32 v[64:65], v[64:65], v[168:169], v[136:137] op_sel:[0,0,0] op_sel_hi:[1,0,1]
    v_pk_fma_f32 v[66:67], v[66:67], v[168:169], v[138:139] op_sel:[0,0,0] op_sel_hi:[1,0,1]
    v_pk_fma_f32 v[68:69], v[68:69], v[168:169], v[140:141] op_sel:[0,0,0] op_sel_hi:[1,0,1]
    v_pk_fma_f32 v[70:71], v[70:71], v[168:169], v[142:143] op_sel:[0,0,0] op_sel_hi:[1,0,1]
    v_cvt_pk_bf16_f32 v212, v64, v65
    v_cvt_pk_bf16_f32 v213, v66, v67
    v_cvt_pk_bf16_f32 v214, v68, v69
    v_cvt_pk_bf16_f32 v215, v70, v71
    buffer_store_dwordx4 v[212:215], v13, s[4:7], s73 offen offset:1024 sc1
    ds_write_b128 v244, v[212:215] offset:1024
    v_pk_fma_f32 v[72:73], v[72:73], v[168:169], v[144:145] op_sel:[0,0,0] op_sel_hi:[1,0,1]
    v_pk_fma_f32 v[74:75], v[74:75], v[168:169], v[146:147] op_sel:[0,0,0] op_sel_hi:[1,0,1]
    v_pk_fma_f32 v[76:77], v[76:77], v[168:169], v[148:149] op_sel:[0,0,0] op_sel_hi:[1,0,1]
    v_pk_fma_f32 v[78:79], v[78:79], v[168:169], v[150:151] op_sel:[0,0,0] op_sel_hi:[1,0,1]
    v_cvt_pk_bf16_f32 v216, v72, v73
    v_cvt_pk_bf16_f32 v217, v74, v75
    v_cvt_pk_bf16_f32 v218, v76, v77
    v_cvt_pk_bf16_f32 v219, v78, v79
    buffer_store_dwordx4 v[216:219], v242, s[4:7], s73 offen offset:2048 sc1
    ds_write_b128 v245, v[216:219] offset:2048
    v_pk_fma_f32 v[80:81], v[80:81], v[168:169], v[152:153] op_sel:[0,0,0] op_sel_hi:[1,0,1]
    v_pk_fma_f32 v[82:83], v[82:83], v[168:169], v[154:155] op_sel:[0,0,0] op_sel_hi:[1,0,1]
    v_pk_fma_f32 v[84:85], v[84:85], v[168:169], v[156:157] op_sel:[0,0,0] op_sel_hi:[1,0,1]
    v_pk_fma_f32 v[86:87], v[86:87], v[168:169], v[158:159] op_sel:[0,0,0] op_sel_hi:[1,0,1]
    v_cvt_pk_bf16_f32 v220, v80, v81
    v_cvt_pk_bf16_f32 v221, v82, v83
    v_cvt_pk_bf16_f32 v222, v84, v85
    v_cvt_pk_bf16_f32 v223, v86, v87
    buffer_store_dwordx4 v[220:223], v243, s[4:7], s73 offen offset:3072 sc1
    ds_write_b128 v246, v[220:223] offset:3072
    ds_write_b64 v237, v[238:239]
    s_waitcnt vmcnt(4)
    s_cmp_lg_u32 s50, 0
    s_cbranch_scc1 l0_13
    v_add_u32 v20, s68, v240
    ds_read_b64_tr_b16 v[104:105], v20 offset:0
    ds_read_b64_tr_b16 v[106:107], v20 offset:512
    ds_read_b64_tr_b16 v[108:109], v20 offset:4096
    ds_read_b64_tr_b16 v[110:111], v20 offset:4608
    ds_read_b64_tr_b16 v[112:113], v20 offset:8192
    ds_read_b64_tr_b16 v[114:115], v20 offset:8704
    ds_read_b64_tr_b16 v[116:117], v20 offset:12288
    ds_read_b64_tr_b16 v[118:119], v20 offset:12800
    ds_read_b64_tr_b16 v[120:121], v20 offset:16384
    ds_read_b64_tr_b16 v[122:123], v20 offset:16896
    ds_read_b64_tr_b16 v[124:125], v20 offset:20480
    ds_read_b64_tr_b16 v[126:127], v20 offset:20992
    s_waitcnt lgkmcnt(10)
    v_mfma_f32_16x16x32_bf16 v[56:59], v[196:199], v[104:107], 0
    ds_read_b64_tr_b16 v[104:105], v20 offset:24576
    ds_read_b64_tr_b16 v[106:107], v20 offset:25088
    s_waitcnt lgkmcnt(10)
    v_mfma_f32_16x16x32_bf16 v[60:63], v[196:199], v[108:111], 0
    ds_read_b64_tr_b16 v[108:109], v20 offset:28672
    ds_read_b64_tr_b16 v[110:111], v20 offset:29184
    s_waitcnt lgkmcnt(10)
    v_mfma_f32_16x16x32_bf16 v[56:59], v[196:199], v[112:115], v[56:59]
    s_waitcnt lgkmcnt(8)
    v_mfma_f32_16x16x32_bf16 v[60:63], v[196:199], v[116:119], v[60:63]
    s_waitcnt lgkmcnt(6)
    v_mfma_f32_16x16x32_bf16 v[56:59], v[196:199], v[120:123], v[56:59]
    s_waitcnt lgkmcnt(4)
    v_mfma_f32_16x16x32_bf16 v[60:63], v[196:199], v[124:127], v[60:63]
    s_waitcnt lgkmcnt(2)
    v_mfma_f32_16x16x32_bf16 v[56:59], v[196:199], v[104:107], v[56:59]
    s_waitcnt lgkmcnt(0)
    v_mfma_f32_16x16x32_bf16 v[60:63], v[196:199], v[108:111], v[60:63]
    s_mul_i32 s60, s44, 384
    s_add_u32 s60, s60, 110592
    v_and_b32_e64 v20, 31, v0
    v_lshl_add_u32 v20, v20, 2, s60
    s_nop 3
    v_add_f32 v56, v56, v60
    ds_write_b32 v20, v56 offset:0
    s_waitcnt lgkmcnt(0)
l0_13:
    s_barrier
    s_cmp_lg_u32 s50, 0
    s_cbranch_scc1 l0_14
    v_min_u32 v19, 7, v0
    v_lshlrev_b32 v19, 4, v19
    v_add_u32 v19, 110592, v19
    ds_read_b128 v[128:131], v19 offset:0
    ds_read_b128 v[132:135], v19 offset:384
    ds_read_b128 v[136:139], v19 offset:768
    ds_read_b128 v[140:143], v19 offset:1152
    s_waitcnt lgkmcnt(0)
    v_pk_add_f32 v[128:129], v[128:129], v[132:133]
    v_pk_add_f32 v[130:131], v[130:131], v[134:135]
    v_pk_add_f32 v[128:129], v[128:129], v[136:137]
    v_pk_add_f32 v[130:131], v[130:131], v[138:139]
    v_pk_add_f32 v[128:129], v[128:129], v[140:141]
    v_pk_add_f32 v[130:131], v[130:131], v[142:143]
    ds_write_b128 v19, v[128:131] offset:51200
    s_waitcnt lgkmcnt(0)
l0_14:
    ds_read_b64_tr_b16 v[104:105], v240 offset:0
    ds_read_b64_tr_b16 v[106:107], v240 offset:1024
    ds_read_b64_tr_b16 v[108:109], v240 offset:512
    ds_read_b64_tr_b16 v[110:111], v240 offset:1536
    ds_read_b64_tr_b16 v[112:113], v240 offset:2048
    ds_read_b64_tr_b16 v[114:115], v240 offset:3072
    ds_read_b64_tr_b16 v[116:117], v240 offset:2560
    ds_read_b64_tr_b16 v[118:119], v240 offset:3584
    s_waitcnt lgkmcnt(6)
    v_mfma_f32_32x32x16_bf16 v[88:103], v[104:107], a[0:3], 0
    ds_read_b64_tr_b16 v[120:121], v240 offset:4096
    ds_read_b64_tr_b16 v[122:123], v240 offset:5120
    ds_read_b128 v[128:131], v241 offset:0
    ds_read_b128 v[132:135], v241 offset:32
    s_waitcnt lgkmcnt(8)
    v_mfma_f32_32x32x16_bf16 v[88:103], v[108:111], a[4:7], v[88:103]
    ds_read_b64_tr_b16 v[124:125], v240 offset:4608
    ds_read_b64_tr_b16 v[126:127], v240 offset:5632
    ds_read_b128 v[136:139], v241 offset:64
    ds_read_b128 v[140:143], v241 offset:96
    s_waitcnt lgkmcnt(10)
    v_mfma_f32_32x32x16_bf16 v[88:103], v[112:115], a[8:11], v[88:103]
    ds_read_b64_tr_b16 v[104:105], v240 offset:6144
    ds_read_b64_tr_b16 v[106:107], v240 offset:7168
    v_mul_f32 v168, 0x3eb8aa3b, v168
    v_mul_f32 v169, 0x3eb8aa3b, v169
    s_waitcnt lgkmcnt(10)
    v_mfma_f32_32x32x16_bf16 v[88:103], v[116:119], a[12:15], v[88:103]
    ds_read_b64_tr_b16 v[108:109], v240 offset:6656
    ds_read_b64_tr_b16 v[110:111], v240 offset:7680
    s_waitcnt lgkmcnt(4)
    v_mul_f32 v128, v169, v128
    v_mfma_f32_32x32x16_bf16 v[88:103], v[120:123], a[16:19], v[88:103]
    ds_read_b64_tr_b16 v[112:113], v240 offset:8192
    ds_read_b64_tr_b16 v[114:115], v240 offset:9216
    v_mul_f32 v129, v169, v129
    v_mfma_f32_32x32x16_bf16 v[88:103], v[124:127], a[20:23], v[88:103]
    ds_read_b64_tr_b16 v[116:117], v240 offset:8704
    ds_read_b64_tr_b16 v[118:119], v240 offset:9728
    v_mul_f32 v130, v169, v130
    s_waitcnt lgkmcnt(6)
    v_mfma_f32_32x32x16_bf16 v[88:103], v[104:107], a[24:27], v[88:103]
    ds_read_b64_tr_b16 v[120:121], v240 offset:10240
    ds_read_b64_tr_b16 v[122:123], v240 offset:11264
    v_mul_f32 v131, v169, v131
    s_waitcnt lgkmcnt(6)
    v_mfma_f32_32x32x16_bf16 v[88:103], v[108:111], a[28:31], v[88:103]
    ds_read_b64_tr_b16 v[124:125], v240 offset:10752
    ds_read_b64_tr_b16 v[126:127], v240 offset:11776
    v_mul_f32 v132, v169, v132
    s_waitcnt lgkmcnt(6)
    v_mfma_f32_32x32x16_bf16 v[88:103], v[112:115], a[32:35], v[88:103]
    ds_read_b64_tr_b16 v[104:105], v240 offset:12288
    ds_read_b64_tr_b16 v[106:107], v240 offset:13312
    v_mul_f32 v133, v169, v133
    s_waitcnt lgkmcnt(6)
    v_mfma_f32_32x32x16_bf16 v[88:103], v[116:119], a[36:39], v[88:103]
    ds_read_b64_tr_b16 v[108:109], v240 offset:12800
    ds_read_b64_tr_b16 v[110:111], v240 offset:13824
    v_mul_f32 v134, v169, v134
    s_waitcnt lgkmcnt(6)
    v_mfma_f32_32x32x16_bf16 v[88:103], v[120:123], a[40:43], v[88:103]
    ds_read_b64_tr_b16 v[112:113], v240 offset:14336
    ds_read_b64_tr_b16 v[114:115], v240 offset:15360
    v_mul_f32 v135, v169, v135
    s_waitcnt lgkmcnt(6)
    v_mfma_f32_32x32x16_bf16 v[88:103], v[124:127], a[44:47], v[88:103]
    ds_read_b64_tr_b16 v[116:117], v240 offset:14848
    ds_read_b64_tr_b16 v[118:119], v240 offset:15872
    v_mul_f32 v136, v169, v136
    s_waitcnt lgkmcnt(6)
    v_mfma_f32_32x32x16_bf16 v[88:103], v[104:107], a[48:51], v[88:103]
    ds_read_b64_tr_b16 v[120:121], v240 offset:16384
    ds_read_b64_tr_b16 v[122:123], v240 offset:17408
    v_mul_f32 v137, v169, v137
    s_waitcnt lgkmcnt(6)
    v_mfma_f32_32x32x16_bf16 v[88:103], v[108:111], a[52:55], v[88:103]
    ds_read_b64_tr_b16 v[124:125], v240 offset:16896
    ds_read_b64_tr_b16 v[126:127], v240 offset:17920
    v_mul_f32 v138, v169, v138
    s_waitcnt lgkmcnt(6)
    v_mfma_f32_32x32x16_bf16 v[88:103], v[112:115], a[56:59], v[88:103]
    ds_read_b64_tr_b16 v[104:105], v240 offset:18432
    ds_read_b64_tr_b16 v[106:107], v240 offset:19456
    v_mul_f32 v139, v169, v139
    s_waitcnt lgkmcnt(6)
    v_mfma_f32_32x32x16_bf16 v[88:103], v[116:119], a[60:63], v[88:103]
    ds_read_b64_tr_b16 v[108:109], v240 offset:18944
    ds_read_b64_tr_b16 v[110:111], v240 offset:19968
    v_mul_f32 v140, v169, v140
    s_waitcnt lgkmcnt(6)
    v_mfma_f32_32x32x16_bf16 v[88:103], v[120:123], a[64:67], v[88:103]
    ds_read_b64_tr_b16 v[112:113], v240 offset:20480
    ds_read_b64_tr_b16 v[114:115], v240 offset:21504
    v_mul_f32 v141, v169, v141
    s_add_u32 s64, s64, 1
    v_mov_b32 v21, s65
    v_mov_b32 v20, s64
    v_lshlrev_b32 v19, 3, v0
    s_mov_b64 exec, 0xffff
    s_waitcnt vmcnt(0)
    buffer_store_dwordx2 v[20:21], v19, s[8:11], s72 offen sc1
    s_mov_b64 exec, -1
    s_waitcnt lgkmcnt(6)
    v_mfma_f32_32x32x16_bf16 v[88:103], v[124:127], a[68:71], v[88:103]
    ds_read_b64_tr_b16 v[116:117], v240 offset:20992
    ds_read_b64_tr_b16 v[118:119], v240 offset:22016
    v_mul_f32_e64 v142, v169, v142
    s_add_u32 m0, s68, 0
    s_mov_b32 s58, 0
    buffer_load_dwordx4 v6, s[16:19], s58 offen lds
    s_waitcnt lgkmcnt(6)
    v_mfma_f32_32x32x16_bf16 v[88:103], v[104:107], a[72:75], v[88:103]
    ds_read_b64_tr_b16 v[120:121], v240 offset:22528
    ds_read_b64_tr_b16 v[122:123], v240 offset:23552
    v_mul_f32_e64 v143, v169, v143
    s_add_u32 m0, m0, s53
    s_add_u32 s58, s58, s56
    buffer_load_dwordx4 v6, s[16:19], s58 offen lds
    s_waitcnt lgkmcnt(6)
    v_mfma_f32_32x32x16_bf16 v[88:103], v[108:111], a[76:79], v[88:103]
    ds_read_b64_tr_b16 v[124:125], v240 offset:23040
    ds_read_b64_tr_b16 v[126:127], v240 offset:24064
    s_waitcnt lgkmcnt(6)
    v_mfma_f32_32x32x16_bf16 v[88:103], v[112:115], a[80:83], v[88:103]
    ds_read_b64_tr_b16 v[104:105], v240 offset:24576
    ds_read_b64_tr_b16 v[106:107], v240 offset:25600
    s_add_u32 m0, m0, s53
    s_add_u32 s58, s58, s56
    buffer_load_dwordx4 v6, s[16:19], s58 offen lds
    s_waitcnt lgkmcnt(6)
    v_mfma_f32_32x32x16_bf16 v[88:103], v[116:119], a[84:87], v[88:103]
    ds_read_b64_tr_b16 v[108:109], v240 offset:25088
    ds_read_b64_tr_b16 v[110:111], v240 offset:26112
    s_waitcnt lgkmcnt(6)
    v_mfma_f32_32x32x16_bf16 v[88:103], v[120:123], a[88:91], v[88:103]
    ds_read_b64_tr_b16 v[112:113], v240 offset:26624
    ds_read_b64_tr_b16 v[114:115], v240 offset:27648
    s_add_u32 m0, m0, s53
    s_add_u32 s58, s58, s56
    buffer_load_dwordx4 v6, s[16:19], s58 offen lds
    s_waitcnt lgkmcnt(6)
    v_mfma_f32_32x32x16_bf16 v[88:103], v[124:127], a[92:95], v[88:103]
    ds_read_b64_tr_b16 v[116:117], v240 offset:27136
    ds_read_b64_tr_b16 v[118:119], v240 offset:28160
    s_waitcnt lgkmcnt(6)
    v_mfma_f32_32x32x16_bf16 v[88:103], v[104:107], a[96:99], v[88:103]
    ds_read_b64_tr_b16 v[120:121], v240 offset:28672
    ds_read_b64_tr_b16 v[122:123], v240 offset:29696
    s_add_u32 m0, m0, s53
    s_add_u32 s58, s58, s56
    buffer_load_dwordx4 v6, s[16:19], s58 offen lds
    s_waitcnt lgkmcnt(6)
    v_mfma_f32_32x32x16_bf16 v[88:103], v[108:111], a[100:103], v[88:103]
    ds_read_b64_tr_b16 v[124:125], v240 offset:29184
    ds_read_b64_tr_b16 v[126:127], v240 offset:30208
    s_waitcnt lgkmcnt(6)
    v_mfma_f32_32x32x16_bf16 v[88:103], v[112:115], a[104:107], v[88:103]
    ds_read_b64_tr_b16 v[104:105], v240 offset:30720
    ds_read_b64_tr_b16 v[106:107], v240 offset:31744
    s_add_u32 m0, m0, s53
    s_add_u32 s58, s58, s56
    buffer_load_dwordx4 v6, s[16:19], s58 offen lds
    s_waitcnt lgkmcnt(6)
    v_mfma_f32_32x32x16_bf16 v[88:103], v[116:119], a[108:111], v[88:103]
    ds_read_b64_tr_b16 v[108:109], v240 offset:31232
    ds_read_b64_tr_b16 v[110:111], v240 offset:32256
    s_waitcnt lgkmcnt(6)
    v_mfma_f32_32x32x16_bf16 v[88:103], v[120:123], a[112:115], v[88:103]
    s_add_u32 m0, m0, s53
    s_add_u32 s58, s58, s56
    buffer_load_dwordx4 v6, s[16:19], s58 offen lds
    s_waitcnt lgkmcnt(4)
    v_mfma_f32_32x32x16_bf16 v[88:103], v[124:127], a[116:119], v[88:103]
    s_waitcnt lgkmcnt(2)
    v_mfma_f32_32x32x16_bf16 v[88:103], v[104:107], a[120:123], v[88:103]
    s_add_u32 m0, m0, s53
    s_add_u32 s58, s58, s56
    buffer_load_dwordx4 v6, s[16:19], s58 offen lds
    s_waitcnt lgkmcnt(0)
    v_mfma_f32_32x32x16_bf16 v[88:103], v[108:111], a[124:127], v[88:103]
    s_nop 11
    v_pk_fma_f32 v[88:89], v[88:89], v[168:169], v[128:129] op_sel:[0,0,0] op_sel_hi:[1,0,1]
    v_pk_fma_f32 v[90:91], v[90:91], v[168:169], v[130:131] op_sel:[0,0,0] op_sel_hi:[1,0,1]
    v_pk_fma_f32 v[92:93], v[92:93], v[168:169], v[132:133] op_sel:[0,0,0] op_sel_hi:[1,0,1]
    v_pk_fma_f32 v[94:95], v[94:95], v[168:169], v[134:135] op_sel:[0,0,0] op_sel_hi:[1,0,1]
    v_pk_fma_f32 v[96:97], v[96:97], v[168:169], v[136:137] op_sel:[0,0,0] op_sel_hi:[1,0,1]
    v_pk_fma_f32 v[98:99], v[98:99], v[168:169], v[138:139] op_sel:[0,0,0] op_sel_hi:[1,0,1]
    v_pk_fma_f32 v[100:101], v[100:101], v[168:169], v[140:141] op_sel:[0,0,0] op_sel_hi:[1,0,1]
    v_pk_fma_f32 v[102:103], v[102:103], v[168:169], v[142:143] op_sel:[0,0,0] op_sel_hi:[1,0,1]
    v_cvt_pk_bf16_f32 v200, v88, v89
    v_cvt_pk_bf16_f32 v201, v90, v91
    v_cvt_pk_bf16_f32 v202, v92, v93
    v_cvt_pk_bf16_f32 v203, v94, v95
    v_cvt_pk_bf16_f32 v204, v96, v97
    v_cvt_pk_bf16_f32 v205, v98, v99
    v_cvt_pk_bf16_f32 v206, v100, v101
    v_cvt_pk_bf16_f32 v207, v102, v103
    ds_write_b128 v195, v[200:203] offset:0
    ds_write_b128 v195, v[204:207] offset:2048
    s_waitcnt lgkmcnt(0)
    s_barrier
    ds_read_b128 v[208:211], v192 offset:40960
    ds_read_b128 v[204:207], v247 offset:4096
    ds_read_b128 v[200:203], v247 offset:0
    ds_read_b128 v[212:215], v192 offset:36864
    v_lshlrev_b32_e64 v19, 5, v0
    buffer_load_dwordx2 v[120:121], v19, s[40:43], 0 offen sc1
    buffer_load_dwordx2 v[20:21], v18, s[8:11], 0 offen sc1
    v_xor_b32 v104, 4051697664, v40
    v_xor_b32 v105, 4051697664, v41
    v_xor_b32 v106, 4051697664, v42
    v_xor_b32 v107, 4051697664, v43
    v_xor_b32 v108, 4051697664, v44
    v_xor_b32 v109, 4051697664, v45
    v_xor_b32 v110, 4051697664, v46
    v_xor_b32 v111, 4051697664, v47
    v_xor_b32 v112, 4051697664, v48
    v_xor_b32 v113, 4051697664, v49
    v_xor_b32 v114, 4051697664, v50
    v_xor_b32 v115, 4051697664, v51
    v_xor_b32 v116, 4051697664, v52
    v_xor_b32 v117, 4051697664, v53
    v_xor_b32 v118, 4051697664, v54
    v_xor_b32 v119, 4051697664, v55
    s_waitcnt lgkmcnt(0)
    v_mfma_f32_32x32x16_bf16 v[56:71], v[208:211], v[204:207], v[40:55]
    v_mfma_f32_32x32x16_bf16 v[72:87], v[212:215], v[204:207], 0
    ds_read_b64_tr_b16 v[216:217], v193 offset:0
    ds_read_b64_tr_b16 v[218:219], v194 offset:0
    ds_read_b64_tr_b16 v[220:221], v193 offset:256
    ds_read_b64_tr_b16 v[222:223], v194 offset:256
    ds_read_b128 v[208:211], v192 offset:32768
    s_nop 5
    v_exp_f32 v56, v56
    v_exp_f32 v57, v57
    v_exp_f32 v58, v58
    v_exp_f32 v59, v59
    s_add_u32 m0, s68, 32768
    s_mov_b32 s58, 262144
    buffer_load_dwordx4 v6, s[16:19], s58 offen lds
    v_exp_f32 v60, v60
    v_exp_f32 v61, v61
    v_exp_f32 v62, v62
    v_exp_f32 v63, v63
    v_sub_u32 v245, v193, v236
    v_sub_u32 v246, v194, v236
    s_add_u32 m0, m0, s53
    s_add_u32 s58, s58, s56
    buffer_load_dwordx4 v6, s[16:19], s58 offen lds
    v_cvt_pk_bf16_f32 v224, v56, v57
    v_cvt_pk_bf16_f32 v225, v58, v59
    v_cvt_pk_bf16_f32 v226, v60, v61
    v_cvt_pk_bf16_f32 v227, v62, v63
    v_exp_f32 v64, v64
    s_waitcnt lgkmcnt(0)
    v_mfma_f32_32x32x16_bf16 v[160:175], v[216:219], v[224:227], 0
    v_exp_f32 v65, v65
    v_exp_f32 v66, v66
    v_exp_f32 v67, v67
    v_exp_f32 v68, v68
    v_exp_f32 v69, v69
    v_exp_f32 v70, v70
    v_exp_f32 v71, v71
    v_cvt_pk_bf16_f32 v228, v64, v65
    v_cvt_pk_bf16_f32 v229, v66, v67
    v_cvt_pk_bf16_f32 v230, v68, v69
    v_cvt_pk_bf16_f32 v231, v70, v71
    v_mfma_f32_32x32x16_bf16 v[56:71], v[208:211], v[204:207], 0
    ds_read_b64_tr_b16 v[216:217], v245 offset:0
    ds_read_b64_tr_b16 v[218:219], v246 offset:0
    ds_read_b64_tr_b16 v[232:233], v245 offset:256
    ds_read_b64_tr_b16 v[234:235], v246 offset:256
    v_exp_f32 v72, v72
    v_exp_f32 v73, v73
    v_exp_f32 v74, v74
    v_mfma_f32_32x32x16_bf16 v[160:175], v[220:223], v[228:231], v[160:175]
    v_exp_f32 v75, v75
    v_exp_f32 v76, v76
    v_exp_f32 v77, v77
    v_exp_f32 v78, v78
    v_exp_f32 v79, v79
    v_sub_u32 v245, v245, v236
    v_sub_u32 v246, v246, v236
    v_cvt_pk_bf16_f32 v224, v72, v73
    v_cvt_pk_bf16_f32 v225, v74, v75
    v_cvt_pk_bf16_f32 v226, v76, v77
    v_cvt_pk_bf16_f32 v227, v78, v79
    v_exp_f32 v80, v80
    s_waitcnt lgkmcnt(0)
    v_mfma_f32_32x32x16_bf16 v[160:175], v[216:219], v[224:227], v[160:175]
    v_exp_f32 v81, v81
    v_exp_f32 v82, v82
    v_exp_f32 v83, v83
    v_exp_f32 v84, v84
    v_exp_f32 v85, v85
    v_exp_f32 v86, v86
    v_exp_f32 v87, v87
    v_cvt_pk_bf16_f32 v228, v80, v81
    v_cvt_pk_bf16_f32 v229, v82, v83
    v_cvt_pk_bf16_f32 v230, v84, v85
    v_cvt_pk_bf16_f32 v231, v86, v87
    s_add_u32 m0, s68, 141312
    s_max_i32 s60, s74, s81
    s_waitcnt vmcnt(2)
    v_cmp_ne_u64 vcc, s[64:65], v[20:21]
    s_cbranch_vccnz att_p
att_pb:
    buffer_load_dwordx4 v13, s[4:7], s60 offen sc1 lds
    s_sub_u32 m0, m0, s53
    s_sub_u32 s60, s60, 346112
    s_max_i32 s60, s60, s81
    buffer_load_dwordx4 v13, s[4:7], s60 offen sc1 lds
    s_sub_u32 m0, m0, s53
    s_sub_u32 s60, s60, 346112
    s_max_i32 s60, s60, s81
    buffer_load_dwordx4 v13, s[4:7], s60 offen sc1 lds
    s_sub_u32 m0, m0, s53
    s_sub_u32 s60, s60, 346112
    s_max_i32 s60, s60, s81
    buffer_load_dwordx4 v13, s[4:7], s60 offen sc1 lds
    s_sub_u32 m0, m0, s53
    s_sub_u32 s60, s60, 346112
    s_max_i32 s60, s60, s81
    buffer_load_dwordx4 v13, s[4:7], s60 offen sc1 lds
    s_sub_u32 m0, m0, s53
    s_sub_u32 s60, s60, 346112
    s_max_i32 s60, s60, s81
    buffer_load_dwordx4 v13, s[4:7], s60 offen sc1 lds
    s_sub_u32 m0, m0, s53
    s_sub_u32 s60, s60, 346112
    s_max_i32 s60, s60, s81
    buffer_load_dwordx4 v13, s[4:7], s60 offen sc1 lds
    s_sub_u32 m0, m0, s53
    s_sub_u32 s60, s60, 346112
    s_max_i32 s60, s60, s81
    buffer_load_dwordx4 v13, s[4:7], s60 offen sc1 lds
    v_readlane_b32 s60, v120, s45
    v_readlane_b32 s61, v121, s45
    s_cmp_eq_u64 s[60:61], s[66:67]
    s_cselect_b32 s51, 1, 0
    s_and_b32 s52, s51, s89
    s_add_u32 s60, s2, s44
    s_cmp_lt_u32 s60, s50
    s_cbranch_scc1 epoch
epoch_b:
    v_mad_u32_u24 v19, v0, s100, v1
    v_lshl_add_u32 v19, s47, 11, v19
    s_sub_u32 s60, s98, 19456
    s_mov_b32 s61, 17408
    s_mov_b32 exec_hi, 0
    s_mov_b32 exec_lo, 0xffff0000
    v_add_u32 v19, s60, v19
    s_mov_b32 exec_lo, -1
    buffer_load_dword v255, v19, s[4:7], s61 offen sc1
    s_mov_b64 exec, -1
    buffer_load_dword v255, v17, s[8:11], 0 offen sc1
    v_mfma_f32_32x32x16_bf16 v[72:87], v[208:211], v[200:203], v[40:55]
    ds_read_b64_tr_b16 v[216:217], v245 offset:0
    ds_read_b64_tr_b16 v[218:219], v246 offset:0
    ds_read_b64_tr_b16 v[220:221], v245 offset:256
    ds_read_b64_tr_b16 v[222:223], v246 offset:256
    v_exp_f32 v56, v56
    v_exp_f32 v57, v57
    v_exp_f32 v58, v58
    v_mfma_f32_32x32x16_bf16 v[160:175], v[232:235], v[228:231], v[160:175]
    v_exp_f32 v59, v59
    v_exp_f32 v60, v60
    v_exp_f32 v61, v61
    v_exp_f32 v62, v62
    v_exp_f32 v63, v63
    v_sub_u32 v245, v245, v236
    v_sub_u32 v246, v246, v236
    v_cvt_pk_bf16_f32 v224, v56, v57
    v_cvt_pk_bf16_f32 v225, v58, v59
    v_cvt_pk_bf16_f32 v226, v60, v61
    v_cvt_pk_bf16_f32 v227, v62, v63
    v_exp_f32 v64, v64
    s_waitcnt lgkmcnt(0)
    v_mfma_f32_32x32x16_bf16 v[160:175], v[216:219], v[224:227], v[160:175]
    v_exp_f32 v65, v65
    v_exp_f32 v66, v66
    v_exp_f32 v67, v67
    v_exp_f32 v68, v68
    v_exp_f32 v69, v69
    v_exp_f32 v70, v70
    v_exp_f32 v71, v71
    v_cvt_pk_bf16_f32 v228, v64, v65
    v_cvt_pk_bf16_f32 v229, v66, v67
    v_cvt_pk_bf16_f32 v230, v68, v69
    v_cvt_pk_bf16_f32 v231, v70, v71
    v_exp_f32 v72, v72
    s_nop 0
    v_mfma_f32_32x32x16_bf16 v[160:175], v[220:223], v[228:231], v[160:175]
    v_exp_f32 v73, v73
    v_exp_f32 v74, v74
    v_exp_f32 v75, v75
    v_exp_f32 v76, v76
    v_exp_f32 v77, v77
    v_exp_f32 v78, v78
    v_exp_f32 v79, v79
    v_cvt_pk_bf16_f32 v224, v72, v73
    v_cvt_pk_bf16_f32 v225, v74, v75
    v_cvt_pk_bf16_f32 v226, v76, v77
    v_cvt_pk_bf16_f32 v227, v78, v79
    v_exp_f32 v80, v80
    s_nop 0
    v_mfma_f32_32x32x16_bf16 v[176:191], v[216:219], v[224:227], 0
    v_exp_f32 v81, v81
    v_exp_f32 v82, v82
    v_exp_f32 v83, v83
    v_exp_f32 v84, v84
    v_exp_f32 v85, v85
    v_exp_f32 v86, v86
    v_exp_f32 v87, v87
    s_waitcnt vmcnt(9)
    s_barrier
    ds_read_b128 v[212:215], v192 offset:28672
    s_cmp_lg_u32 s50, 0
    s_cbranch_scc1 l0_16
    s_getpc_b64 s[60:61]
pc_17:
    s_lshr_b32 s76, s2, 3
    s_lshl2_add_u32 s76, s76, s44
    s_lshl_b32 s76, s76, 8
    v_lshl_add_u32 v19, v0, 7, s76
    v_min_u32 v19, text_end-pc_17-4, v19
    v_mov_b32 v21, s61
    v_add_co_u32 v20, vcc, s60, v19
    s_nop 1
    v_addc_co_u32 v21, vcc, 0, v21, vcc
    s_mov_b64 exec, 3
    global_load_dword v255, v[20:21], off
    s_mov_b64 exec, -1
l0_16:
    v_cvt_pk_bf16_f32 v228, v80, v81
    v_cvt_pk_bf16_f32 v229, v82, v83
    v_cvt_pk_bf16_f32 v230, v84, v85
    v_cvt_pk_bf16_f32 v231, v86, v87
    s_cmp_eq_u32 s75, 0
    s_cbranch_scc1 att_e8
    s_waitcnt lgkmcnt(0)
    v_mfma_f32_32x32x16_bf16 v[56:71], v[212:215], v[204:207], 0
    v_mfma_f32_32x32x16_bf16 v[72:87], v[212:215], v[200:203], 0
    ds_read_b64_tr_b16 v[216:217], v245 offset:0
    ds_read_b64_tr_b16 v[218:219], v246 offset:0
    ds_read_b64_tr_b16 v[232:233], v245 offset:256
    ds_read_b64_tr_b16 v[234:235], v246 offset:256
    s_nop 6
    v_exp_f32 v56, v56
    v_exp_f32 v57, v57
    v_exp_f32 v58, v58
    v_mfma_f32_32x32x16_bf16 v[176:191], v[220:223], v[228:231], v[176:191]
    v_exp_f32 v59, v59
    v_exp_f32 v60, v60
    v_exp_f32 v61, v61
    v_exp_f32 v62, v62
    v_exp_f32 v63, v63
    v_sub_u32 v245, v245, v236
    v_sub_u32 v246, v246, v236
    v_cvt_pk_bf16_f32 v224, v56, v57
    v_cvt_pk_bf16_f32 v225, v58, v59
    v_cvt_pk_bf16_f32 v226, v60, v61
    v_cvt_pk_bf16_f32 v227, v62, v63
    v_exp_f32 v64, v64
    s_waitcnt lgkmcnt(0)
    v_mfma_f32_32x32x16_bf16 v[160:175], v[216:219], v[224:227], v[160:175]
    v_exp_f32 v65, v65
    v_exp_f32 v66, v66
    v_exp_f32 v67, v67
    v_exp_f32 v68, v68
    v_exp_f32 v69, v69
    s_waitcnt vmcnt(8)
    s_barrier
    ds_read_b128 v[208:211], v192 offset:24576
    v_exp_f32 v70, v70
    v_exp_f32 v71, v71
    v_cvt_pk_bf16_f32 v228, v64, v65
    v_cvt_pk_bf16_f32 v229, v66, v67
    v_cvt_pk_bf16_f32 v230, v68, v69
    v_cvt_pk_bf16_f32 v231, v70, v71
    s_waitcnt lgkmcnt(0)
    v_mfma_f32_32x32x16_bf16 v[56:71], v[208:211], v[204:207], 0
    v_exp_f32 v72, v72
    v_exp_f32 v73, v73
    v_exp_f32 v74, v74
    v_mfma_f32_32x32x16_bf16 v[160:175], v[232:235], v[228:231], v[160:175]
    v_exp_f32 v75, v75
    v_exp_f32 v76, v76
    v_exp_f32 v77, v77
    v_exp_f32 v78, v78
    v_exp_f32 v79, v79
    v_cvt_pk_bf16_f32 v224, v72, v73
    v_cvt_pk_bf16_f32 v225, v74, v75
    v_cvt_pk_bf16_f32 v226, v76, v77
    v_cvt_pk_bf16_f32 v227, v78, v79
    v_exp_f32 v80, v80
    s_nop 0
    v_mfma_f32_32x32x16_bf16 v[176:191], v[216:219], v[224:227], v[176:191]
    v_exp_f32 v81, v81
    v_exp_f32 v82, v82
    v_exp_f32 v83, v83
    v_exp_f32 v84, v84
    v_exp_f32 v85, v85
    v_exp_f32 v86, v86
    v_exp_f32 v87, v87
    v_cvt_pk_bf16_f32 v228, v80, v81
    v_cvt_pk_bf16_f32 v229, v82, v83
    v_cvt_pk_bf16_f32 v230, v84, v85
    v_cvt_pk_bf16_f32 v231, v86, v87
    s_cmp_eq_u32 s75, 1
    s_cbranch_scc1 att_e12
    v_mfma_f32_32x32x16_bf16 v[72:87], v[208:211], v[200:203], 0
    ds_read_b64_tr_b16 v[216:217], v245 offset:0
    ds_read_b64_tr_b16 v[218:219], v246 offset:0
    ds_read_b64_tr_b16 v[220:221], v245 offset:256
    ds_read_b64_tr_b16 v[222:223], v246 offset:256
    v_exp_f32 v56, v56
    v_exp_f32 v57, v57
    v_exp_f32 v58, v58
    v_mfma_f32_32x32x16_bf16 v[176:191], v[232:235], v[228:231], v[176:191]
    v_exp_f32 v59, v59
    v_exp_f32 v60, v60
    v_exp_f32 v61, v61
    v_exp_f32 v62, v62
    v_exp_f32 v63, v63
    v_sub_u32 v245, v245, v236
    v_sub_u32 v246, v246, v236
    v_cvt_pk_bf16_f32 v224, v56, v57
    v_cvt_pk_bf16_f32 v225, v58, v59
    v_cvt_pk_bf16_f32 v226, v60, v61
    v_cvt_pk_bf16_f32 v227, v62, v63
    v_exp_f32 v64, v64
    s_waitcnt lgkmcnt(0)
    v_mfma_f32_32x32x16_bf16 v[160:175], v[216:219], v[224:227], v[160:175]
    v_exp_f32 v65, v65
    v_exp_f32 v66, v66
    v_exp_f32 v67, v67
    v_exp_f32 v68, v68
    v_exp_f32 v69, v69
    s_waitcnt vmcnt(7)
    s_barrier
    ds_read_b128 v[212:215], v192 offset:20480
    v_exp_f32 v70, v70
    v_exp_f32 v71, v71
    v_cvt_pk_bf16_f32 v228, v64, v65
    v_cvt_pk_bf16_f32 v229, v66, v67
    v_cvt_pk_bf16_f32 v230, v68, v69
    v_cvt_pk_bf16_f32 v231, v70, v71
    s_waitcnt lgkmcnt(0)
    v_mfma_f32_32x32x16_bf16 v[56:71], v[212:215], v[204:207], 0
    v_exp_f32 v72, v72
    v_exp_f32 v73, v73
    v_exp_f32 v74, v74
    v_mfma_f32_32x32x16_bf16 v[160:175], v[220:223], v[228:231], v[160:175]
    v_exp_f32 v75, v75
    v_exp_f32 v76, v76
    v_exp_f32 v77, v77
    v_exp_f32 v78, v78
    v_exp_f32 v79, v79
    v_cvt_pk_bf16_f32 v224, v72, v73
    v_cvt_pk_bf16_f32 v225, v74, v75
    v_cvt_pk_bf16_f32 v226, v76, v77
    v_cvt_pk_bf16_f32 v227, v78, v79
    v_exp_f32 v80, v80
    s_nop 0
    v_mfma_f32_32x32x16_bf16 v[176:191], v[216:219], v[224:227], v[176:191]
    v_exp_f32 v81, v81
    v_exp_f32 v82, v82
    v_exp_f32 v83, v83
    v_exp_f32 v84, v84
    v_exp_f32 v85, v85
    v_exp_f32 v86, v86
    v_exp_f32 v87, v87
    v_cvt_pk_bf16_f32 v228, v80, v81
    v_cvt_pk_bf16_f32 v229, v82, v83
    v_cvt_pk_bf16_f32 v230, v84, v85
    v_cvt_pk_bf16_f32 v231, v86, v87
    v_mfma_f32_32x32x16_bf16 v[72:87], v[212:215], v[200:203], 0
    ds_read_b64_tr_b16 v[216:217], v245 offset:0
    ds_read_b64_tr_b16 v[218:219], v246 offset:0
    ds_read_b64_tr_b16 v[232:233], v245 offset:256
    ds_read_b64_tr_b16 v[234:235], v246 offset:256
    v_exp_f32 v56, v56
    v_exp_f32 v57, v57
    v_exp_f32 v58, v58
    v_mfma_f32_32x32x16_bf16 v[176:191], v[220:223], v[228:231], v[176:191]
    v_exp_f32 v59, v59
    v_exp_f32 v60, v60
    v_exp_f32 v61, v61
    v_exp_f32 v62, v62
    v_exp_f32 v63, v63
    v_sub_u32 v245, v245, v236
    v_sub_u32_e64 v246, v246, v236
    s_add_u32 m0, s68, 40960
    s_mov_b32 s58, 327680
    buffer_load_dwordx4 v6, s[16:19], s58 offen lds
    v_cvt_pk_bf16_f32 v224, v56, v57
    v_cvt_pk_bf16_f32 v225, v58, v59
    v_cvt_pk_bf16_f32 v226, v60, v61
    v_cvt_pk_bf16_f32 v227, v62, v63
    v_exp_f32 v64, v64
    s_waitcnt lgkmcnt(0)
    v_mfma_f32_32x32x16_bf16 v[160:175], v[216:219], v[224:227], v[160:175]
    v_exp_f32 v65, v65
    v_exp_f32 v66, v66
    v_exp_f32 v67, v67
    v_exp_f32 v68, v68
    v_exp_f32 v69, v69
    s_waitcnt vmcnt(6)
    s_barrier
    ds_read_b128 v[208:211], v192 offset:16384
    v_exp_f32 v70, v70
    v_exp_f32_e64 v71, v71
    s_add_u32 m0, m0, s53
    s_add_u32 s58, s58, s56
    buffer_load_dwordx4 v6, s[16:19], s58 offen lds
    v_cvt_pk_bf16_f32 v228, v64, v65
    v_cvt_pk_bf16_f32 v229, v66, v67
    v_cvt_pk_bf16_f32 v230, v68, v69
    v_cvt_pk_bf16_f32 v231, v70, v71
    s_waitcnt lgkmcnt(0)
    v_mfma_f32_32x32x16_bf16 v[56:71], v[208:211], v[204:207], 0
    v_exp_f32 v72, v72
    v_exp_f32 v73, v73
    v_exp_f32 v74, v74
    v_mfma_f32_32x32x16_bf16 v[160:175], v[232:235], v[228:231], v[160:175]
    v_exp_f32 v75, v75
    v_exp_f32 v76, v76
    v_exp_f32 v77, v77
    v_exp_f32 v78, v78
    v_exp_f32 v79, v79
    s_add_u32 m0, m0, s53
    s_add_u32 s58, s58, s56
    buffer_load_dwordx4 v6, s[16:19], s58 offen lds
    v_cvt_pk_bf16_f32 v224, v72, v73
    v_cvt_pk_bf16_f32 v225, v74, v75
    v_cvt_pk_bf16_f32 v226, v76, v77
    v_cvt_pk_bf16_f32 v227, v78, v79
    v_exp_f32 v80, v80
    s_nop 0
    v_mfma_f32_32x32x16_bf16 v[176:191], v[216:219], v[224:227], v[176:191]
    v_exp_f32 v81, v81
    v_exp_f32 v82, v82
    v_exp_f32 v83, v83
    v_exp_f32 v84, v84
    v_exp_f32 v85, v85
    v_exp_f32 v86, v86
    v_exp_f32 v87, v87
    s_add_u32 m0, m0, s53
    s_add_u32 s58, s58, s56
    buffer_load_dwordx4 v6, s[16:19], s58 offen lds
    v_cvt_pk_bf16_f32 v228, v80, v81
    v_cvt_pk_bf16_f32 v229, v82, v83
    v_cvt_pk_bf16_f32 v230, v84, v85
    v_cvt_pk_bf16_f32 v231, v86, v87
    v_mfma_f32_32x32x16_bf16 v[72:87], v[208:211], v[200:203], 0
    ds_read_b64_tr_b16 v[216:217], v245 offset:0
    ds_read_b64_tr_b16 v[218:219], v246 offset:0
    ds_read_b64_tr_b16 v[220:221], v245 offset:256
    ds_read_b64_tr_b16 v[222:223], v246 offset:256
    ds_read_b128 v[212:215], v192 offset:12288
    v_exp_f32 v56, v56
    v_exp_f32 v57, v57
    v_exp_f32 v58, v58
    v_mfma_f32_32x32x16_bf16 v[176:191], v[232:235], v[228:231], v[176:191]
    v_exp_f32 v59, v59
    v_exp_f32 v60, v60
    v_exp_f32 v61, v61
    v_exp_f32 v62, v62
    v_exp_f32 v63, v63
    v_sub_u32 v245, v245, v236
    v_sub_u32 v246, v246, v236
    s_add_u32 m0, m0, s53
    s_add_u32 s58, s58, s56
    buffer_load_dwordx4 v6, s[16:19], s58 offen lds
    v_cvt_pk_bf16_f32 v224, v56, v57
    v_cvt_pk_bf16_f32 v225, v58, v59
    v_cvt_pk_bf16_f32 v226, v60, v61
    v_cvt_pk_bf16_f32 v227, v62, v63
    v_exp_f32 v64, v64
    s_waitcnt lgkmcnt(0)
    v_mfma_f32_32x32x16_bf16 v[160:175], v[216:219], v[224:227], v[160:175]
    v_exp_f32 v65, v65
    v_exp_f32 v66, v66
    v_exp_f32 v67, v67
    v_exp_f32 v68, v68
    v_exp_f32 v69, v69
    v_exp_f32 v70, v70
    v_exp_f32 v71, v71
    s_add_u32 m0, m0, s53
    s_add_u32 s58, s58, s56
    buffer_load_dwordx4 v6, s[16:19], s58 offen lds
    v_cvt_pk_bf16_f32 v228, v64, v65
    v_cvt_pk_bf16_f32 v229, v66, v67
    v_cvt_pk_bf16_f32 v230, v68, v69
    v_cvt_pk_bf16_f32 v231, v70, v71
    v_mfma_f32_32x32x16_bf16 v[56:71], v[212:215], v[204:207], 0
    v_exp_f32 v72, v72
    v_exp_f32 v73, v73
    v_exp_f32 v74, v74
    v_mfma_f32_32x32x16_bf16 v[160:175], v[220:223], v[228:231], v[160:175]
    v_exp_f32 v75, v75
    v_exp_f32 v76, v76
    v_exp_f32 v77, v77
    v_exp_f32 v78, v78
    v_exp_f32 v79, v79
    s_add_u32 m0, s68, 98304
    s_mov_b32 s58, 262144
    buffer_load_dwordx4 v6, s[20:23], s58 offen lds
    v_cvt_pk_bf16_f32 v224, v72, v73
    v_cvt_pk_bf16_f32 v225, v74, v75
    v_cvt_pk_bf16_f32 v226, v76, v77
    v_cvt_pk_bf16_f32 v227, v78, v79
    v_exp_f32 v80, v80
    s_nop 0
    v_mfma_f32_32x32x16_bf16 v[176:191], v[216:219], v[224:227], v[176:191]
    v_exp_f32 v81, v81
    v_exp_f32 v82, v82
    v_exp_f32 v83, v83
    v_exp_f32 v84, v84
    v_exp_f32 v85, v85
    v_exp_f32 v86, v86
    v_exp_f32 v87, v87
    s_add_u32 m0, m0, s53
    s_add_u32 s58, s58, s56
    buffer_load_dwordx4 v6, s[20:23], s58 offen lds
    v_cvt_pk_bf16_f32 v228, v80, v81
    v_cvt_pk_bf16_f32 v229, v82, v83
    v_cvt_pk_bf16_f32 v230, v84, v85
    v_cvt_pk_bf16_f32 v231, v86, v87
    s_cmp_eq_u32 s75, 4
    s_cbranch_scc1 att_e24
    v_mfma_f32_32x32x16_bf16 v[72:87], v[212:215], v[200:203], 0
    ds_read_b64_tr_b16 v[216:217], v245 offset:0
    ds_read_b64_tr_b16 v[218:219], v246 offset:0
    ds_read_b64_tr_b16 v[232:233], v245 offset:256
    ds_read_b64_tr_b16 v[234:235], v246 offset:256
    v_exp_f32 v56, v56
    v_exp_f32 v57, v57
    v_exp_f32 v58, v58
    v_mfma_f32_32x32x16_bf16 v[176:191], v[220:223], v[228:231], v[176:191]
    v_exp_f32 v59, v59
    v_exp_f32 v60, v60
    v_exp_f32 v61, v61
    v_exp_f32 v62, v62
    v_exp_f32 v63, v63
    v_sub_u32 v245, v245, v236
    v_sub_u32 v246, v246, v236
    s_add_u32 m0, m0, s53
    s_add_u32 s58, s58, s56
    buffer_load_dwordx4 v6, s[20:23], s58 offen lds
    v_cvt_pk_bf16_f32 v224, v56, v57
    v_cvt_pk_bf16_f32 v225, v58, v59
    v_cvt_pk_bf16_f32 v226, v60, v61
    v_cvt_pk_bf16_f32 v227, v62, v63
    v_exp_f32 v64, v64
    s_waitcnt lgkmcnt(0)
    v_mfma_f32_32x32x16_bf16 v[160:175], v[216:219], v[224:227], v[160:175]
    v_exp_f32 v65, v65
    v_exp_f32 v66, v66
    v_exp_f32 v67, v67
    v_exp_f32 v68, v68
    v_exp_f32 v69, v69
    s_waitcnt vmcnt(11)
    s_barrier
    ds_read_b128 v[208:211], v192 offset:8192
    v_exp_f32 v70, v70
    v_exp_f32 v71, v71
    s_add_u32 m0, s68, 65536
    s_mov_b32 s58, 0
    buffer_load_dwordx4 v6, s[20:23], s58 offen lds
    v_cvt_pk_bf16_f32 v228, v64, v65
    v_cvt_pk_bf16_f32 v229, v66, v67
    v_cvt_pk_bf16_f32 v230, v68, v69
    v_cvt_pk_bf16_f32 v231, v70, v71
    s_waitcnt lgkmcnt(0)
    v_mfma_f32_32x32x16_bf16 v[56:71], v[208:211], v[204:207], v[104:119]
    v_exp_f32 v72, v72
    v_exp_f32 v73, v73
    v_exp_f32 v74, v74
    v_mfma_f32_32x32x16_bf16 v[160:175], v[232:235], v[228:231], v[160:175]
    v_exp_f32 v75, v75
    v_exp_f32 v76, v76
    v_exp_f32 v77, v77
    v_exp_f32 v78, v78
    v_exp_f32 v79, v79
    s_add_u32 m0, m0, s53
    s_add_u32 s58, s58, s56
    buffer_load_dwordx4 v6, s[20:23], s58 offen lds
    v_cvt_pk_bf16_f32 v224, v72, v73
    v_cvt_pk_bf16_f32 v225, v74, v75
    v_cvt_pk_bf16_f32 v226, v76, v77
    v_cvt_pk_bf16_f32 v227, v78, v79
    v_exp_f32 v80, v80
    s_nop 0
    v_mfma_f32_32x32x16_bf16 v[176:191], v[216:219], v[224:227], v[176:191]
    v_exp_f32 v81, v81
    v_exp_f32 v82, v82
    v_exp_f32 v83, v83
    v_exp_f32 v84, v84
    v_exp_f32 v85, v85
    v_exp_f32 v86, v86
    v_exp_f32 v87, v87
    s_add_u32 m0, m0, s53
    s_add_u32 s58, s58, s56
    buffer_load_dwordx4 v6, s[20:23], s58 offen lds
    v_cvt_pk_bf16_f32 v228, v80, v81
    v_cvt_pk_bf16_f32 v229, v82, v83
    v_cvt_pk_bf16_f32 v230, v84, v85
    v_cvt_pk_bf16_f32 v231, v86, v87
    s_cmp_eq_u32 s75, 5
    s_cbranch_scc1 att_e28
    v_mfma_f32_32x32x16_bf16 v[72:87], v[208:211], v[200:203], 0
    ds_read_b64_tr_b16 v[216:217], v245 offset:0
    ds_read_b64_tr_b16 v[218:219], v246 offset:0
    ds_read_b64_tr_b16 v[220:221], v245 offset:256
    ds_read_b64_tr_b16 v[222:223], v246 offset:256
    ds_read_b128 v[212:215], v192 offset:4096
    v_exp_f32 v56, v56
    v_exp_f32 v57, v57
    v_exp_f32 v58, v58
    v_mfma_f32_32x32x16_bf16 v[176:191], v[232:235], v[228:231], v[176:191]
    v_exp_f32 v59, v59
    v_exp_f32 v60, v60
    v_exp_f32 v61, v61
    v_exp_f32 v62, v62
    v_exp_f32 v63, v63
    v_sub_u32 v245, v245, v236
    v_sub_u32 v246, v246, v236
    s_add_u32 m0, m0, s53
    s_add_u32 s58, s58, s56
    buffer_load_dwordx4 v6, s[20:23], s58 offen lds
    v_cvt_pk_bf16_f32 v224, v56, v57
    v_cvt_pk_bf16_f32 v225, v58, v59
    v_cvt_pk_bf16_f32 v226, v60, v61
    v_cvt_pk_bf16_f32 v227, v62, v63
    v_exp_f32 v64, v64
    s_waitcnt lgkmcnt(0)
    v_mfma_f32_32x32x16_bf16 v[160:175], v[216:219], v[224:227], v[160:175]
    v_exp_f32 v65, v65
    v_exp_f32 v66, v66
    v_exp_f32 v67, v67
    v_exp_f32 v68, v68
    v_exp_f32 v69, v69
    v_exp_f32 v70, v70
    v_exp_f32 v71, v71
    s_add_u32 m0, m0, s53
    s_add_u32 s58, s58, s56
    buffer_load_dwordx4 v6, s[20:23], s58 offen lds
    v_cvt_pk_bf16_f32 v228, v64, v65
    v_cvt_pk_bf16_f32 v229, v66, v67
    v_cvt_pk_bf16_f32 v230, v68, v69
    v_cvt_pk_bf16_f32 v231, v70, v71
    v_mfma_f32_32x32x16_bf16 v[56:71], v[212:215], v[200:203], 0
    ds_read_b128 v[208:211], v192 offset:0
    v_exp_f32 v72, v72
    v_exp_f32 v73, v73
    v_exp_f32 v74, v74
    v_mfma_f32_32x32x16_bf16 v[160:175], v[220:223], v[228:231], v[160:175]
    v_exp_f32 v75, v75
    v_exp_f32 v76, v76
    v_exp_f32 v77, v77
    v_exp_f32 v78, v78
    v_exp_f32 v79, v79
    s_add_u32 m0, m0, s53
    s_add_u32 s58, s58, s56
    buffer_load_dwordx4 v6, s[20:23], s58 offen lds
    v_cvt_pk_bf16_f32 v224, v72, v73
    v_cvt_pk_bf16_f32 v225, v74, v75
    v_cvt_pk_bf16_f32 v226, v76, v77
    v_cvt_pk_bf16_f32 v227, v78, v79
    v_exp_f32 v80, v80
    s_waitcnt lgkmcnt(0)
    v_mfma_f32_32x32x16_bf16 v[176:191], v[216:219], v[224:227], v[176:191]
    v_exp_f32 v81, v81
    v_exp_f32 v82, v82
    v_exp_f32 v83, v83
    v_exp_f32 v84, v84
    v_exp_f32 v85, v85
    v_exp_f32 v86, v86
    v_exp_f32 v87, v87
    s_add_u32 m0, m0, s53
    s_add_u32 s58, s58, s56
    buffer_load_dwordx4 v6, s[20:23], s58 offen lds
    v_cvt_pk_bf16_f32 v228, v80, v81
    v_cvt_pk_bf16_f32 v229, v82, v83
    v_cvt_pk_bf16_f32 v230, v84, v85
    v_cvt_pk_bf16_f32 v231, v86, v87
    v_mfma_f32_32x32x16_bf16 v[72:87], v[208:211], v[200:203], v[104:119]
    ds_read_b64_tr_b16 v[216:217], v245 offset:0
    ds_read_b64_tr_b16 v[218:219], v246 offset:0
    ds_read_b64_tr_b16 v[232:233], v245 offset:256
    ds_read_b64_tr_b16 v[234:235], v246 offset:256
    v_exp_f32 v56, v56
    v_exp_f32 v57, v57
    v_exp_f32 v58, v58
    v_mfma_f32_32x32x16_bf16 v[176:191], v[220:223], v[228:231], v[176:191]
    v_exp_f32 v59, v59
    v_exp_f32 v60, v60
    v_exp_f32 v61, v61
    v_exp_f32 v62, v62
    v_exp_f32 v63, v63
    v_sub_u32 v245, v245, v236
    v_sub_u32 v246, v246, v236
    s_add_u32 m0, m0, s53
    s_add_u32 s58, s58, s56
    buffer_load_dwordx4 v6, s[20:23], s58 offen lds
    v_cvt_pk_bf16_f32 v224, v56, v57
    v_cvt_pk_bf16_f32 v225, v58, v59
    v_cvt_pk_bf16_f32 v226, v60, v61
    v_cvt_pk_bf16_f32 v227, v62, v63
    v_exp_f32 v64, v64
    s_waitcnt lgkmcnt(0)
    v_mfma_f32_32x32x16_bf16 v[176:191], v[216:219], v[224:227], v[176:191]
    v_exp_f32 v65, v65
    v_exp_f32 v66, v66
    v_exp_f32 v67, v67
    v_exp_f32 v68, v68
    v_exp_f32 v69, v69
    v_exp_f32 v70, v70
    v_exp_f32_e64 v71, v71
    v_cvt_pk_bf16_f32 v228, v64, v65
    v_cvt_pk_bf16_f32 v229, v66, v67
    v_cvt_pk_bf16_f32 v230, v68, v69
    v_cvt_pk_bf16_f32 v231, v70, v71
    ds_read_b64_tr_b16 v[216:217], v245 offset:0
    ds_read_b64_tr_b16 v[218:219], v246 offset:0
    ds_read_b64_tr_b16 v[220:221], v245 offset:256
    ds_read_b64_tr_b16 v[222:223], v246 offset:256
    v_exp_f32 v72, v72
    v_mfma_f32_32x32x16_bf16 v[176:191], v[232:235], v[228:231], v[176:191]
    v_exp_f32 v73, v73
    v_exp_f32 v74, v74
    v_exp_f32 v75, v75
    v_exp_f32 v76, v76
    v_exp_f32 v77, v77
    v_exp_f32 v78, v78
    v_exp_f32 v79, v79
    v_cvt_pk_bf16_f32 v224, v72, v73
    v_cvt_pk_bf16_f32 v225, v74, v75
    v_cvt_pk_bf16_f32 v226, v76, v77
    v_cvt_pk_bf16_f32 v227, v78, v79
    v_exp_f32 v80, v80
    s_waitcnt lgkmcnt(0)
    v_mfma_f32_32x32x16_bf16 v[176:191], v[216:219], v[224:227], v[176:191]
    v_exp_f32 v81, v81
    v_exp_f32 v82, v82
    v_exp_f32 v83, v83
    v_exp_f32 v84, v84
    v_exp_f32 v85, v85
    v_exp_f32 v86, v86
    v_exp_f32 v87, v87
    v_cvt_pk_bf16_f32 v228, v80, v81
    v_cvt_pk_bf16_f32 v229, v82, v83
    v_cvt_pk_bf16_f32 v230, v84, v85
    v_cvt_pk_bf16_f32 v231, v86, v87
    s_nop 1
    v_mfma_f32_32x32x16_bf16 v[176:191], v[220:223], v[228:231], v[176:191]
att_rb:
    v_lshrrev_b32 v19, 5, v0
    v_lshl_add_u32 v19, v19, 8, v3
    s_lshr_b32 s61, s44, 1
    s_mul_i32 s61, s61, 692216
    v_subrev_u32 v19, s61, v19
    s_lshl_b32 s61, s46, 10
    s_add_u32 s61, s61, 17408
    s_add_u32 s60, s61, 692224
    v_pk_mul_f32 v[120:121], v[160:161], 0
    v_pk_fma_f32 v[120:121], v[162:163], 0, v[120:121]
    v_pk_fma_f32 v[120:121], v[164:165], 0, v[120:121]
    v_pk_fma_f32 v[120:121], v[166:167], 0, v[120:121]
    v_pk_fma_f32 v[120:121], v[176:177], 0, v[120:121]
    v_pk_fma_f32 v[120:121], v[178:179], 0, v[120:121]
    v_pk_fma_f32 v[120:121], v[180:181], 0, v[120:121]
    v_pk_fma_f32 v[120:121], v[182:183], 0, v[120:121]
    v_add_f32 v120, v120, v168
    v_add_f32 v121, v121, v184
    v_subrev_u32 v120, 662700032, v120
    v_subrev_u32 v121, 662700032, v121
    v_max_u32 v120, v120, v121
    v_cmp_lt_u32 vcc, 1073741824, v120
    s_cbranch_vccnz att_x
att_xb:
    v_rcp_f32 v120, v168
    s_nop 4
    v_rcp_f32_e64 v121, v184
    s_nop 0
    v_pk_mul_f32 v[160:161], v[160:161], v[120:121] op_sel:[0,0] op_sel_hi:[1,0]
    v_pk_mul_f32 v[162:163], v[162:163], v[120:121] op_sel:[0,0] op_sel_hi:[1,0]
    v_pk_mul_f32 v[164:165], v[164:165], v[120:121] op_sel:[0,0] op_sel_hi:[1,0]
    v_pk_mul_f32 v[166:167], v[166:167], v[120:121] op_sel:[0,0] op_sel_hi:[1,0]
    v_cvt_pk_bf16_f32 v224, v160, v161
    v_cvt_pk_bf16_f32 v225, v162, v163
    v_cvt_pk_bf16_f32 v226, v164, v165
    v_cvt_pk_bf16_f32 v227, v166, v167
    v_pk_mul_f32 v[176:177], v[176:177], v[120:121] op_sel:[0,1] op_sel_hi:[1,1]
    v_pk_mul_f32 v[178:179], v[178:179], v[120:121] op_sel:[0,1] op_sel_hi:[1,1]
    v_pk_mul_f32 v[180:181], v[180:181], v[120:121] op_sel:[0,1] op_sel_hi:[1,1]
    v_pk_mul_f32 v[182:183], v[182:183], v[120:121] op_sel:[0,1] op_sel_hi:[1,1]
    v_cvt_pk_bf16_f32 v228, v176, v177
    v_cvt_pk_bf16_f32 v229, v178, v179
    v_cvt_pk_bf16_f32 v230, v180, v181
    v_cvt_pk_bf16_f32 v231, v182, v183
    s_cmp_eq_u32 s51, 0
    s_cbranch_scc1 sc_18
    buffer_store_dwordx2 v[224:225], v19, s[4:7], s60 offen offset:0
    buffer_store_dwordx2 v[226:227], v19, s[4:7], s60 offen offset:256
    buffer_store_dwordx2 v[228:229], v19, s[4:7], s61 offen offset:0
    buffer_store_dwordx2 v[230:231], v19, s[4:7], s61 offen offset:256
scb_19:
    v_add_u32 v144, 17408, v1
    v_add_u32 v120, 65536, v8
    v_add_u32 v121, 65536, v9
    v_add_u32 v122, 65536, v10
    v_add_u32 v123, 65536, v11
    s_waitcnt vmcnt(4)
    s_barrier
    s_add_u32 m0, s68, 110592
    s_mov_b32 s58, 360448
    buffer_load_dwordx4 v6, s[20:23], s58 offen lds
    ds_read_b64_tr_b16 a[0:1], v8 offset:0
    ds_read_b64_tr_b16 a[2:3], v8 offset:2048
    ds_read_b64_tr_b16 a[4:5], v9 offset:0
    ds_read_b64_tr_b16 a[6:7], v9 offset:2048
    ds_read_b64_tr_b16 a[8:9], v10 offset:0
    ds_read_b64_tr_b16 a[10:11], v10 offset:2048
    ds_read_b64_tr_b16 a[12:13], v11 offset:0
    ds_read_b64_tr_b16 a[14:15], v11 offset:2048
    ds_read_b64_tr_b16 a[16:17], v8 offset:4096
    ds_read_b64_tr_b16 a[18:19], v8 offset:6144
    ds_read_b64_tr_b16 a[20:21], v9 offset:4096
    ds_read_b64_tr_b16 a[22:23], v9 offset:6144
    s_add_u32 m0, m0, s53
    s_add_u32 s58, s58, s56
    buffer_load_dwordx4 v6, s[20:23], s58 offen lds
    ds_read_b64_tr_b16 a[24:25], v10 offset:4096
    ds_read_b64_tr_b16 a[26:27], v10 offset:6144
    ds_read_b64_tr_b16 a[28:29], v11 offset:4096
    ds_read_b64_tr_b16 a[30:31], v11 offset:6144
    ds_read_b64_tr_b16 a[32:33], v8 offset:8192
    ds_read_b64_tr_b16 a[34:35], v8 offset:10240
    ds_read_b64_tr_b16 a[36:37], v9 offset:8192
    ds_read_b64_tr_b16 a[38:39], v9 offset:10240
    ds_read_b64_tr_b16 a[40:41], v10 offset:8192
    ds_read_b64_tr_b16 a[42:43], v10 offset:10240
    ds_read_b64_tr_b16 a[44:45], v11 offset:8192
    ds_read_b64_tr_b16 a[46:47], v11 offset:10240
    s_add_u32 m0, m0, s53
    s_add_u32 s58, s58, s56
    buffer_load_dwordx4 v6, s[20:23], s58 offen lds
    ds_read_b64_tr_b16 a[48:49], v8 offset:12288
    ds_read_b64_tr_b16 a[50:51], v8 offset:14336
    ds_read_b64_tr_b16 a[52:53], v9 offset:12288
    ds_read_b64_tr_b16 a[54:55], v9 offset:14336
    ds_read_b64_tr_b16 a[56:57], v10 offset:12288
    ds_read_b64_tr_b16 a[58:59], v10 offset:14336
    ds_read_b64_tr_b16 a[60:61], v11 offset:12288
    ds_read_b64_tr_b16 a[62:63], v11 offset:14336
    ds_read_b64_tr_b16 a[64:65], v8 offset:16384
    ds_read_b64_tr_b16 a[66:67], v8 offset:18432
    ds_read_b64_tr_b16 a[68:69], v9 offset:16384
    ds_read_b64_tr_b16 a[70:71], v9 offset:18432
    ds_read_b64_tr_b16 a[72:73], v10 offset:16384
    ds_read_b64_tr_b16 a[74:75], v10 offset:18432
    ds_read_b64_tr_b16 a[76:77], v11 offset:16384
    ds_read_b64_tr_b16 a[78:79], v11 offset:18432
    ds_read_b64_tr_b16 a[80:81], v8 offset:20480
    ds_read_b64_tr_b16 a[82:83], v8 offset:22528
    ds_read_b64_tr_b16 a[84:85], v9 offset:20480
    ds_read_b64_tr_b16 a[86:87], v9 offset:22528
    ds_read_b64_tr_b16 a[88:89], v10 offset:20480
    ds_read_b64_tr_b16 a[90:91], v10 offset:22528
    ds_read_b64_tr_b16 a[92:93], v11 offset:20480
    ds_read_b64_tr_b16 a[94:95], v11 offset:22528
    s_add_u32 s64, s64, 1
    v_mov_b32 v21, s65
    v_mov_b32 v20, s64
    s_mov_b64 exec, 1
    s_waitcnt vmcnt(3)
    s_cmp_eq_u32 s51, 0
    s_cbranch_scc1 sc_20
    buffer_store_dwordx2 v[20:21], off, s[8:11], s71
scb_21:
    s_mov_b64 exec, -1
    s_add_u32 m0, m0, s53
    s_add_u32 s58, s58, s56
    buffer_load_dwordx4 v6, s[20:23], s58 offen lds
    ds_read_b64_tr_b16 a[96:97], v8 offset:24576
    ds_read_b64_tr_b16 a[98:99], v8 offset:26624
    ds_read_b64_tr_b16 a[100:101], v9 offset:24576
    ds_read_b64_tr_b16 a[102:103], v9 offset:26624
    ds_read_b64_tr_b16 a[104:105], v10 offset:24576
    ds_read_b64_tr_b16 a[106:107], v10 offset:26624
    s_add_u32 m0, m0, s53
    s_add_u32 s58, s58, s56
    buffer_load_dwordx4 v6, s[20:23], s58 offen lds
    ds_read_b64_tr_b16 a[108:109], v11 offset:24576
    ds_read_b64_tr_b16 a[110:111], v11 offset:26624
    ds_read_b64_tr_b16 a[112:113], v8 offset:28672
    ds_read_b64_tr_b16 a[114:115], v8 offset:30720
    ds_read_b64_tr_b16 a[116:117], v9 offset:28672
    ds_read_b64_tr_b16 a[118:119], v9 offset:30720
    s_add_u32 m0, s87, 131072
    s_add_u32 s58, s88, 1376256
    buffer_load_dwordx4 v248, s[28:31], s58 offen offset:0 lds
    ds_read_b64_tr_b16 a[120:121], v10 offset:28672
    ds_read_b64_tr_b16 a[122:123], v10 offset:30720
    ds_read_b64_tr_b16 a[124:125], v11 offset:28672
    ds_read_b64_tr_b16 a[126:127], v11 offset:30720
    ds_read_b64_tr_b16 a[128:129], v8 offset:32768
    ds_read_b64_tr_b16 a[130:131], v8 offset:34816
    buffer_load_dwordx4 v249, s[28:31], s58 offen offset:1024 lds
    ds_read_b64_tr_b16 a[132:133], v9 offset:32768
    ds_read_b64_tr_b16 a[134:135], v9 offset:34816
    ds_read_b64_tr_b16 a[136:137], v10 offset:32768
    ds_read_b64_tr_b16 a[138:139], v10 offset:34816
    ds_read_b64_tr_b16 a[140:141], v11 offset:32768
    ds_read_b64_tr_b16 a[142:143], v11 offset:34816
    buffer_load_dwordx4 v250, s[28:31], s58 offen offset:2048 lds
    ds_read_b64_tr_b16 a[144:145], v8 offset:36864
    ds_read_b64_tr_b16 a[146:147], v8 offset:38912
    ds_read_b64_tr_b16 a[148:149], v9 offset:36864
    ds_read_b64_tr_b16 a[150:151], v9 offset:38912
    ds_read_b64_tr_b16 a[152:153], v10 offset:36864
    ds_read_b64_tr_b16 a[154:155], v10 offset:38912
    ds_read_b64_tr_b16 a[156:157], v11 offset:36864
    ds_read_b64_tr_b16 a[158:159], v11 offset:38912
    s_mov_b32 s59, 0x8000
poll_22:
    s_nop 0
    buffer_load_dwordx2 v[20:21], v16, s[8:11], 0 offen sc1
    s_sub_u32 s59, s59, 1
    s_cbranch_scc1 bail
    s_waitcnt vmcnt(0)
    v_cmp_ne_u64 vcc, s[64:65], v[20:21]
    s_cbranch_vccnz poll_22
    buffer_load_dwordx4 v[56:59], v144, s[4:7], 0 offen offset:0 sc1
    ds_read_b64_tr_b16 a[160:161], v8 offset:40960
    ds_read_b64_tr_b16 a[162:163], v8 offset:43008
    ds_read_b64_tr_b16 a[164:165], v9 offset:40960
    ds_read_b64_tr_b16 a[166:167], v9 offset:43008
    buffer_load_dwordx4 v[60:63], v144, s[4:7], 0 offen offset:1024 sc1
    ds_read_b64_tr_b16 a[168:169], v10 offset:40960
    ds_read_b64_tr_b16 a[170:171], v10 offset:43008
    ds_read_b64_tr_b16 a[172:173], v11 offset:40960
    ds_read_b64_tr_b16 a[174:175], v11 offset:43008
    buffer_load_dwordx4 v[64:67], v144, s[4:7], 0 offen offset:2048 sc1
    ds_read_b64_tr_b16 a[176:177], v8 offset:45056
    ds_read_b64_tr_b16 a[178:179], v8 offset:47104
    ds_read_b64_tr_b16 a[180:181], v9 offset:45056
    ds_read_b64_tr_b16 a[182:183], v9 offset:47104
    buffer_load_dwordx4 v[68:71], v144, s[4:7], 0 offen offset:3072 sc1
    ds_read_b64_tr_b16 a[184:185], v10 offset:45056
    ds_read_b64_tr_b16 a[186:187], v10 offset:47104
    ds_read_b64_tr_b16 a[188:189], v11 offset:45056
    ds_read_b64_tr_b16 a[190:191], v11 offset:47104
    buffer_load_dwordx4 v[72:75], v144, s[4:7], s53 offen offset:0 sc1
    ds_read_b64_tr_b16 a[192:193], v8 offset:49152
    ds_read_b64_tr_b16 a[194:195], v8 offset:51200
    ds_read_b64_tr_b16 a[196:197], v9 offset:49152
    ds_read_b64_tr_b16 a[198:199], v9 offset:51200
    buffer_load_dwordx4 v[76:79], v144, s[4:7], s53 offen offset:1024 sc1
    ds_read_b64_tr_b16 a[200:201], v10 offset:49152
    ds_read_b64_tr_b16 a[202:203], v10 offset:51200
    ds_read_b64_tr_b16 a[204:205], v11 offset:49152
    ds_read_b64_tr_b16 a[206:207], v11 offset:51200
    buffer_load_dwordx4 v[80:83], v144, s[4:7], s53 offen offset:2048 sc1
    ds_read_b64_tr_b16 a[208:209], v8 offset:53248
    ds_read_b64_tr_b16 a[210:211], v8 offset:55296
    ds_read_b64_tr_b16 a[212:213], v9 offset:53248
    ds_read_b64_tr_b16 a[214:215], v9 offset:55296
    buffer_load_dwordx4 v[84:87], v144, s[4:7], s53 offen offset:3072 sc1
    ds_read_b64_tr_b16 a[216:217], v10 offset:53248
    ds_read_b64_tr_b16 a[218:219], v10 offset:55296
    ds_read_b64_tr_b16 a[220:221], v11 offset:53248
    ds_read_b64_tr_b16 a[222:223], v11 offset:55296
    buffer_load_dwordx4 v[88:91], v144, s[4:7], s54 offen offset:0 sc1
    ds_read_b64_tr_b16 a[224:225], v8 offset:57344
    ds_read_b64_tr_b16 a[226:227], v8 offset:59392
    ds_read_b64_tr_b16 a[228:229], v9 offset:57344
    ds_read_b64_tr_b16 a[230:231], v9 offset:59392
    buffer_load_dwordx4 v[92:95], v144, s[4:7], s54 offen offset:1024 sc1
    ds_read_b64_tr_b16 a[232:233], v10 offset:57344
    ds_read_b64_tr_b16 a[234:235], v10 offset:59392
    ds_read_b64_tr_b16 a[236:237], v11 offset:57344
    ds_read_b64_tr_b16 a[238:239], v11 offset:59392
    buffer_load_dwordx4 v[96:99], v144, s[4:7], s54 offen offset:2048 sc1
    ds_read_b64_tr_b16 a[240:241], v8 offset:61440
    ds_read_b64_tr_b16 a[242:243], v8 offset:63488
    ds_read_b64_tr_b16 a[244:245], v9 offset:61440
    ds_read_b64_tr_b16 a[246:247], v9 offset:63488
    buffer_load_dwordx4 v[100:103], v144, s[4:7], s54 offen offset:3072 sc1
    ds_read_b64_tr_b16 a[248:249], v10 offset:61440
    ds_read_b64_tr_b16 a[250:251], v10 offset:63488
    ds_read_b64_tr_b16 a[252:253], v11 offset:61440
    ds_read_b64_tr_b16 a[254:255], v11 offset:63488
    s_waitcnt lgkmcnt(0)
    s_waitcnt vmcnt(11)
    v_mfma_f32_16x16x32_bf16 v[24:27], a[0:3], v[56:59], v[24:27]
    buffer_load_dwordx4 v[104:107], v144, s[4:7], s55 offen offset:0 sc1
    v_mfma_f32_16x16x32_bf16 v[28:31], a[4:7], v[56:59], v[28:31]
    ds_read_b64_tr_b16 a[0:1], v120 offset:0
    ds_read_b64_tr_b16 a[2:3], v120 offset:2048
    v_mfma_f32_16x16x32_bf16 v[32:35], a[8:11], v[56:59], v[32:35]
    ds_read_b64_tr_b16 a[4:5], v121 offset:0
    ds_read_b64_tr_b16 a[6:7], v121 offset:2048
    v_mfma_f32_16x16x32_bf16 v[36:39], a[12:15], v[56:59], v[36:39]
    ds_read_b64_tr_b16 a[8:9], v122 offset:0
    ds_read_b64_tr_b16 a[10:11], v122 offset:2048
    s_waitcnt vmcnt(11)
    v_mfma_f32_16x16x32_bf16 v[24:27], a[16:19], v[60:63], v[24:27]
    buffer_load_dwordx4 v[108:111], v144, s[4:7], s55 offen offset:1024 sc1
    ds_read_b64_tr_b16 a[12:13], v123 offset:0
    ds_read_b64_tr_b16 a[14:15], v123 offset:2048
    v_mfma_f32_16x16x32_bf16 v[28:31], a[20:23], v[60:63], v[28:31]
    ds_read_b64_tr_b16 a[16:17], v120 offset:4096
    ds_read_b64_tr_b16 a[18:19], v120 offset:6144
    v_mfma_f32_16x16x32_bf16 v[32:35], a[24:27], v[60:63], v[32:35]
    v_mfma_f32_16x16x32_bf16 v[36:39], a[28:31], v[60:63], v[36:39]
    ds_read_b64_tr_b16 a[20:21], v121 offset:4096
    ds_read_b64_tr_b16 a[22:23], v121 offset:6144
    s_waitcnt vmcnt(11)
    v_mfma_f32_16x16x32_bf16 v[24:27], a[32:35], v[64:67], v[24:27]
    buffer_load_dwordx4 v[112:115], v144, s[4:7], s55 offen offset:2048 sc1
    ds_read_b64_tr_b16 a[24:25], v122 offset:4096
    ds_read_b64_tr_b16 a[26:27], v122 offset:6144
    v_mfma_f32_16x16x32_bf16 v[28:31], a[36:39], v[64:67], v[28:31]
    v_mfma_f32_16x16x32_bf16 v[32:35], a[40:43], v[64:67], v[32:35]
    ds_read_b64_tr_b16 a[28:29], v123 offset:4096
    ds_read_b64_tr_b16 a[30:31], v123 offset:6144
    v_mfma_f32_16x16x32_bf16 v[36:39], a[44:47], v[64:67], v[36:39]
    ds_read_b64_tr_b16 a[32:33], v120 offset:8192
    ds_read_b64_tr_b16 a[34:35], v120 offset:10240
    s_waitcnt vmcnt(11)
    v_mfma_f32_16x16x32_bf16 v[24:27], a[48:51], v[68:71], v[24:27]
    buffer_load_dwordx4 v[116:119], v144, s[4:7], s55 offen offset:3072 sc1
    v_mfma_f32_16x16x32_bf16 v[28:31], a[52:55], v[68:71], v[28:31]
    ds_read_b64_tr_b16 a[36:37], v121 offset:8192
    ds_read_b64_tr_b16 a[38:39], v121 offset:10240
    v_mfma_f32_16x16x32_bf16 v[32:35], a[56:59], v[68:71], v[32:35]
    ds_read_b64_tr_b16 a[40:41], v122 offset:8192
    ds_read_b64_tr_b16 a[42:43], v122 offset:10240
    v_mfma_f32_16x16x32_bf16 v[36:39], a[60:63], v[68:71], v[36:39]
    s_waitcnt vmcnt(11)
    v_mfma_f32_16x16x32_bf16 v[24:27], a[64:67], v[72:75], v[24:27]
    buffer_load_dwordx4 v251, s[28:31], s58 offen offset:3072 lds
    ds_read_b64_tr_b16 a[44:45], v123 offset:8192
    ds_read_b64_tr_b16 a[46:47], v123 offset:10240
    v_mfma_f32_16x16x32_bf16 v[28:31], a[68:71], v[72:75], v[28:31]
    ds_read_b64_tr_b16 a[48:49], v120 offset:12288
    ds_read_b64_tr_b16 a[50:51], v120 offset:14336
    v_mfma_f32_16x16x32_bf16 v[32:35], a[72:75], v[72:75], v[32:35]
    ds_read_b64_tr_b16 a[52:53], v121 offset:12288
    ds_read_b64_tr_b16 a[54:55], v121 offset:14336
    v_mfma_f32_16x16x32_bf16 v[36:39], a[76:79], v[72:75], v[36:39]
    s_waitcnt vmcnt(11)
    v_mfma_f32_16x16x32_bf16 v[24:27], a[80:83], v[76:79], v[24:27]
    s_add_u32 m0, m0, s53
    s_add_u32 s58, s58, s53
    buffer_load_dwordx4 v252, s[28:31], s58 offen offset:0 lds
    ds_read_b64_tr_b16 a[56:57], v122 offset:12288
    ds_read_b64_tr_b16 a[58:59], v122 offset:14336
    v_mfma_f32_16x16x32_bf16 v[28:31], a[84:87], v[76:79], v[28:31]
    ds_read_b64_tr_b16 a[60:61], v123 offset:12288
    ds_read_b64_tr_b16 a[62:63], v123 offset:14336
    v_mfma_f32_16x16x32_bf16 v[32:35], a[88:91], v[76:79], v[32:35]
    v_mfma_f32_16x16x32_bf16 v[36:39], a[92:95], v[76:79], v[36:39]
    ds_read_b64_tr_b16 a[64:65], v120 offset:16384
    ds_read_b64_tr_b16 a[66:67], v120 offset:18432
    s_waitcnt vmcnt(11)
    v_mfma_f32_16x16x32_bf16 v[24:27], a[96:99], v[80:83], v[24:27]
    buffer_load_dwordx4 v253, s[28:31], s58 offen offset:1024 lds
    ds_read_b64_tr_b16 a[68:69], v121 offset:16384
    ds_read_b64_tr_b16 a[70:71], v121 offset:18432
    v_mfma_f32_16x16x32_bf16 v[28:31], a[100:103], v[80:83], v[28:31]
    v_mfma_f32_16x16x32_bf16 v[32:35], a[104:107], v[80:83], v[32:35]
    ds_read_b64_tr_b16 a[72:73], v122 offset:16384
    ds_read_b64_tr_b16 a[74:75], v122 offset:18432
    v_mfma_f32_16x16x32_bf16 v[36:39], a[108:111], v[80:83], v[36:39]
    ds_read_b64_tr_b16 a[76:77], v123 offset:16384
    ds_read_b64_tr_b16 a[78:79], v123 offset:18432
    s_waitcnt vmcnt(11)
    v_mfma_f32_16x16x32_bf16 v[24:27], a[112:115], v[84:87], v[24:27]
    buffer_load_dwordx4 v254, s[28:31], s58 offen offset:2048 lds
    v_mfma_f32_16x16x32_bf16 v[28:31], a[116:119], v[84:87], v[28:31]
    ds_read_b64_tr_b16 a[80:81], v120 offset:20480
    ds_read_b64_tr_b16 a[82:83], v120 offset:22528
    v_mfma_f32_16x16x32_bf16 v[32:35], a[120:123], v[84:87], v[32:35]
    ds_read_b64_tr_b16 a[84:85], v121 offset:20480
    ds_read_b64_tr_b16 a[86:87], v121 offset:22528
    v_mfma_f32_16x16x32_bf16 v[36:39], a[124:127], v[84:87], v[36:39]
    s_barrier
    s_waitcnt vmcnt(11)
    v_mfma_f32_16x16x32_bf16 v[24:27], a[128:131], v[88:91], v[24:27]
    s_add_u32 m0, s68, 0
    s_mov_b32 s58, 0
    buffer_load_dwordx4 v6, s[24:27], s58 offen lds
    ds_read_b64_tr_b16 a[88:89], v122 offset:20480
    ds_read_b64_tr_b16 a[90:91], v122 offset:22528
    v_mfma_f32_16x16x32_bf16 v[28:31], a[132:135], v[88:91], v[28:31]
    ds_read_b64_tr_b16 a[92:93], v123 offset:20480
    ds_read_b64_tr_b16 a[94:95], v123 offset:22528
    v_mfma_f32_16x16x32_bf16 v[32:35], a[136:139], v[88:91], v[32:35]
    ds_read_b64_tr_b16 a[96:97], v120 offset:24576
    ds_read_b64_tr_b16 a[98:99], v120 offset:26624
    v_mfma_f32_16x16x32_bf16 v[36:39], a[140:143], v[88:91], v[36:39]
    s_waitcnt vmcnt(11)
    v_mfma_f32_16x16x32_bf16 v[24:27], a[144:147], v[92:95], v[24:27]
    s_add_u32 m0, m0, s53
    s_add_u32 s58, s58, s56
    buffer_load_dwordx4 v6, s[24:27], s58 offen lds
    ds_read_b64_tr_b16 a[100:101], v121 offset:24576
    ds_read_b64_tr_b16 a[102:103], v121 offset:26624
    v_mfma_f32_16x16x32_bf16 v[28:31], a[148:151], v[92:95], v[28:31]
    ds_read_b64_tr_b16 a[104:105], v122 offset:24576
    ds_read_b64_tr_b16 a[106:107], v122 offset:26624
    v_mfma_f32_16x16x32_bf16 v[32:35], a[152:155], v[92:95], v[32:35]
    v_mfma_f32_16x16x32_bf16 v[36:39], a[156:159], v[92:95], v[36:39]
    ds_read_b64_tr_b16 a[108:109], v123 offset:24576
    ds_read_b64_tr_b16 a[110:111], v123 offset:26624
    s_waitcnt vmcnt(11)
    v_mfma_f32_16x16x32_bf16 v[24:27], a[160:163], v[96:99], v[24:27]
    s_add_u32 m0, m0, s53
    s_add_u32 s58, s58, s56
    buffer_load_dwordx4 v6, s[24:27], s58 offen lds
    ds_read_b64_tr_b16 a[112:113], v120 offset:28672
    ds_read_b64_tr_b16 a[114:115], v120 offset:30720
    v_mfma_f32_16x16x32_bf16 v[28:31], a[164:167], v[96:99], v[28:31]
    v_mfma_f32_16x16x32_bf16 v[32:35], a[168:171], v[96:99], v[32:35]
    ds_read_b64_tr_b16 a[116:117], v121 offset:28672
    ds_read_b64_tr_b16 a[118:119], v121 offset:30720
    v_mfma_f32_16x16x32_bf16 v[36:39], a[172:175], v[96:99], v[36:39]
    ds_read_b64_tr_b16 a[120:121], v122 offset:28672
    ds_read_b64_tr_b16 a[122:123], v122 offset:30720
    s_waitcnt vmcnt(11)
    v_mfma_f32_16x16x32_bf16 v[24:27], a[176:179], v[100:103], v[24:27]
    s_add_u32 m0, m0, s53
    s_add_u32 s58, s58, s56
    buffer_load_dwordx4 v6, s[24:27], s58 offen lds
    v_mfma_f32_16x16x32_bf16 v[28:31], a[180:183], v[100:103], v[28:31]
    ds_read_b64_tr_b16 a[124:125], v123 offset:28672
    ds_read_b64_tr_b16 a[126:127], v123 offset:30720
    v_mfma_f32_16x16x32_bf16 v[32:35], a[184:187], v[100:103], v[32:35]
    ds_read_b64_tr_b16 a[128:129], v120 offset:32768
    ds_read_b64_tr_b16 a[130:131], v120 offset:34816
    v_mfma_f32_16x16x32_bf16 v[36:39], a[188:191], v[100:103], v[36:39]
    s_waitcnt vmcnt(11)
    v_mfma_f32_16x16x32_bf16 v[24:27], a[192:195], v[104:107], v[24:27]
    s_add_u32 m0, m0, s53
    s_add_u32 s58, s58, s56
    buffer_load_dwordx4 v6, s[24:27], s58 offen lds
    ds_read_b64_tr_b16 a[132:133], v121 offset:32768
    ds_read_b64_tr_b16 a[134:135], v121 offset:34816
    v_mfma_f32_16x16x32_bf16 v[28:31], a[196:199], v[104:107], v[28:31]
    ds_read_b64_tr_b16 a[136:137], v122 offset:32768
    ds_read_b64_tr_b16 a[138:139], v122 offset:34816
    v_mfma_f32_16x16x32_bf16 v[32:35], a[200:203], v[104:107], v[32:35]
    ds_read_b64_tr_b16 a[140:141], v123 offset:32768
    ds_read_b64_tr_b16 a[142:143], v123 offset:34816
    v_mfma_f32_16x16x32_bf16 v[36:39], a[204:207], v[104:107], v[36:39]
    s_waitcnt vmcnt(11)
    v_mfma_f32_16x16x32_bf16 v[24:27], a[208:211], v[108:111], v[24:27]
    s_add_u32 m0, m0, s53
    s_add_u32 s58, s58, s56
    buffer_load_dwordx4 v6, s[24:27], s58 offen lds
    ds_read_b64_tr_b16 a[144:145], v120 offset:36864
    ds_read_b64_tr_b16 a[146:147], v120 offset:38912
    v_mfma_f32_16x16x32_bf16 v[28:31], a[212:215], v[108:111], v[28:31]
    ds_read_b64_tr_b16 a[148:149], v121 offset:36864
    ds_read_b64_tr_b16 a[150:151], v121 offset:38912
    v_mfma_f32_16x16x32_bf16 v[32:35], a[216:219], v[108:111], v[32:35]
    v_mfma_f32_16x16x32_bf16 v[36:39], a[220:223], v[108:111], v[36:39]
    ds_read_b64_tr_b16 a[152:153], v122 offset:36864
    ds_read_b64_tr_b16 a[154:155], v122 offset:38912
    s_waitcnt vmcnt(11)
    v_mfma_f32_16x16x32_bf16 v[24:27], a[224:227], v[112:115], v[24:27]
    s_add_u32 m0, m0, s53
    s_add_u32 s58, s58, s56
    buffer_load_dwordx4 v6, s[24:27], s58 offen lds
    ds_read_b64_tr_b16 a[156:157], v123 offset:36864
    ds_read_b64_tr_b16 a[158:159], v123 offset:38912
    v_mfma_f32_16x16x32_bf16 v[28:31], a[228:231], v[112:115], v[28:31]
    v_mfma_f32_16x16x32_bf16 v[32:35], a[232:235], v[112:115], v[32:35]
    ds_read_b64_tr_b16 a[160:161], v120 offset:40960
    ds_read_b64_tr_b16 a[162:163], v120 offset:43008
    v_mfma_f32_16x16x32_bf16 v[36:39], a[236:239], v[112:115], v[36:39]
    ds_read_b64_tr_b16 a[164:165], v121 offset:40960
    ds_read_b64_tr_b16 a[166:167], v121 offset:43008
    s_waitcnt vmcnt(11)
    v_mfma_f32_16x16x32_bf16 v[24:27], a[240:243], v[116:119], v[24:27]
    s_add_u32 m0, m0, s53
    s_add_u32 s58, s58, s56
    buffer_load_dwordx4 v6, s[24:27], s58 offen lds
    v_mfma_f32_16x16x32_bf16 v[28:31], a[244:247], v[116:119], v[28:31]
    ds_read_b64_tr_b16 a[168:169], v122 offset:40960
    ds_read_b64_tr_b16 a[170:171], v122 offset:43008
    v_mfma_f32_16x16x32_bf16 v[32:35], a[248:251], v[116:119], v[32:35]
    ds_read_b64_tr_b16 a[172:173], v123 offset:40960
    ds_read_b64_tr_b16 a[174:175], v123 offset:43008
    v_mfma_f32_16x16x32_bf16 v[36:39], a[252:255], v[116:119], v[36:39]
    s_mov_b32 s60, 0
    s_mov_b32 s61, 16384
    v_cvt_pk_bf16_f32 v128, v24, v25
    v_cvt_pk_bf16_f32 v129, v26, v27
    v_cvt_pk_bf16_f32 v130, v28, v29
    v_cvt_pk_bf16_f32 v131, v30, v31
    v_cvt_pk_bf16_f32 v132, v32, v33
    s_nop 0
    v_cvt_pk_bf16_f32 v133, v34, v35
    v_cvt_pk_bf16_f32 v134, v36, v37
    v_cvt_pk_bf16_f32 v135, v38, v39
    s_cmp_eq_u32 s51, 0
    s_cbranch_scc1 sc_23
    buffer_store_dwordx4 v[128:131], v2, s[4:7], s60 offen offset:0
    buffer_store_dwordx4 v[132:135], v2, s[4:7], s60 offen offset:1024
scb_24:
    v_pk_add_f32 v[136:137], v[24:25], v[26:27]
    v_pk_mul_f32 v[138:139], v[24:25], v[24:25]
    v_pk_fma_f32 v[138:139], v[26:27], v[26:27], v[138:139]
    v_pk_add_f32 v[136:137], v[136:137], v[28:29]
    v_pk_fma_f32 v[138:139], v[28:29], v[28:29], v[138:139]
    v_pk_add_f32 v[136:137], v[136:137], v[30:31]
    v_pk_fma_f32 v[138:139], v[30:31], v[30:31], v[138:139]
    v_pk_add_f32 v[136:137], v[136:137], v[32:33]
    v_pk_fma_f32 v[138:139], v[32:33], v[32:33], v[138:139]
    v_pk_add_f32 v[136:137], v[136:137], v[34:35]
    v_pk_fma_f32 v[138:139], v[34:35], v[34:35], v[138:139]
    v_pk_add_f32 v[136:137], v[136:137], v[36:37]
    v_pk_fma_f32 v[138:139], v[36:37], v[36:37], v[138:139]
    v_pk_add_f32 v[136:137], v[136:137], v[38:39]
    v_pk_fma_f32 v[138:139], v[38:39], v[38:39], v[138:139]
    v_add_f32 v136, v136, v137
    v_add_f32 v137, v138, v139
    s_nop 1
    v_permlane32_swap_b32 v136, v137
    v_add_f32 v136, v136, v137
    v_mov_b32 v137, v136
    s_nop 1
    v_permlane16_swap_b32 v136, v137
    v_add_f32_e64 v136, v136, v137
    s_cmp_eq_u32 s51, 0
    s_cbranch_scc1 sc_25
    buffer_store_dword v136, v5, s[4:7], s61 offen
scb_26:
    s_add_u32 m0, m0, s53
    s_add_u32 s58, s58, s56
    buffer_load_dwordx4 v6, s[24:27], s58 offen lds
    s_add_u32 m0, m0, s53
    s_add_u32 s58, s58, s56
    buffer_load_dwordx4 v6, s[24:27], s58 offen lds
    s_add_u32 m0, m0, s53
    s_add_u32 s58, s58, s56
    buffer_load_dwordx4 v6, s[24:27], s58 offen lds
    s_add_u32 m0, m0, s53
    s_add_u32 s58, s58, s56
    buffer_load_dwordx4 v6, s[24:27], s58 offen lds
    s_add_u32 m0, m0, s53
    s_add_u32 s58, s58, s56
    buffer_load_dwordx4 v6, s[24:27], s58 offen lds
    s_add_u32 m0, m0, s53
    s_add_u32 s58, s58, s56
    buffer_load_dwordx4 v6, s[24:27], s58 offen lds
    v_add_u32 v144, 0, v1
    s_mov_b32 s77, 16384
    v_and_b32_e64 v19, 0x30, v0
    v_add_u32 v19, 162816, v19
    s_waitcnt lgkmcnt(0)
    ds_read_b64_tr_b16 a[176:177], v120 offset:45056
    ds_read_b64_tr_b16 a[178:179], v120 offset:47104
    ds_read_b64_tr_b16 a[180:181], v121 offset:45056
    ds_read_b64_tr_b16 a[182:183], v121 offset:47104
    ds_read_b64_tr_b16 a[184:185], v122 offset:45056
    ds_read_b64_tr_b16 a[186:187], v122 offset:47104
    ds_read_b64_tr_b16 a[188:189], v123 offset:45056
    ds_read_b64_tr_b16 a[190:191], v123 offset:47104
    ds_read_b64_tr_b16 a[192:193], v120 offset:49152
    ds_read_b64_tr_b16 a[194:195], v120 offset:51200
    ds_read_b64_tr_b16 a[196:197], v121 offset:49152
    ds_read_b64_tr_b16 a[198:199], v121 offset:51200
    ds_read_b64_tr_b16 a[200:201], v122 offset:49152
    ds_read_b64_tr_b16 a[202:203], v122 offset:51200
    ds_read_b64_tr_b16 a[204:205], v123 offset:49152
    ds_read_b64_tr_b16 a[206:207], v123 offset:51200
    ds_read_b64_tr_b16 a[208:209], v120 offset:53248
    ds_read_b64_tr_b16 a[210:211], v120 offset:55296
    ds_read_b64_tr_b16 a[212:213], v121 offset:53248
    ds_read_b64_tr_b16 a[214:215], v121 offset:55296
    ds_read_b64_tr_b16 a[216:217], v122 offset:53248
    ds_read_b64_tr_b16 a[218:219], v122 offset:55296
    ds_read_b64_tr_b16 a[220:221], v123 offset:53248
    ds_read_b64_tr_b16 a[222:223], v123 offset:55296
    ds_read_b64_tr_b16 a[224:225], v120 offset:57344
    ds_read_b64_tr_b16 a[226:227], v120 offset:59392
    ds_read_b64_tr_b16 a[228:229], v121 offset:57344
    ds_read_b64_tr_b16 a[230:231], v121 offset:59392
    ds_read_b64_tr_b16 a[232:233], v122 offset:57344
    ds_read_b64_tr_b16 a[234:235], v122 offset:59392
    ds_read_b64_tr_b16 a[236:237], v123 offset:57344
    ds_read_b64_tr_b16 a[238:239], v123 offset:59392
    s_add_u32 s64, s64, 1
    v_mov_b32 v21, s65
    v_mov_b32 v20, s64
    s_mov_b64 exec, 1
    s_waitcnt vmcnt(6)
    s_cmp_eq_u32 s51, 0
    s_cbranch_scc1 sc_27
    buffer_store_dwordx2 v[20:21], off, s[8:11], s69
scb_28:
    s_mov_b64 exec, -1
    ds_read_b64_tr_b16 a[240:241], v120 offset:61440
    ds_read_b64_tr_b16 a[242:243], v120 offset:63488
    ds_read_b64_tr_b16 a[244:245], v121 offset:61440
    ds_read_b64_tr_b16 a[246:247], v121 offset:63488
    ds_read_b64_tr_b16 a[248:249], v122 offset:61440
    ds_read_b64_tr_b16 a[250:251], v122 offset:63488
    ds_read_b64_tr_b16 a[252:253], v123 offset:61440
    ds_read_b64_tr_b16 a[254:255], v123 offset:63488
    s_waitcnt lgkmcnt(0)
    s_barrier
    s_add_u32 m0, m0, s53
    s_add_u32 s58, s58, s56
    buffer_load_dwordx4 v6, s[24:27], s58 offen lds
    s_add_u32 m0, m0, s53
    s_add_u32 s58, s58, s56
    buffer_load_dwordx4 v6, s[24:27], s58 offen lds
    s_add_u32 m0, s87, 73728
    s_add_u32 s58, s88, 458752
    buffer_load_dwordx4 v248, s[28:31], s58 offen offset:0 lds
    buffer_load_dwordx4 v249, s[28:31], s58 offen offset:1024 lds
    s_cmp_lg_u32 s50, 0
    s_cbranch_scc1 l0_29
    v_mov_b32 v192, 0x3f803f80
    v_mov_b32 v193, 0x3f803f80
    v_mov_b32 v194, 0x3f803f80
    v_mov_b32 v195, 0x3f803f80
    v_lshl_add_u32 v184, s44, 6, v19
    s_cmp_lg_u32 s44, 0
    s_cbranch_scc1 csn_31
    v_mfma_f32_16x16x32_bf16 v[176:179], a[0:3], v[192:195], 0
    v_mfma_f32_16x16x32_bf16 v[180:183], a[16:19], v[192:195], 0
    v_mfma_f32_16x16x32_bf16 v[176:179], a[32:35], v[192:195], v[176:179]
    v_mfma_f32_16x16x32_bf16 v[180:183], a[48:51], v[192:195], v[180:183]
    v_mfma_f32_16x16x32_bf16 v[176:179], a[64:67], v[192:195], v[176:179]
    v_mfma_f32_16x16x32_bf16 v[180:183], a[80:83], v[192:195], v[180:183]
    v_mfma_f32_16x16x32_bf16 v[176:179], a[96:99], v[192:195], v[176:179]
    v_mfma_f32_16x16x32_bf16 v[180:183], a[112:115], v[192:195], v[180:183]
    v_mfma_f32_16x16x32_bf16 v[176:179], a[128:131], v[192:195], v[176:179]
    v_mfma_f32_16x16x32_bf16 v[180:183], a[144:147], v[192:195], v[180:183]
    v_mfma_f32_16x16x32_bf16 v[176:179], a[160:163], v[192:195], v[176:179]
    v_mfma_f32_16x16x32_bf16 v[180:183], a[176:179], v[192:195], v[180:183]
    v_mfma_f32_16x16x32_bf16 v[176:179], a[192:195], v[192:195], v[176:179]
    v_mfma_f32_16x16x32_bf16 v[180:183], a[208:211], v[192:195], v[180:183]
    v_mfma_f32_16x16x32_bf16 v[176:179], a[224:227], v[192:195], v[176:179]
    v_mfma_f32_16x16x32_bf16 v[180:183], a[240:243], v[192:195], v[180:183]
    s_branch cse_30
csn_31:
    s_cmp_lg_u32 s44, 1
    s_cbranch_scc1 csn_32
    v_mfma_f32_16x16x32_bf16 v[176:179], a[4:7], v[192:195], 0
    v_mfma_f32_16x16x32_bf16 v[180:183], a[20:23], v[192:195], 0
    v_mfma_f32_16x16x32_bf16 v[176:179], a[36:39], v[192:195], v[176:179]
    v_mfma_f32_16x16x32_bf16 v[180:183], a[52:55], v[192:195], v[180:183]
    v_mfma_f32_16x16x32_bf16 v[176:179], a[68:71], v[192:195], v[176:179]
    v_mfma_f32_16x16x32_bf16 v[180:183], a[84:87], v[192:195], v[180:183]
    v_mfma_f32_16x16x32_bf16 v[176:179], a[100:103], v[192:195], v[176:179]
    v_mfma_f32_16x16x32_bf16 v[180:183], a[116:119], v[192:195], v[180:183]
    v_mfma_f32_16x16x32_bf16 v[176:179], a[132:135], v[192:195], v[176:179]
    v_mfma_f32_16x16x32_bf16 v[180:183], a[148:151], v[192:195], v[180:183]
    v_mfma_f32_16x16x32_bf16 v[176:179], a[164:167], v[192:195], v[176:179]
    v_mfma_f32_16x16x32_bf16 v[180:183], a[180:183], v[192:195], v[180:183]
    v_mfma_f32_16x16x32_bf16 v[176:179], a[196:199], v[192:195], v[176:179]
    v_mfma_f32_16x16x32_bf16 v[180:183], a[212:215], v[192:195], v[180:183]
    v_mfma_f32_16x16x32_bf16 v[176:179], a[228:231], v[192:195], v[176:179]
    v_mfma_f32_16x16x32_bf16 v[180:183], a[244:247], v[192:195], v[180:183]
    s_branch cse_30
csn_32:
    s_cmp_lg_u32 s44, 2
    s_cbranch_scc1 csn_33
    v_mfma_f32_16x16x32_bf16 v[176:179], a[8:11], v[192:195], 0
    v_mfma_f32_16x16x32_bf16 v[180:183], a[24:27], v[192:195], 0
    v_mfma_f32_16x16x32_bf16 v[176:179], a[40:43], v[192:195], v[176:179]
    v_mfma_f32_16x16x32_bf16 v[180:183], a[56:59], v[192:195], v[180:183]
    v_mfma_f32_16x16x32_bf16 v[176:179], a[72:75], v[192:195], v[176:179]
    v_mfma_f32_16x16x32_bf16 v[180:183], a[88:91], v[192:195], v[180:183]
    v_mfma_f32_16x16x32_bf16 v[176:179], a[104:107], v[192:195], v[176:179]
    v_mfma_f32_16x16x32_bf16 v[180:183], a[120:123], v[192:195], v[180:183]
    v_mfma_f32_16x16x32_bf16 v[176:179], a[136:139], v[192:195], v[176:179]
    v_mfma_f32_16x16x32_bf16 v[180:183], a[152:155], v[192:195], v[180:183]
    v_mfma_f32_16x16x32_bf16 v[176:179], a[168:171], v[192:195], v[176:179]
    v_mfma_f32_16x16x32_bf16 v[180:183], a[184:187], v[192:195], v[180:183]
    v_mfma_f32_16x16x32_bf16 v[176:179], a[200:203], v[192:195], v[176:179]
    v_mfma_f32_16x16x32_bf16 v[180:183], a[216:219], v[192:195], v[180:183]
    v_mfma_f32_16x16x32_bf16 v[176:179], a[232:235], v[192:195], v[176:179]
    v_mfma_f32_16x16x32_bf16 v[180:183], a[248:251], v[192:195], v[180:183]
    s_branch cse_30
csn_33:
    v_mfma_f32_16x16x32_bf16 v[176:179], a[12:15], v[192:195], 0
    v_mfma_f32_16x16x32_bf16 v[180:183], a[28:31], v[192:195], 0
    v_mfma_f32_16x16x32_bf16 v[176:179], a[44:47], v[192:195], v[176:179]
    v_mfma_f32_16x16x32_bf16 v[180:183], a[60:63], v[192:195], v[180:183]
    v_mfma_f32_16x16x32_bf16 v[176:179], a[76:79], v[192:195], v[176:179]
    v_mfma_f32_16x16x32_bf16 v[180:183], a[92:95], v[192:195], v[180:183]
    v_mfma_f32_16x16x32_bf16 v[176:179], a[108:111], v[192:195], v[176:179]
    v_mfma_f32_16x16x32_bf16 v[180:183], a[124:127], v[192:195], v[180:183]
    v_mfma_f32_16x16x32_bf16 v[176:179], a[140:143], v[192:195], v[176:179]
    v_mfma_f32_16x16x32_bf16 v[180:183], a[156:159], v[192:195], v[180:183]
    v_mfma_f32_16x16x32_bf16 v[176:179], a[172:175], v[192:195], v[176:179]
    v_mfma_f32_16x16x32_bf16 v[180:183], a[188:191], v[192:195], v[180:183]
    v_mfma_f32_16x16x32_bf16 v[176:179], a[204:207], v[192:195], v[176:179]
    v_mfma_f32_16x16x32_bf16 v[180:183], a[220:223], v[192:195], v[180:183]
    v_mfma_f32_16x16x32_bf16 v[176:179], a[236:239], v[192:195], v[176:179]
    v_mfma_f32_16x16x32_bf16 v[180:183], a[252:255], v[192:195], v[180:183]
cse_30:
    s_nop 7
    v_pk_add_f32 v[176:177], v[176:177], v[180:181]
    v_pk_add_f32 v[178:179], v[178:179], v[182:183]
    ds_write_b128 v184, v[176:179]
    s_waitcnt lgkmcnt(0)
    s_barrier
l0_29:
    ds_read_b128 v[176:179], v19 offset:0
    ds_read_b128 v[180:183], v19 offset:64
    ds_read_b128 v[184:187], v19 offset:128
    ds_read_b128 v[188:191], v19 offset:192
    s_mov_b32 s59, 0x8000
poll_35:
    buffer_load_dwordx2 v[20:21], v15, s[8:11], 0 offen sc1
    s_sub_u32 s59, s59, 1
    s_cbranch_scc1 bail
    s_waitcnt vmcnt(0)
    v_cmp_ne_u64 vcc, s[64:65], v[20:21]
    s_cbranch_vccnz poll_35
    buffer_load_dwordx4 v[196:199], v1, s[4:7], s77 offen sc1
    buffer_load_dwordx4 v[56:59], v144, s[4:7], 0 offen offset:0 sc1
    buffer_load_dwordx4 v[60:63], v144, s[4:7], 0 offen offset:1024 sc1
    buffer_load_dwordx4 v[64:67], v144, s[4:7], 0 offen offset:2048 sc1
    s_nop 0
    buffer_load_dwordx4 v[68:71], v144, s[4:7], 0 offen offset:3072 sc1
    buffer_load_dwordx4 v[72:75], v144, s[4:7], s53 offen offset:0 sc1
    buffer_load_dwordx4 v[76:79], v144, s[4:7], s53 offen offset:1024 sc1
    buffer_load_dwordx4 v[80:83], v144, s[4:7], s53 offen offset:2048 sc1
    buffer_load_dwordx4 v[84:87], v144, s[4:7], s53 offen offset:3072 sc1
    buffer_load_dwordx4 v[88:91], v144, s[4:7], s54 offen offset:0 sc1
    buffer_load_dwordx4 v[92:95], v144, s[4:7], s54 offen offset:1024 sc1
    buffer_load_dwordx4 v[96:99], v144, s[4:7], s54 offen offset:2048 sc1
    buffer_load_dwordx4 v[100:103], v144, s[4:7], s54 offen offset:3072 sc1
    s_waitcnt vmcnt(11)
    v_mfma_f32_16x16x32_bf16 v[160:163], a[0:3], v[56:59], 0
    buffer_load_dwordx4 v[104:107], v144, s[4:7], s55 offen offset:0 sc1
    v_mfma_f32_16x16x32_bf16 v[164:167], a[4:7], v[56:59], 0
    ds_read_b64_tr_b16 a[0:1], v8 offset:0
    ds_read_b64_tr_b16 a[2:3], v8 offset:2048
    v_add_f32 v196, v196, v198
    v_mfma_f32_16x16x32_bf16 v[168:171], a[8:11], v[56:59], 0
    ds_read_b64_tr_b16 a[4:5], v9 offset:0
    ds_read_b64_tr_b16 a[6:7], v9 offset:2048
    v_add_f32 v197, v197, v199
    v_mfma_f32_16x16x32_bf16 v[172:175], a[12:15], v[56:59], 0
    s_nop 0
    v_permlane32_swap_b32 v196, v197
    s_waitcnt vmcnt(11)
    v_mfma_f32_16x16x32_bf16 v[160:163], a[16:19], v[60:63], v[160:163]
    buffer_load_dwordx4 v[108:111], v144, s[4:7], s55 offen offset:1024 sc1
    ds_read_b64_tr_b16 a[8:9], v10 offset:0
    ds_read_b64_tr_b16 a[10:11], v10 offset:2048
    v_mfma_f32_16x16x32_bf16 v[164:167], a[20:23], v[60:63], v[164:167]
    v_add_f32 v196, v196, v197
    v_mfma_f32_16x16x32_bf16 v[168:171], a[24:27], v[60:63], v[168:171]
    ds_read_b64_tr_b16 a[12:13], v11 offset:0
    ds_read_b64_tr_b16 a[14:15], v11 offset:2048
    v_mov_b32 v197, v196
    v_mfma_f32_16x16x32_bf16 v[172:175], a[28:31], v[60:63], v[172:175]
    s_nop 0
    v_permlane16_swap_b32 v196, v197
    s_waitcnt vmcnt(11)
    v_mfma_f32_16x16x32_bf16 v[160:163], a[32:35], v[64:67], v[160:163]
    buffer_load_dwordx4 v[112:115], v144, s[4:7], s55 offen offset:2048 sc1
    ds_read_b64_tr_b16 a[16:17], v8 offset:4096
    ds_read_b64_tr_b16 a[18:19], v8 offset:6144
    v_mfma_f32_16x16x32_bf16 v[164:167], a[36:39], v[64:67], v[164:167]
    v_add_f32 v196, v196, v197
    v_mfma_f32_16x16x32_bf16 v[168:171], a[40:43], v[64:67], v[168:171]
    ds_read_b64_tr_b16 a[20:21], v9 offset:4096
    ds_read_b64_tr_b16 a[22:23], v9 offset:6144
    v_mov_b32 v197, v196
    v_mfma_f32_16x16x32_bf16 v[172:175], a[44:47], v[64:67], v[172:175]
    s_nop 0
    v_permlane32_swap_b32 v196, v197
    s_waitcnt vmcnt(11)
    v_mfma_f32_16x16x32_bf16 v[160:163], a[48:51], v[68:71], v[160:163]
    buffer_load_dwordx4 v[116:119], v144, s[4:7], s55 offen offset:3072 sc1
    ds_read_b64_tr_b16 a[24:25], v10 offset:4096
    ds_read_b64_tr_b16 a[26:27], v10 offset:6144
    v_mfma_f32_16x16x32_bf16 v[164:167], a[52:55], v[68:71], v[164:167]
    v_mul_f32 v201, 0xbb000000, v196
    v_mfma_f32_16x16x32_bf16 v[168:171], a[56:59], v[68:71], v[168:171]
    ds_read_b64_tr_b16 a[28:29], v11 offset:4096
    ds_read_b64_tr_b16 a[30:31], v11 offset:6144
    v_mul_f32 v197, 0x3b000000, v197
    v_mfma_f32_16x16x32_bf16 v[172:175], a[60:63], v[68:71], v[172:175]
    v_fma_f32 v197, -v201, v201, v197
    s_waitcnt vmcnt(11)
    v_mfma_f32_16x16x32_bf16 v[160:163], a[64:67], v[72:75], v[160:163]
    buffer_load_dwordx4 v250, s[28:31], s58 offen offset:2048 lds
    ds_read_b64_tr_b16 a[32:33], v8 offset:8192
    ds_read_b64_tr_b16 a[34:35], v8 offset:10240
    v_mfma_f32_16x16x32_bf16 v[164:167], a[68:71], v[72:75], v[164:167]
    v_max_f32 v202, 0, v197
    v_mfma_f32_16x16x32_bf16 v[168:171], a[72:75], v[72:75], v[168:171]
    ds_read_b64_tr_b16 a[36:37], v9 offset:8192
    ds_read_b64_tr_b16 a[38:39], v9 offset:10240
    v_add_f32 v197, 0x3727c5ac, v202
    v_mfma_f32_16x16x32_bf16 v[172:175], a[76:79], v[72:75], v[172:175]
    v_rsq_f32 v200, v197
    s_waitcnt vmcnt(11)
    v_mfma_f32_16x16x32_bf16 v[160:163], a[80:83], v[76:79], v[160:163]
    buffer_load_dwordx4 v251, s[28:31], s58 offen offset:3072 lds
    ds_read_b64_tr_b16 a[40:41], v10 offset:8192
    ds_read_b64_tr_b16 a[42:43], v10 offset:10240
    v_mfma_f32_16x16x32_bf16 v[164:167], a[84:87], v[76:79], v[164:167]
    v_mul_f32 v196, v200, v200
    v_mfma_f32_16x16x32_bf16 v[168:171], a[88:91], v[76:79], v[168:171]
    ds_read_b64_tr_b16 a[44:45], v11 offset:8192
    ds_read_b64_tr_b16 a[46:47], v11 offset:10240
    v_fmaak_f32 v196, v196, v202, 0x3727c5ac
    v_mfma_f32_16x16x32_bf16 v[172:175], a[92:95], v[76:79], v[172:175]
    v_rsq_f32 v196, v196
    s_waitcnt vmcnt(11)
    v_mfma_f32_16x16x32_bf16 v[160:163], a[96:99], v[80:83], v[160:163]
    s_add_u32 m0, m0, s53
    s_add_u32 s58, s58, s53
    buffer_load_dwordx4 v252, s[28:31], s58 offen offset:0 lds
    ds_read_b64_tr_b16 a[48:49], v8 offset:12288
    ds_read_b64_tr_b16 a[50:51], v8 offset:14336
    v_mfma_f32_16x16x32_bf16 v[164:167], a[100:103], v[80:83], v[164:167]
    v_mul_f32 v202, v200, v201
    v_mfma_f32_16x16x32_bf16 v[168:171], a[104:107], v[80:83], v[168:171]
    ds_read_b64_tr_b16 a[52:53], v9 offset:12288
    ds_read_b64_tr_b16 a[54:55], v9 offset:14336
    v_mul_f32 v196, v200, v196
    v_mfma_f32_16x16x32_bf16 v[172:175], a[108:111], v[80:83], v[172:175]
    v_rcp_f32 v206, v196
    s_waitcnt vmcnt(11)
    v_mfma_f32_16x16x32_bf16 v[160:163], a[112:115], v[84:87], v[160:163]
    buffer_load_dwordx4 v253, s[28:31], s58 offen offset:1024 lds
    ds_read_b64_tr_b16 a[56:57], v10 offset:12288
    ds_read_b64_tr_b16 a[58:59], v10 offset:14336
    v_mfma_f32_16x16x32_bf16 v[164:167], a[116:119], v[84:87], v[164:167]
    v_mul_f32 v205, 0xc0135761, v196
    v_mfma_f32_16x16x32_bf16 v[168:171], a[120:123], v[84:87], v[168:171]
    ds_read_b64_tr_b16 a[60:61], v11 offset:12288
    ds_read_b64_tr_b16 a[62:63], v11 offset:14336
    v_mul_f32 v204, v196, v196
    v_mfma_f32_16x16x32_bf16 v[172:175], a[124:127], v[84:87], v[172:175]
    v_mul_f32 v204, 0x3d372713, v204
    s_waitcnt vmcnt(11)
    v_mfma_f32_16x16x32_bf16 v[160:163], a[128:131], v[88:91], v[160:163]
    buffer_load_dwordx4 v254, s[28:31], s58 offen offset:2048 lds
    ds_read_b64_tr_b16 a[64:65], v8 offset:16384
    ds_read_b64_tr_b16 a[66:67], v8 offset:18432
    v_mfma_f32_16x16x32_bf16 v[164:167], a[132:135], v[88:91], v[164:167]
    v_mul_f32_e64 v204, v204, v205
    v_mfma_f32_16x16x32_bf16 v[168:171], a[136:139], v[88:91], v[168:171]
    ds_read_b64_tr_b16 a[68:69], v9 offset:16384
    ds_read_b64_tr_b16 a[70:71], v9 offset:18432
    v_mfma_f32_16x16x32_bf16 v[172:175], a[140:143], v[88:91], v[172:175]
    s_waitcnt vmcnt(11)
    v_mfma_f32_16x16x32_bf16 v[160:163], a[144:147], v[92:95], v[160:163]
    s_add_u32 m0, s87, 102400
    s_add_u32 s58, s88, 917504
    buffer_load_dwordx4 v248, s[28:31], s58 offen offset:0 lds
    ds_read_b64_tr_b16 a[72:73], v10 offset:16384
    ds_read_b64_tr_b16 a[74:75], v10 offset:18432
    v_mfma_f32_16x16x32_bf16 v[164:167], a[148:151], v[92:95], v[164:167]
    v_mfma_f32_16x16x32_bf16 v[168:171], a[152:155], v[92:95], v[168:171]
    ds_read_b64_tr_b16 a[76:77], v11 offset:16384
    ds_read_b64_tr_b16 a[78:79], v11 offset:18432
    v_mfma_f32_16x16x32_bf16 v[172:175], a[156:159], v[92:95], v[172:175]
    s_waitcnt vmcnt(11)
    v_mfma_f32_16x16x32_bf16 v[160:163], a[160:163], v[96:99], v[160:163]
    buffer_load_dwordx4 v249, s[28:31], s58 offen offset:1024 lds
    ds_read_b64_tr_b16 a[80:81], v8 offset:20480
    ds_read_b64_tr_b16 a[82:83], v8 offset:22528
    v_mfma_f32_16x16x32_bf16 v[164:167], a[164:167], v[96:99], v[164:167]
    v_mfma_f32_16x16x32_bf16 v[168:171], a[168:171], v[96:99], v[168:171]
    ds_read_b64_tr_b16 a[84:85], v9 offset:20480
    ds_read_b64_tr_b16 a[86:87], v9 offset:22528
    v_mfma_f32_16x16x32_bf16 v[172:175], a[172:175], v[96:99], v[172:175]
    s_waitcnt vmcnt(11)
    v_mfma_f32_16x16x32_bf16 v[160:163], a[176:179], v[100:103], v[160:163]
    buffer_load_dwordx4 v250, s[28:31], s58 offen offset:2048 lds
    ds_read_b64_tr_b16 a[88:89], v10 offset:20480
    ds_read_b64_tr_b16 a[90:91], v10 offset:22528
    v_mfma_f32_16x16x32_bf16 v[164:167], a[180:183], v[100:103], v[164:167]
    v_mfma_f32_16x16x32_bf16 v[168:171], a[184:187], v[100:103], v[168:171]
    ds_read_b64_tr_b16 a[92:93], v11 offset:20480
    ds_read_b64_tr_b16 a[94:95], v11 offset:22528
    v_mfma_f32_16x16x32_bf16 v[172:175], a[188:191], v[100:103], v[172:175]
    s_waitcnt vmcnt(11)
    v_mfma_f32_16x16x32_bf16 v[160:163], a[192:195], v[104:107], v[160:163]
    buffer_load_dwordx4 v251, s[28:31], s58 offen offset:3072 lds
    ds_read_b64_tr_b16 a[96:97], v8 offset:24576
    ds_read_b64_tr_b16 a[98:99], v8 offset:26624
    v_mfma_f32_16x16x32_bf16 v[164:167], a[196:199], v[104:107], v[164:167]
    v_mfma_f32_16x16x32_bf16 v[168:171], a[200:203], v[104:107], v[168:171]
    ds_read_b64_tr_b16 a[100:101], v9 offset:24576
    ds_read_b64_tr_b16 a[102:103], v9 offset:26624
    v_mfma_f32_16x16x32_bf16 v[172:175], a[204:207], v[104:107], v[172:175]
    s_waitcnt vmcnt(11)
    v_mfma_f32_16x16x32_bf16 v[160:163], a[208:211], v[108:111], v[160:163]
    s_add_u32 m0, m0, s53
    s_add_u32 s58, s58, s53
    buffer_load_dwordx4 v252, s[28:31], s58 offen offset:0 lds
    ds_read_b64_tr_b16 a[104:105], v10 offset:24576
    ds_read_b64_tr_b16 a[106:107], v10 offset:26624
    v_mfma_f32_16x16x32_bf16 v[164:167], a[212:215], v[108:111], v[164:167]
    v_mfma_f32_16x16x32_bf16 v[168:171], a[216:219], v[108:111], v[168:171]
    ds_read_b64_tr_b16 a[108:109], v11 offset:24576
    ds_read_b64_tr_b16 a[110:111], v11 offset:26624
    v_mfma_f32_16x16x32_bf16 v[172:175], a[220:223], v[108:111], v[172:175]
    s_waitcnt vmcnt(11)
    v_mfma_f32_16x16x32_bf16 v[160:163], a[224:227], v[112:115], v[160:163]
    buffer_load_dwordx4 v253, s[28:31], s58 offen offset:1024 lds
    ds_read_b64_tr_b16 a[112:113], v8 offset:28672
    ds_read_b64_tr_b16 a[114:115], v8 offset:30720
    v_mfma_f32_16x16x32_bf16 v[164:167], a[228:231], v[112:115], v[164:167]
    v_mfma_f32_16x16x32_bf16 v[168:171], a[232:235], v[112:115], v[168:171]
    ds_read_b64_tr_b16 a[116:117], v9 offset:28672
    ds_read_b64_tr_b16 a[118:119], v9 offset:30720
    v_mfma_f32_16x16x32_bf16 v[172:175], a[236:239], v[112:115], v[172:175]
    s_waitcnt vmcnt(11)
    v_mfma_f32_16x16x32_bf16 v[160:163], a[240:243], v[116:119], v[160:163]
    buffer_load_dwordx4 v254, s[28:31], s58 offen offset:2048 lds
    ds_read_b64_tr_b16 a[120:121], v10 offset:28672
    ds_read_b64_tr_b16 a[122:123], v10 offset:30720
    v_mfma_f32_16x16x32_bf16 v[164:167], a[244:247], v[116:119], v[164:167]
    v_mfma_f32_16x16x32_bf16 v[168:171], a[248:251], v[116:119], v[168:171]
    ds_read_b64_tr_b16 a[124:125], v11 offset:28672
    ds_read_b64_tr_b16 a[126:127], v11 offset:30720
    v_mfma_f32_16x16x32_bf16 v[172:175], a[252:255], v[116:119], v[172:175]
    s_waitcnt lgkmcnt(0)
    v_pk_fma_f32 v[160:161], v[176:177], v[200:201], v[160:161] op_sel:[0,1,0] op_sel_hi:[1,1,1]
    v_pk_fma_f32 v[162:163], v[178:179], v[200:201], v[162:163] op_sel:[0,1,0] op_sel_hi:[1,1,1]
    s_nop 0
    v_pk_fma_f32 v[164:165], v[180:181], v[200:201], v[164:165] op_sel:[0,1,0] op_sel_hi:[1,1,1]
    v_pk_fma_f32 v[166:167], v[182:183], v[200:201], v[166:167] op_sel:[0,1,0] op_sel_hi:[1,1,1]
    v_pk_fma_f32 v[168:169], v[184:185], v[200:201], v[168:169] op_sel:[0,1,0] op_sel_hi:[1,1,1]
    v_pk_fma_f32 v[170:171], v[186:187], v[200:201], v[170:171] op_sel:[0,1,0] op_sel_hi:[1,1,1]
    v_pk_fma_f32 v[172:173], v[188:189], v[200:201], v[172:173] op_sel:[0,1,0] op_sel_hi:[1,1,1]
    v_pk_fma_f32 v[174:175], v[190:191], v[200:201], v[174:175] op_sel:[0,1,0] op_sel_hi:[1,1,1]
    v_pk_mul_f32 v[208:209], v[160:161], v[160:161]
    v_pk_mul_f32 v[210:211], v[162:163], v[162:163]
    v_pk_mul_f32 v[212:213], v[164:165], v[164:165]
    v_pk_mul_f32 v[214:215], v[166:167], v[166:167]
    v_pk_mul_f32 v[216:217], v[168:169], v[168:169]
    v_pk_mul_f32 v[218:219], v[170:171], v[170:171]
    v_pk_mul_f32 v[220:221], v[172:173], v[172:173]
    v_pk_mul_f32 v[222:223], v[174:175], v[174:175]
    v_pk_fma_f32 v[208:209], v[208:209], v[204:205], v[204:205] op_sel:[0,0,1] op_sel_hi:[1,0,1]
    v_pk_fma_f32 v[210:211], v[210:211], v[204:205], v[204:205] op_sel:[0,0,1] op_sel_hi:[1,0,1]
    v_pk_fma_f32 v[212:213], v[212:213], v[204:205], v[204:205] op_sel:[0,0,1] op_sel_hi:[1,0,1]
    v_pk_fma_f32 v[214:215], v[214:215], v[204:205], v[204:205] op_sel:[0,0,1] op_sel_hi:[1,0,1]
    v_pk_fma_f32 v[216:217], v[216:217], v[204:205], v[204:205] op_sel:[0,0,1] op_sel_hi:[1,0,1]
    v_pk_fma_f32 v[218:219], v[218:219], v[204:205], v[204:205] op_sel:[0,0,1] op_sel_hi:[1,0,1]
    v_pk_fma_f32 v[220:221], v[220:221], v[204:205], v[204:205] op_sel:[0,0,1] op_sel_hi:[1,0,1]
    v_pk_fma_f32 v[222:223], v[222:223], v[204:205], v[204:205] op_sel:[0,0,1] op_sel_hi:[1,0,1]
    v_pk_mul_f32 v[208:209], v[208:209], v[160:161]
    v_pk_mul_f32 v[210:211], v[210:211], v[162:163]
    v_pk_mul_f32 v[212:213], v[212:213], v[164:165]
    v_pk_mul_f32 v[214:215], v[214:215], v[166:167]
    v_pk_mul_f32 v[216:217], v[216:217], v[168:169]
    v_pk_mul_f32 v[218:219], v[218:219], v[170:171]
    v_pk_mul_f32 v[220:221], v[220:221], v[172:173]
    v_pk_mul_f32 v[222:223], v[222:223], v[174:175]
    v_exp_f32 v208, v208
    v_exp_f32 v209, v209
    v_exp_f32 v210, v210
    v_exp_f32 v211, v211
    v_exp_f32 v212, v212
    v_exp_f32 v213, v213
    v_exp_f32 v214, v214
    v_exp_f32 v215, v215
    v_exp_f32 v216, v216
    v_exp_f32 v217, v217
    v_exp_f32 v218, v218
    v_exp_f32 v219, v219
    v_exp_f32 v220, v220
    v_exp_f32 v221, v221
    v_exp_f32 v222, v222
    v_exp_f32 v223, v223
    v_pk_fma_f32 v[208:209], v[208:209], v[206:207], v[206:207] op_sel:[0,0,0] op_sel_hi:[1,0,0]
    v_pk_fma_f32 v[210:211], v[210:211], v[206:207], v[206:207] op_sel:[0,0,0] op_sel_hi:[1,0,0]
    v_pk_fma_f32 v[212:213], v[212:213], v[206:207], v[206:207] op_sel:[0,0,0] op_sel_hi:[1,0,0]
    v_pk_fma_f32 v[214:215], v[214:215], v[206:207], v[206:207] op_sel:[0,0,0] op_sel_hi:[1,0,0]
    v_pk_fma_f32 v[216:217], v[216:217], v[206:207], v[206:207] op_sel:[0,0,0] op_sel_hi:[1,0,0]
    v_pk_fma_f32 v[218:219], v[218:219], v[206:207], v[206:207] op_sel:[0,0,0] op_sel_hi:[1,0,0]
    v_pk_fma_f32 v[220:221], v[220:221], v[206:207], v[206:207] op_sel:[0,0,0] op_sel_hi:[1,0,0]
    v_pk_fma_f32 v[222:223], v[222:223], v[206:207], v[206:207] op_sel:[0,0,0] op_sel_hi:[1,0,0]
    v_rcp_f32 v208, v208
    v_rcp_f32 v209, v209
    v_rcp_f32 v210, v210
    v_rcp_f32 v211, v211
    v_rcp_f32 v212, v212
    v_rcp_f32 v213, v213
    v_rcp_f32 v214, v214
    v_rcp_f32 v215, v215
    v_rcp_f32 v216, v216
    v_rcp_f32 v217, v217
    v_rcp_f32 v218, v218
    v_rcp_f32 v219, v219
    v_rcp_f32 v220, v220
    v_rcp_f32 v221, v221
    v_rcp_f32 v222, v222
    v_rcp_f32 v223, v223
    v_pk_mul_f32 v[160:161], v[160:161], v[208:209]
    v_pk_mul_f32 v[162:163], v[162:163], v[210:211]
    v_pk_mul_f32 v[164:165], v[164:165], v[212:213]
    v_pk_mul_f32 v[166:167], v[166:167], v[214:215]
    v_pk_mul_f32 v[168:169], v[168:169], v[216:217]
    v_pk_mul_f32 v[170:171], v[170:171], v[218:219]
    v_pk_mul_f32 v[172:173], v[172:173], v[220:221]
    v_pk_mul_f32 v[174:175], v[174:175], v[222:223]
    v_cvt_pk_bf16_f32 v128, v160, v161
    v_cvt_pk_bf16_f32 v129, v162, v163
    v_cvt_pk_bf16_f32 v130, v164, v165
    v_cvt_pk_bf16_f32 v131, v166, v167
    v_cvt_pk_bf16_f32 v132, v168, v169
    v_cvt_pk_bf16_f32 v133, v170, v171
    v_cvt_pk_bf16_f32 v134, v172, v173
    v_cvt_pk_bf16_f32 v135, v174, v175
    s_cmp_eq_u32 s52, 0
    s_cbranch_scc1 sc_36
    buffer_store_dwordx4 v[128:131], v2, s[4:7], s98 offen offset:0
    buffer_store_dwordx4 v[132:135], v2, s[4:7], s98 offen offset:1024
scb_37:
    s_barrier
    s_add_u32 m0, s68, 0
    s_mov_b32 s58, 0
    buffer_load_dwordx4 v6, s[32:35], s58 offen lds
    s_add_u32 m0, m0, s53
    s_add_u32 s58, s58, s56
    buffer_load_dwordx4 v6, s[32:35], s58 offen lds
    v_pk_fma_f32 v[40:41], v[24:25], v[200:201], v[202:203] op_sel:[0,0,0] op_sel_hi:[1,0,0]
    v_pk_fma_f32 v[42:43], v[26:27], v[200:201], v[202:203] op_sel:[0,0,0] op_sel_hi:[1,0,0]
    v_pk_fma_f32 v[44:45], v[28:29], v[200:201], v[202:203] op_sel:[0,0,0] op_sel_hi:[1,0,0]
    v_pk_fma_f32 v[46:47], v[30:31], v[200:201], v[202:203] op_sel:[0,0,0] op_sel_hi:[1,0,0]
    s_nop 0
    v_pk_fma_f32 v[48:49], v[32:33], v[200:201], v[202:203] op_sel:[0,0,0] op_sel_hi:[1,0,0]
    v_pk_fma_f32 v[50:51], v[34:35], v[200:201], v[202:203] op_sel:[0,0,0] op_sel_hi:[1,0,0]
    v_pk_fma_f32 v[52:53], v[36:37], v[200:201], v[202:203] op_sel:[0,0,0] op_sel_hi:[1,0,0]
    v_pk_fma_f32 v[54:55], v[38:39], v[200:201], v[202:203] op_sel:[0,0,0] op_sel_hi:[1,0,0]
    s_lshl_b32 s60, s49, 4
    v_and_b32 v211, 15, v0
    v_add_u32 v211, s60, v211
    v_and_b32 v212, 0x300, v13
    v_add_u32 v212, s98, v212
    v_mov_b32 v210, 0x80000000
    v_add_u32 v19, -1, v211
    v_cmp_gt_u32 vcc, 0x800, v19
    v_lshrrev_b32 v208, 4, v19
    v_and_b32 v19, 15, v19
    v_mad_u32_u24 v208, v208, s57, v212
    v_lshl_add_u32 v208, v19, 4, v208
    v_cndmask_b32 v144, v210, v208, vcc
    v_add_u32 v19, 1, v211
    v_cmp_gt_u32 vcc, 0x800, v19
    v_lshrrev_b32 v208, 4, v19
    v_and_b32 v19, 15, v19
    v_mad_u32_u24 v208, v208, s57, v212
    v_lshl_add_u32 v208, v19, 4, v208
    v_cndmask_b32 v145, v210, v208, vcc
    v_add_u32 v19, -2, v211
    v_cmp_gt_u32 vcc, 0x800, v19
    v_lshrrev_b32 v208, 4, v19
    v_and_b32 v19, 15, v19
    v_mad_u32_u24 v208, v208, s57, v212
    v_lshl_add_u32 v208, v19, 4, v208
    v_cndmask_b32 v146, v210, v208, vcc
    v_add_u32 v19, 2, v211
    v_cmp_gt_u32 vcc, 0x800, v19
    v_lshrrev_b32 v208, 4, v19
    v_and_b32 v19, 15, v19
    v_mad_u32_u24 v208, v208, s57, v212
    v_lshl_add_u32 v208, v19, 4, v208
    v_cndmask_b32 v147, v210, v208, vcc
    ds_read_b64_tr_b16 a[128:129], v8 offset:32768
    ds_read_b64_tr_b16 a[130:131], v8 offset:34816
    ds_read_b64_tr_b16 a[132:133], v9 offset:32768
    ds_read_b64_tr_b16 a[134:135], v9 offset:34816
    ds_read_b64_tr_b16 a[136:137], v10 offset:32768
    ds_read_b64_tr_b16 a[138:139], v10 offset:34816
    ds_read_b64_tr_b16 a[140:141], v11 offset:32768
    ds_read_b64_tr_b16 a[142:143], v11 offset:34816
    ds_read_b64_tr_b16 a[144:145], v8 offset:36864
    ds_read_b64_tr_b16 a[146:147], v8 offset:38912
    ds_read_b64_tr_b16 a[148:149], v9 offset:36864
    ds_read_b64_tr_b16 a[150:151], v9 offset:38912
    ds_read_b64_tr_b16 a[152:153], v10 offset:36864
    ds_read_b64_tr_b16 a[154:155], v10 offset:38912
    ds_read_b64_tr_b16 a[156:157], v11 offset:36864
    ds_read_b64_tr_b16 a[158:159], v11 offset:38912
    s_add_u32 s64, s64, 1
    v_mov_b32 v21, s65
    v_mov_b32 v20, s64
    v_lshlrev_b32_e64 v19, 3, v0
    s_cmp_eq_u32 s89, 0
    s_cselect_b64 exec, 0xffff, 1
    s_waitcnt vmcnt(2)
    s_cmp_eq_u32 s52, 0
    s_cbranch_scc1 sc_38
    buffer_store_dwordx2 v[20:21], v19, s[8:11], s70 offen
scb_39:
    s_mov_b64 exec, -1
    s_add_u32 m0, m0, s53
    s_add_u32 s58, s58, s56
    buffer_load_dwordx4 v6, s[32:35], s58 offen lds
    ds_read_b64_tr_b16 a[160:161], v8 offset:40960
    ds_read_b64_tr_b16 a[162:163], v8 offset:43008
    ds_read_b64_tr_b16 a[164:165], v9 offset:40960
    ds_read_b64_tr_b16 a[166:167], v9 offset:43008
    ds_read_b64_tr_b16 a[168:169], v10 offset:40960
    ds_read_b64_tr_b16 a[170:171], v10 offset:43008
    ds_read_b64_tr_b16 a[172:173], v11 offset:40960
    ds_read_b64_tr_b16 a[174:175], v11 offset:43008
    s_add_u32 m0, m0, s53
    s_add_u32 s58, s58, s56
    buffer_load_dwordx4 v6, s[32:35], s58 offen lds
    ds_read_b64_tr_b16 a[176:177], v8 offset:45056
    ds_read_b64_tr_b16 a[178:179], v8 offset:47104
    ds_read_b64_tr_b16 a[180:181], v9 offset:45056
    ds_read_b64_tr_b16 a[182:183], v9 offset:47104
    ds_read_b64_tr_b16 a[184:185], v10 offset:45056
    ds_read_b64_tr_b16 a[186:187], v10 offset:47104
    ds_read_b64_tr_b16 a[188:189], v11 offset:45056
    ds_read_b64_tr_b16 a[190:191], v11 offset:47104
    s_add_u32 m0, m0, s53
    s_add_u32 s58, s58, s56
    buffer_load_dwordx4 v6, s[32:35], s58 offen lds
    ds_read_b64_tr_b16 a[192:193], v8 offset:49152
    ds_read_b64_tr_b16 a[194:195], v8 offset:51200
    ds_read_b64_tr_b16 a[196:197], v9 offset:49152
    ds_read_b64_tr_b16 a[198:199], v9 offset:51200
    ds_read_b64_tr_b16 a[200:201], v10 offset:49152
    ds_read_b64_tr_b16 a[202:203], v10 offset:51200
    ds_read_b64_tr_b16 a[204:205], v11 offset:49152
    ds_read_b64_tr_b16 a[206:207], v11 offset:51200
    s_add_u32 m0, m0, s53
    s_add_u32 s58, s58, s56
    buffer_load_dwordx4 v6, s[32:35], s58 offen lds
    ds_read_b64_tr_b16 a[208:209], v8 offset:53248
    ds_read_b64_tr_b16 a[210:211], v8 offset:55296
    ds_read_b64_tr_b16 a[212:213], v9 offset:53248
    ds_read_b64_tr_b16 a[214:215], v9 offset:55296
    ds_read_b64_tr_b16 a[216:217], v10 offset:53248
    ds_read_b64_tr_b16 a[218:219], v10 offset:55296
    ds_read_b64_tr_b16 a[220:221], v11 offset:53248
    ds_read_b64_tr_b16 a[222:223], v11 offset:55296
    s_add_u32 m0, m0, s53
    s_add_u32 s58, s58, s56
    buffer_load_dwordx4 v6, s[32:35], s58 offen lds
    ds_read_b64_tr_b16 a[224:225], v8 offset:57344
    ds_read_b64_tr_b16 a[226:227], v8 offset:59392
    ds_read_b64_tr_b16 a[228:229], v9 offset:57344
    ds_read_b64_tr_b16 a[230:231], v9 offset:59392
    ds_read_b64_tr_b16 a[232:233], v10 offset:57344
    ds_read_b64_tr_b16 a[234:235], v10 offset:59392
    ds_read_b64_tr_b16 a[236:237], v11 offset:57344
    ds_read_b64_tr_b16 a[238:239], v11 offset:59392
    s_add_u32 m0, m0, s53
    s_add_u32 s58, s58, s56
    buffer_load_dwordx4 v6, s[32:35], s58 offen lds
    ds_read_b64_tr_b16 a[240:241], v8 offset:61440
    ds_read_b64_tr_b16 a[242:243], v8 offset:63488
    ds_read_b64_tr_b16 a[244:245], v9 offset:61440
    ds_read_b64_tr_b16 a[246:247], v9 offset:63488
    ds_read_b64_tr_b16 a[248:249], v10 offset:61440
    ds_read_b64_tr_b16 a[250:251], v10 offset:63488
    ds_read_b64_tr_b16 a[252:253], v11 offset:61440
    ds_read_b64_tr_b16 a[254:255], v11 offset:63488
    s_waitcnt lgkmcnt(0)
    s_barrier
    s_add_u32 m0, m0, s53
    s_add_u32 s58, s58, s56
    buffer_load_dwordx4 v6, s[32:35], s58 offen lds
    s_add_u32 m0, m0, s53
    s_add_u32 s58, s58, s56
    buffer_load_dwordx4 v6, s[32:35], s58 offen lds
    s_add_u32 m0, m0, s53
    s_add_u32 s58, s58, s56
    buffer_load_dwordx4 v6, s[32:35], s58 offen lds
    s_add_u32 m0, s87, 45056
    s_add_u32 s58, s88, 0
    buffer_load_dwordx4 v248, s[28:31], s58 offen offset:0 lds
    v_lshrrev_b32 v19, 2, v0
    v_mul_u32_u24 v19, 224, v19
    v_and_b32 v20, 3, v0
    v_lshl_add_u32 v19, v20, 3, v19
    s_and_b32 s60, s46, 1
    s_lshl_b32 s61, s60, 5
    s_mul_i32 s60, s60, 192
    s_sub_u32 s60, 45248, s60
    s_add_u32 s61, s61, 45056
    v_add_u32 v140, s61, v19
    v_add_u32 v141, s60, v19
    v_add_u32 v142, 57344, v140
    v_add_u32 v143, 57344, v141
    s_mov_b32 s59, 0x8000
poll_40:
    buffer_load_dwordx2 v[20:21], v17, s[8:11], 0 offen sc1
    s_sub_u32 s59, s59, 1
    s_cbranch_scc1 bail
    s_waitcnt vmcnt(0)
    v_cmp_ne_u64 vcc, s[64:65], v[20:21]
    s_cbranch_vccnz poll_40
    buffer_load_dwordx4 v[56:59], v144, s[4:7], 0 offen offset:0 sc1
    buffer_load_dwordx4 v[60:63], v144, s[4:7], 0 offen offset:1024 sc1
    buffer_load_dwordx4 v[64:67], v144, s[4:7], 0 offen offset:2048 sc1
    buffer_load_dwordx4 v[68:71], v144, s[4:7], 0 offen offset:3072 sc1
    buffer_load_dwordx4 v[72:75], v145, s[4:7], s53 offen offset:0 sc1
    buffer_load_dwordx4 v[76:79], v145, s[4:7], s53 offen offset:1024 sc1
    buffer_load_dwordx4 v[80:83], v145, s[4:7], s53 offen offset:2048 sc1
    buffer_load_dwordx4 v[84:87], v145, s[4:7], s53 offen offset:3072 sc1
    buffer_load_dwordx4 v[88:91], v146, s[4:7], s54 offen offset:0 sc1
    buffer_load_dwordx4 v[92:95], v146, s[4:7], s54 offen offset:1024 sc1
    buffer_load_dwordx4 v[96:99], v146, s[4:7], s54 offen offset:2048 sc1
    buffer_load_dwordx4 v[100:103], v146, s[4:7], s54 offen offset:3072 sc1
    s_waitcnt vmcnt(11)
    v_mfma_f32_16x16x32_bf16 v[40:43], a[0:3], v[56:59], v[40:43]
    buffer_load_dwordx4 v[104:107], v147, s[4:7], s55 offen offset:0 sc1
    v_mfma_f32_16x16x32_bf16 v[44:47], a[4:7], v[56:59], v[44:47]
    v_mfma_f32_16x16x32_bf16 v[48:51], a[8:11], v[56:59], v[48:51]
    v_mfma_f32_16x16x32_bf16 v[52:55], a[12:15], v[56:59], v[52:55]
    s_waitcnt vmcnt(11)
    v_mfma_f32_16x16x32_bf16 v[40:43], a[16:19], v[60:63], v[40:43]
    buffer_load_dwordx4 v[108:111], v147, s[4:7], s55 offen offset:1024 sc1
    v_mfma_f32_16x16x32_bf16 v[44:47], a[20:23], v[60:63], v[44:47]
    v_mfma_f32_16x16x32_bf16 v[48:51], a[24:27], v[60:63], v[48:51]
    v_mfma_f32_16x16x32_bf16 v[52:55], a[28:31], v[60:63], v[52:55]
    s_waitcnt vmcnt(11)
    v_mfma_f32_16x16x32_bf16 v[40:43], a[32:35], v[64:67], v[40:43]
    buffer_load_dwordx4 v[112:115], v147, s[4:7], s55 offen offset:2048 sc1
    v_mfma_f32_16x16x32_bf16 v[44:47], a[36:39], v[64:67], v[44:47]
    v_mfma_f32_16x16x32_bf16 v[48:51], a[40:43], v[64:67], v[48:51]
    v_mfma_f32_16x16x32_bf16 v[52:55], a[44:47], v[64:67], v[52:55]
    s_waitcnt vmcnt(11)
    v_mfma_f32_16x16x32_bf16 v[40:43], a[48:51], v[68:71], v[40:43]
    buffer_load_dwordx4 v[116:119], v147, s[4:7], s55 offen offset:3072 sc1
    v_mfma_f32_16x16x32_bf16 v[44:47], a[52:55], v[68:71], v[44:47]
    v_mfma_f32_16x16x32_bf16 v[48:51], a[56:59], v[68:71], v[48:51]
    v_mfma_f32_16x16x32_bf16 v[52:55], a[60:63], v[68:71], v[52:55]
    s_waitcnt vmcnt(11)
    v_mfma_f32_16x16x32_bf16 v[40:43], a[64:67], v[72:75], v[40:43]
    v_mfma_f32_16x16x32_bf16 v[44:47], a[68:71], v[72:75], v[44:47]
    v_mfma_f32_16x16x32_bf16 v[48:51], a[72:75], v[72:75], v[48:51]
    v_mfma_f32_16x16x32_bf16 v[52:55], a[76:79], v[72:75], v[52:55]
    s_waitcnt vmcnt(10)
    v_mfma_f32_16x16x32_bf16 v[40:43], a[80:83], v[76:79], v[40:43]
    v_mfma_f32_16x16x32_bf16 v[44:47], a[84:87], v[76:79], v[44:47]
    v_mfma_f32_16x16x32_bf16 v[48:51], a[88:91], v[76:79], v[48:51]
    v_mfma_f32_16x16x32_bf16 v[52:55], a[92:95], v[76:79], v[52:55]
    s_waitcnt vmcnt(9)
    v_mfma_f32_16x16x32_bf16 v[40:43], a[96:99], v[80:83], v[40:43]
    v_mfma_f32_16x16x32_bf16 v[44:47], a[100:103], v[80:83], v[44:47]
    v_mfma_f32_16x16x32_bf16 v[48:51], a[104:107], v[80:83], v[48:51]
    v_mfma_f32_16x16x32_bf16 v[52:55], a[108:111], v[80:83], v[52:55]
    s_waitcnt vmcnt(8)
    v_mfma_f32_16x16x32_bf16 v[40:43], a[112:115], v[84:87], v[40:43]
    v_mfma_f32_16x16x32_bf16 v[44:47], a[116:119], v[84:87], v[44:47]
    v_mfma_f32_16x16x32_bf16 v[48:51], a[120:123], v[84:87], v[48:51]
    v_mfma_f32_16x16x32_bf16 v[52:55], a[124:127], v[84:87], v[52:55]
    s_waitcnt vmcnt(7)
    v_mfma_f32_16x16x32_bf16 v[40:43], a[128:131], v[88:91], v[40:43]
    buffer_load_dwordx4 v249, s[28:31], s58 offen offset:1024 lds
    v_mfma_f32_16x16x32_bf16 v[44:47], a[132:135], v[88:91], v[44:47]
    v_mfma_f32_16x16x32_bf16 v[48:51], a[136:139], v[88:91], v[48:51]
    v_mfma_f32_16x16x32_bf16 v[52:55], a[140:143], v[88:91], v[52:55]
    s_waitcnt vmcnt(7)
    v_mfma_f32_16x16x32_bf16 v[40:43], a[144:147], v[92:95], v[40:43]
    buffer_load_dwordx4 v250, s[28:31], s58 offen offset:2048 lds
    v_mfma_f32_16x16x32_bf16 v[44:47], a[148:151], v[92:95], v[44:47]
    v_mfma_f32_16x16x32_bf16 v[48:51], a[152:155], v[92:95], v[48:51]
    v_mfma_f32_16x16x32_bf16 v[52:55], a[156:159], v[92:95], v[52:55]
    s_waitcnt vmcnt(7)
    v_mfma_f32_16x16x32_bf16 v[40:43], a[160:163], v[96:99], v[40:43]
    buffer_load_dwordx4 v251, s[28:31], s58 offen offset:3072 lds
    v_mfma_f32_16x16x32_bf16 v[44:47], a[164:167], v[96:99], v[44:47]
    v_mfma_f32_16x16x32_bf16 v[48:51], a[168:171], v[96:99], v[48:51]
    v_mfma_f32_16x16x32_bf16 v[52:55], a[172:175], v[96:99], v[52:55]
    s_waitcnt vmcnt(7)
    v_mfma_f32_16x16x32_bf16 v[40:43], a[176:179], v[100:103], v[40:43]
    s_add_u32 m0, m0, s53
    s_add_u32 s58, s58, s53
    buffer_load_dwordx4 v252, s[28:31], s58 offen offset:0 lds
    v_mfma_f32_16x16x32_bf16 v[44:47], a[180:183], v[100:103], v[44:47]
    v_mfma_f32_16x16x32_bf16 v[48:51], a[184:187], v[100:103], v[48:51]
    v_mfma_f32_16x16x32_bf16 v[52:55], a[188:191], v[100:103], v[52:55]
    s_waitcnt vmcnt(7)
    v_mfma_f32_16x16x32_bf16 v[40:43], a[192:195], v[104:107], v[40:43]
    buffer_load_dwordx4 v253, s[28:31], s58 offen offset:1024 lds
    v_mfma_f32_16x16x32_bf16 v[44:47], a[196:199], v[104:107], v[44:47]
    v_mfma_f32_16x16x32_bf16 v[48:51], a[200:203], v[104:107], v[48:51]
    v_mfma_f32_16x16x32_bf16 v[52:55], a[204:207], v[104:107], v[52:55]
    s_waitcnt vmcnt(7)
    v_mfma_f32_16x16x32_bf16 v[40:43], a[208:211], v[108:111], v[40:43]
    buffer_load_dwordx4 v254, s[28:31], s58 offen offset:2048 lds
    v_mfma_f32_16x16x32_bf16 v[44:47], a[212:215], v[108:111], v[44:47]
    v_mfma_f32_16x16x32_bf16 v[48:51], a[216:219], v[108:111], v[48:51]
    v_mfma_f32_16x16x32_bf16 v[52:55], a[220:223], v[108:111], v[52:55]
    s_waitcnt vmcnt(7)
    v_mfma_f32_16x16x32_bf16 v[40:43], a[224:227], v[112:115], v[40:43]
    v_mfma_f32_16x16x32_bf16 v[44:47], a[228:231], v[112:115], v[44:47]
    v_mfma_f32_16x16x32_bf16 v[48:51], a[232:235], v[112:115], v[48:51]
    v_mfma_f32_16x16x32_bf16 v[52:55], a[236:239], v[112:115], v[52:55]
    s_waitcnt vmcnt(6)
    v_mfma_f32_16x16x32_bf16 v[40:43], a[240:243], v[116:119], v[40:43]
    v_mfma_f32_16x16x32_bf16 v[44:47], a[244:247], v[116:119], v[44:47]
    v_mfma_f32_16x16x32_bf16 v[48:51], a[248:251], v[116:119], v[48:51]
    v_mfma_f32_16x16x32_bf16 v[52:55], a[252:255], v[116:119], v[52:55]
    s_mov_b32 s60, 0
    s_mov_b32 s61, 16384
    s_nop 2
    v_cvt_pk_bf16_f32 v128, v40, v41
    v_cvt_pk_bf16_f32 v129, v42, v43
    v_cvt_pk_bf16_f32 v130, v44, v45
    v_cvt_pk_bf16_f32 v131, v46, v47
    v_cvt_pk_bf16_f32 v132, v48, v49
    v_cvt_pk_bf16_f32 v133, v50, v51
    v_cvt_pk_bf16_f32 v134, v52, v53
    v_cvt_pk_bf16_f32 v135, v54, v55
    s_cmp_eq_u32 s51, 0
    s_cbranch_scc1 sc_41
    buffer_store_dwordx4 v[128:131], v2, s[4:7], s60 offen offset:0
    buffer_store_dwordx4 v[132:135], v2, s[4:7], s60 offen offset:1024
scb_42:
    v_pk_add_f32 v[136:137], v[40:41], v[42:43]
    v_pk_mul_f32 v[138:139], v[40:41], v[40:41]
    v_pk_fma_f32 v[138:139], v[42:43], v[42:43], v[138:139]
    v_pk_add_f32 v[136:137], v[136:137], v[44:45]
    v_pk_fma_f32 v[138:139], v[44:45], v[44:45], v[138:139]
    v_pk_add_f32 v[136:137], v[136:137], v[46:47]
    v_pk_fma_f32 v[138:139], v[46:47], v[46:47], v[138:139]
    v_pk_add_f32 v[136:137], v[136:137], v[48:49]
    v_pk_fma_f32 v[138:139], v[48:49], v[48:49], v[138:139]
    v_pk_add_f32 v[136:137], v[136:137], v[50:51]
    v_pk_fma_f32 v[138:139], v[50:51], v[50:51], v[138:139]
    v_pk_add_f32 v[136:137], v[136:137], v[52:53]
    v_pk_fma_f32 v[138:139], v[52:53], v[52:53], v[138:139]
    v_pk_add_f32 v[136:137], v[136:137], v[54:55]
    v_pk_fma_f32 v[138:139], v[54:55], v[54:55], v[138:139]
    v_add_f32_e64 v136, v136, v137
    v_add_f32 v137, v138, v139
    s_nop 1
    v_permlane32_swap_b32 v136, v137
    v_add_f32 v136, v136, v137
    v_mov_b32 v137, v136
    s_nop 1
    v_permlane16_swap_b32 v136, v137
    v_add_f32 v136, v136, v137
    s_cmp_eq_u32 s51, 0
    s_cbranch_scc1 sc_43
    buffer_store_dword v136, v5, s[4:7], s61 offen
scb_44:
    v_pk_add_f32 v[24:25], v[24:25], v[40:41]
    v_pk_add_f32 v[26:27], v[26:27], v[42:43]
    v_pk_add_f32 v[28:29], v[28:29], v[44:45]
    v_pk_add_f32 v[30:31], v[30:31], v[46:47]
    v_pk_add_f32 v[32:33], v[32:33], v[48:49]
    v_pk_add_f32 v[34:35], v[34:35], v[50:51]
    v_pk_add_f32 v[36:37], v[36:37], v[52:53]
    v_pk_add_f32 v[38:39], v[38:39], v[54:55]
    v_add_u32_e64 v146, 0, v4
    v_add_u32 v147, 173056, v4
    s_mov_b32 s77, 16384
    v_add_u32 v232, 65536, v8
    v_add_u32 v233, 65536, v9
    v_add_u32 v234, 65536, v10
    v_add_u32 v235, 65536, v11
    v_add_u32 v236, 131072, v8
    v_add_u32 v237, 131072, v9
    v_add_u32 v238, 131072, v10
    v_add_u32 v239, 131072, v11
    s_add_u32 s64, s64, 1
    v_mov_b32 v21, s65
    v_mov_b32_e64 v20, s64
    s_mov_b64 exec, 1
    s_waitcnt vmcnt(0)
    s_cmp_eq_u32 s51, 0
    s_cbranch_scc1 sc_45
    buffer_store_dwordx2 v[20:21], off, s[8:11], s69
scb_46:
    s_mov_b64 exec, -1
    s_barrier
    ds_read_b64_tr_b16 a[0:1], v8 offset:0
    ds_read_b64_tr_b16 a[2:3], v8 offset:2048
    ds_read_b64_tr_b16 a[4:5], v9 offset:0
    ds_read_b64_tr_b16 a[6:7], v9 offset:2048
    ds_read_b64_tr_b16 a[8:9], v10 offset:0
    ds_read_b64_tr_b16 a[10:11], v10 offset:2048
    ds_read_b64_tr_b16 a[12:13], v11 offset:0
    ds_read_b64_tr_b16 a[14:15], v11 offset:2048
    ds_read_b64_tr_b16 a[16:17], v8 offset:4096
    ds_read_b64_tr_b16 a[18:19], v8 offset:6144
    ds_read_b64_tr_b16 a[20:21], v9 offset:4096
    ds_read_b64_tr_b16 a[22:23], v9 offset:6144
    ds_read_b64_tr_b16 a[24:25], v10 offset:4096
    ds_read_b64_tr_b16 a[26:27], v10 offset:6144
    ds_read_b64_tr_b16 a[28:29], v11 offset:4096
    ds_read_b64_tr_b16 a[30:31], v11 offset:6144
    ds_read_b64_tr_b16 a[32:33], v8 offset:8192
    ds_read_b64_tr_b16 a[34:35], v8 offset:10240
    ds_read_b64_tr_b16 a[36:37], v9 offset:8192
    ds_read_b64_tr_b16 a[38:39], v9 offset:10240
    ds_read_b64_tr_b16 a[40:41], v10 offset:8192
    ds_read_b64_tr_b16 a[42:43], v10 offset:10240
    ds_read_b64_tr_b16 a[44:45], v11 offset:8192
    ds_read_b64_tr_b16 a[46:47], v11 offset:10240
    ds_read_b64_tr_b16 a[48:49], v8 offset:12288
    ds_read_b64_tr_b16 a[50:51], v8 offset:14336
    ds_read_b64_tr_b16 a[52:53], v9 offset:12288
    ds_read_b64_tr_b16 a[54:55], v9 offset:14336
    ds_read_b64_tr_b16 a[56:57], v10 offset:12288
    ds_read_b64_tr_b16 a[58:59], v10 offset:14336
    ds_read_b64_tr_b16 a[60:61], v11 offset:12288
    ds_read_b64_tr_b16 a[62:63], v11 offset:14336
    ds_read_b64_tr_b16 a[64:65], v8 offset:16384
    ds_read_b64_tr_b16 a[66:67], v8 offset:18432
    ds_read_b64_tr_b16 a[68:69], v9 offset:16384
    ds_read_b64_tr_b16 a[70:71], v9 offset:18432
    ds_read_b64_tr_b16 a[72:73], v10 offset:16384
    ds_read_b64_tr_b16 a[74:75], v10 offset:18432
    ds_read_b64_tr_b16 a[76:77], v11 offset:16384
    ds_read_b64_tr_b16 a[78:79], v11 offset:18432
    ds_read_b64_tr_b16 a[80:81], v8 offset:20480
    ds_read_b64_tr_b16 a[82:83], v8 offset:22528
    ds_read_b64_tr_b16 a[84:85], v9 offset:20480
    ds_read_b64_tr_b16 a[86:87], v9 offset:22528
    ds_read_b64_tr_b16 a[88:89], v10 offset:20480
    ds_read_b64_tr_b16 a[90:91], v10 offset:22528
    ds_read_b64_tr_b16 a[92:93], v11 offset:20480
    ds_read_b64_tr_b16 a[94:95], v11 offset:22528
    ds_read_b64_tr_b16 a[96:97], v8 offset:24576
    ds_read_b64_tr_b16 a[98:99], v8 offset:26624
    ds_read_b64_tr_b16 a[100:101], v9 offset:24576
    ds_read_b64_tr_b16 a[102:103], v9 offset:26624
    ds_read_b64_tr_b16 a[104:105], v10 offset:24576
    ds_read_b64_tr_b16 a[106:107], v10 offset:26624
    ds_read_b64_tr_b16 a[108:109], v11 offset:24576
    ds_read_b64_tr_b16 a[110:111], v11 offset:26624
    ds_read_b64_tr_b16 a[112:113], v8 offset:28672
    ds_read_b64_tr_b16 a[114:115], v8 offset:30720
    ds_read_b64_tr_b16 a[116:117], v9 offset:28672
    ds_read_b64_tr_b16 a[118:119], v9 offset:30720
    ds_read_b64_tr_b16 a[120:121], v10 offset:28672
    ds_read_b64_tr_b16 a[122:123], v10 offset:30720
    ds_read_b64_tr_b16 a[124:125], v11 offset:28672
    ds_read_b64_tr_b16 a[126:127], v11 offset:30720
    ds_read_b64_tr_b16 a[128:129], v8 offset:32768
    ds_read_b64_tr_b16 a[130:131], v8 offset:34816
    ds_read_b64_tr_b16 a[132:133], v9 offset:32768
    ds_read_b64_tr_b16 a[134:135], v9 offset:34816
    ds_read_b64_tr_b16 a[136:137], v10 offset:32768
    ds_read_b64_tr_b16 a[138:139], v10 offset:34816
    ds_read_b64_tr_b16 a[140:141], v11 offset:32768
    ds_read_b64_tr_b16 a[142:143], v11 offset:34816
    ds_read_b64_tr_b16 a[144:145], v8 offset:36864
    ds_read_b64_tr_b16 a[146:147], v8 offset:38912
    ds_read_b64_tr_b16 a[148:149], v9 offset:36864
    ds_read_b64_tr_b16 a[150:151], v9 offset:38912
    ds_read_b64_tr_b16 a[152:153], v10 offset:36864
    ds_read_b64_tr_b16 a[154:155], v10 offset:38912
    ds_read_b64_tr_b16 a[156:157], v11 offset:36864
    ds_read_b64_tr_b16 a[158:159], v11 offset:38912
    ds_read_b64_tr_b16 a[160:161], v8 offset:40960
    ds_read_b64_tr_b16 a[162:163], v8 offset:43008
    ds_read_b64_tr_b16 a[164:165], v9 offset:40960
    ds_read_b64_tr_b16 a[166:167], v9 offset:43008
    ds_read_b64_tr_b16 a[168:169], v10 offset:40960
    ds_read_b64_tr_b16 a[170:171], v10 offset:43008
    ds_read_b64_tr_b16 a[172:173], v11 offset:40960
    ds_read_b64_tr_b16 a[174:175], v11 offset:43008
    s_mov_b32 s59, 0x8000
poll_47:
    buffer_load_dwordx2 v[20:21], v14, s[8:11], 0 offen sc1
    s_sub_u32 s59, s59, 1
    s_cbranch_scc1 bail
    s_waitcnt vmcnt(0)
    v_cmp_ne_u64 vcc, s[64:65], v[20:21]
    s_cbranch_vccnz poll_47
    buffer_load_dwordx4 v[156:159], v146, s[4:7], s77 offen sc1
    buffer_load_dwordx4 v[160:163], v147, s[4:7], s77 offen sc1
    buffer_load_dwordx4 v[168:171], v146, s[4:7], 0 offen offset:0 sc1
    buffer_load_dwordx4 a[176:179], v147, s[4:7], 0 offen offset:0 sc1
    buffer_load_dwordx4 v[172:175], v146, s[4:7], 0 offen offset:1024 sc1
    s_nop 0
    buffer_load_dwordx4 a[180:183], v147, s[4:7], 0 offen offset:1024 sc1
    buffer_load_dwordx4 v[176:179], v146, s[4:7], 0 offen offset:2048 sc1
    buffer_load_dwordx4 a[184:187], v147, s[4:7], 0 offen offset:2048 sc1
    buffer_load_dwordx4 v[180:183], v146, s[4:7], 0 offen offset:3072 sc1
    buffer_load_dwordx4 a[188:191], v147, s[4:7], 0 offen offset:3072 sc1
    s_waitcnt lgkmcnt(0)
    s_cmp_lg_u32 s50, 0
    s_cbranch_scc1 l0_48
    v_add_u32 v40, s87, v140
    v_mov_b32 v44, 0x3f803f80
    v_add_u32 v41, s87, v141
    v_mov_b32 v45, 0x3f803f80
    v_add_u32 v42, s87, v142
    v_mov_b32 v46, 0x3f803f80
    v_add_u32_e64 v43, s87, v143
    v_mov_b32 v47, 0x3f803f80
    ds_read_b64_tr_b16 v[112:113], v40 offset:0
    ds_read_b64_tr_b16 v[114:115], v40 offset:3584
    ds_read_b64_tr_b16 v[116:117], v40 offset:32
    ds_read_b64_tr_b16 v[118:119], v40 offset:3616
    ds_read_b64_tr_b16 v[120:121], v40 offset:64
    ds_read_b64_tr_b16 v[122:123], v40 offset:3648
    ds_read_b64_tr_b16 v[124:125], v40 offset:96
    ds_read_b64_tr_b16 v[126:127], v40 offset:3680
    ds_read_b64_tr_b16 v[128:129], v40 offset:128
    ds_read_b64_tr_b16 v[130:131], v40 offset:3712
    ds_read_b64_tr_b16 v[132:133], v40 offset:160
    ds_read_b64_tr_b16 v[134:135], v40 offset:3744
    s_waitcnt lgkmcnt(10)
    v_mfma_f32_16x16x32_bf16 v[56:59], v[44:47], v[112:115], 0
    ds_read_b64_tr_b16 v[112:113], v41 offset:0
    ds_read_b64_tr_b16 v[114:115], v41 offset:3584
    s_waitcnt lgkmcnt(10)
    v_mfma_f32_16x16x32_bf16 v[60:63], v[44:47], v[116:119], 0
    ds_read_b64_tr_b16 v[116:117], v40 offset:28672
    ds_read_b64_tr_b16 v[118:119], v40 offset:32256
    s_waitcnt lgkmcnt(10)
    v_mfma_f32_16x16x32_bf16 v[64:67], v[44:47], v[120:123], 0
    ds_read_b64_tr_b16 v[120:121], v40 offset:28704
    ds_read_b64_tr_b16 v[122:123], v40 offset:32288
    s_waitcnt lgkmcnt(10)
    v_mfma_f32_16x16x32_bf16 v[68:71], v[44:47], v[124:127], 0
    ds_read_b64_tr_b16 v[124:125], v40 offset:28736
    ds_read_b64_tr_b16 v[126:127], v40 offset:32320
    s_waitcnt lgkmcnt(10)
    v_mfma_f32_16x16x32_bf16 v[72:75], v[44:47], v[128:131], 0
    ds_read_b64_tr_b16 v[128:129], v40 offset:28768
    ds_read_b64_tr_b16 v[130:131], v40 offset:32352
    s_waitcnt lgkmcnt(10)
    v_mfma_f32_16x16x32_bf16 v[76:79], v[44:47], v[132:135], 0
    ds_read_b64_tr_b16 v[132:133], v40 offset:28800
    ds_read_b64_tr_b16 v[134:135], v40 offset:32384
    s_waitcnt lgkmcnt(10)
    v_mfma_f32_16x16x32_bf16 v[80:83], v[44:47], v[112:115], 0
    ds_read_b64_tr_b16 v[112:113], v40 offset:28832
    ds_read_b64_tr_b16 v[114:115], v40 offset:32416
    s_waitcnt lgkmcnt(10)
    v_mfma_f32_16x16x32_bf16 v[56:59], v[44:47], v[116:119], v[56:59]
    ds_read_b64_tr_b16 v[116:117], v41 offset:28672
    ds_read_b64_tr_b16 v[118:119], v41 offset:32256
    s_waitcnt lgkmcnt(10)
    v_mfma_f32_16x16x32_bf16 v[60:63], v[44:47], v[120:123], v[60:63]
    ds_read_b64_tr_b16 v[120:121], v42 offset:0
    ds_read_b64_tr_b16 v[122:123], v42 offset:3584
    s_waitcnt lgkmcnt(10)
    v_mfma_f32_16x16x32_bf16 v[64:67], v[44:47], v[124:127], v[64:67]
    ds_read_b64_tr_b16 v[124:125], v42 offset:32
    ds_read_b64_tr_b16 v[126:127], v42 offset:3616
    s_waitcnt lgkmcnt(10)
    v_mfma_f32_16x16x32_bf16 v[68:71], v[44:47], v[128:131], v[68:71]
    ds_read_b64_tr_b16 v[128:129], v42 offset:64
    ds_read_b64_tr_b16 v[130:131], v42 offset:3648
    s_waitcnt lgkmcnt(10)
    v_mfma_f32_16x16x32_bf16 v[72:75], v[44:47], v[132:135], v[72:75]
    ds_read_b64_tr_b16 v[132:133], v42 offset:96
    ds_read_b64_tr_b16 v[134:135], v42 offset:3680
    s_waitcnt lgkmcnt(10)
    v_mfma_f32_16x16x32_bf16 v[76:79], v[44:47], v[112:115], v[76:79]
    ds_read_b64_tr_b16 v[112:113], v42 offset:128
    ds_read_b64_tr_b16 v[114:115], v42 offset:3712
    s_waitcnt lgkmcnt(10)
    v_mfma_f32_16x16x32_bf16 v[80:83], v[44:47], v[116:119], v[80:83]
    ds_read_b64_tr_b16 v[116:117], v42 offset:160
    ds_read_b64_tr_b16 v[118:119], v42 offset:3744
    s_waitcnt lgkmcnt(10)
    v_mfma_f32_16x16x32_bf16 v[56:59], v[44:47], v[120:123], v[56:59]
    ds_read_b64_tr_b16 v[120:121], v43 offset:0
    ds_read_b64_tr_b16 v[122:123], v43 offset:3584
    s_waitcnt lgkmcnt(10)
    v_mfma_f32_16x16x32_bf16 v[60:63], v[44:47], v[124:127], v[60:63]
    ds_read_b64_tr_b16 v[124:125], v42 offset:28672
    ds_read_b64_tr_b16 v[126:127], v42 offset:32256
    s_waitcnt lgkmcnt(10)
    v_mfma_f32_16x16x32_bf16 v[64:67], v[44:47], v[128:131], v[64:67]
    ds_read_b64_tr_b16 v[128:129], v42 offset:28704
    ds_read_b64_tr_b16 v[130:131], v42 offset:32288
    s_waitcnt lgkmcnt(10)
    v_mfma_f32_16x16x32_bf16 v[68:71], v[44:47], v[132:135], v[68:71]
    ds_read_b64_tr_b16 v[132:133], v42 offset:28736
    ds_read_b64_tr_b16 v[134:135], v42 offset:32320
    s_waitcnt lgkmcnt(10)
    v_mfma_f32_16x16x32_bf16 v[72:75], v[44:47], v[112:115], v[72:75]
    ds_read_b64_tr_b16 v[112:113], v42 offset:28768
    ds_read_b64_tr_b16 v[114:115], v42 offset:32352
    s_waitcnt lgkmcnt(10)
    v_mfma_f32_16x16x32_bf16 v[76:79], v[44:47], v[116:119], v[76:79]
    ds_read_b64_tr_b16 v[116:117], v42 offset:28800
    ds_read_b64_tr_b16 v[118:119], v42 offset:32384
    s_waitcnt lgkmcnt(10)
    v_mfma_f32_16x16x32_bf16 v[80:83], v[44:47], v[120:123], v[80:83]
    ds_read_b64_tr_b16 v[120:121], v42 offset:28832
    ds_read_b64_tr_b16 v[122:123], v42 offset:32416
    s_waitcnt lgkmcnt(10)
    v_mfma_f32_16x16x32_bf16 v[56:59], v[44:47], v[124:127], v[56:59]
    ds_read_b64_tr_b16 v[124:125], v43 offset:28672
    ds_read_b64_tr_b16 v[126:127], v43 offset:32256
    s_waitcnt lgkmcnt(10)
    v_mfma_f32_16x16x32_bf16 v[60:63], v[44:47], v[128:131], v[60:63]
    s_waitcnt lgkmcnt(8)
    v_mfma_f32_16x16x32_bf16 v[64:67], v[44:47], v[132:135], v[64:67]
    s_waitcnt lgkmcnt(6)
    v_mfma_f32_16x16x32_bf16 v[68:71], v[44:47], v[112:115], v[68:71]
    s_waitcnt lgkmcnt(4)
    v_mfma_f32_16x16x32_bf16 v[72:75], v[44:47], v[116:119], v[72:75]
    s_waitcnt lgkmcnt(2)
    v_mfma_f32_16x16x32_bf16 v[76:79], v[44:47], v[120:123], v[76:79]
    s_waitcnt lgkmcnt(0)
    v_mfma_f32_16x16x32_bf16 v[80:83], v[44:47], v[124:127], v[80:83]
    s_mul_i32 s60, s44, 448
    s_add_u32 s60, s60, 159744
    v_and_b32_e64 v20, 15, v0
    v_lshl_add_u32 v20, v20, 2, s60
    ds_write_b32 v20, v56 offset:0
    ds_write_b32 v20, v60 offset:64
    ds_write_b32 v20, v64 offset:128
    ds_write_b32 v20, v68 offset:192
    ds_write_b32 v20, v72 offset:256
    ds_write_b32 v20, v76 offset:320
    ds_write_b32 v20, v80 offset:384
    s_waitcnt lgkmcnt(0)
l0_48:
    s_barrier
    s_cmp_lg_u32 s50, 0
    s_cbranch_scc1 l0_49
    v_min_u32 v19, 27, v0
    v_lshlrev_b32 v19, 4, v19
    v_add_u32 v19, 159744, v19
    ds_read_b128 v[112:115], v19 offset:0
    ds_read_b128 v[116:119], v19 offset:448
    ds_read_b128 v[120:123], v19 offset:896
    ds_read_b128 v[124:127], v19 offset:1344
    s_waitcnt lgkmcnt(0)
    v_pk_add_f32 v[112:113], v[112:113], v[116:117]
    v_pk_add_f32 v[114:115], v[114:115], v[118:119]
    v_pk_add_f32 v[112:113], v[112:113], v[120:121]
    v_pk_add_f32 v[114:115], v[114:115], v[122:123]
    v_pk_add_f32 v[112:113], v[112:113], v[124:125]
    v_pk_add_f32 v[114:115], v[114:115], v[126:127]
    ds_write_b128 v19, v[112:115] offset:2560
    s_waitcnt lgkmcnt(0)
l0_49:
    ds_read_b64_tr_b16 v[112:113], v140 offset:0
    ds_read_b64_tr_b16 v[114:115], v140 offset:3584
    ds_read_b64_tr_b16 v[116:117], v140 offset:32
    ds_read_b64_tr_b16 v[118:119], v140 offset:3616
    ds_read_b64_tr_b16 v[120:121], v140 offset:64
    ds_read_b64_tr_b16 v[122:123], v140 offset:3648
    ds_read_b64_tr_b16 v[124:125], v140 offset:96
    ds_read_b64_tr_b16 v[126:127], v140 offset:3680
    ds_read_b64_tr_b16 v[128:129], v140 offset:128
    ds_read_b64_tr_b16 v[130:131], v140 offset:3712
    s_waitcnt vmcnt(6) lgkmcnt(6)
    v_mfma_f32_16x16x32_bf16 v[56:59], v[112:115], v[168:171], 0
    ds_read_b64_tr_b16 v[132:133], v140 offset:160
    ds_read_b64_tr_b16 v[134:135], v140 offset:3744
    v_mfma_f32_16x16x32_bf16 v[84:87], v[112:115], a[176:179], 0
    v_add_f32 v156, v156, v158
    v_mfma_f32_16x16x32_bf16 v[60:63], v[116:119], v[168:171], 0
    ds_read_b64_tr_b16 v[136:137], v141 offset:0
    ds_read_b64_tr_b16 v[138:139], v141 offset:3584
    v_mfma_f32_16x16x32_bf16 v[88:91], v[116:119], a[176:179], 0
    buffer_load_dwordx4 v[184:187], v146, s[4:7], s53 offen offset:0 sc1
    s_waitcnt lgkmcnt(6)
    v_mfma_f32_16x16x32_bf16 v[64:67], v[120:123], v[168:171], 0
    ds_read_b64_tr_b16 v[112:113], v140 offset:7168
    ds_read_b64_tr_b16 v[114:115], v140 offset:10752
    v_mfma_f32_16x16x32_bf16 v[92:95], v[120:123], a[176:179], 0
    v_add_f32 v157, v157, v159
    v_mfma_f32_16x16x32_bf16 v[68:71], v[124:127], v[168:171], 0
    ds_read_b64_tr_b16 v[116:117], v140 offset:7200
    ds_read_b64_tr_b16 v[118:119], v140 offset:10784
    v_mfma_f32_16x16x32_bf16 v[96:99], v[124:127], a[176:179], 0
    buffer_load_dwordx4 a[192:195], v147, s[4:7], s53 offen offset:0 sc1
    s_waitcnt lgkmcnt(6)
    v_mfma_f32_16x16x32_bf16 v[72:75], v[128:131], v[168:171], 0
    ds_read_b64_tr_b16 v[120:121], v140 offset:7232
    ds_read_b64_tr_b16 v[122:123], v140 offset:10816
    v_mfma_f32_16x16x32_bf16 v[100:103], v[128:131], a[176:179], 0
    v_permlane32_swap_b32 v156, v157
    v_mfma_f32_16x16x32_bf16 v[76:79], v[132:135], v[168:171], 0
    ds_read_b64_tr_b16 v[124:125], v140 offset:7264
    ds_read_b64_tr_b16 v[126:127], v140 offset:10848
    v_mfma_f32_16x16x32_bf16 v[104:107], v[132:135], a[176:179], 0
    buffer_load_dwordx4 v[188:191], v146, s[4:7], s53 offen offset:1024 sc1
    s_waitcnt lgkmcnt(6)
    v_mfma_f32_16x16x32_bf16 v[80:83], v[136:139], v[168:171], 0
    ds_read_b64_tr_b16 v[128:129], v140 offset:7296
    ds_read_b64_tr_b16 v[130:131], v140 offset:10880
    v_mfma_f32_16x16x32_bf16 v[108:111], v[136:139], a[176:179], 0
    v_add_f32 v156, v156, v157
    s_waitcnt vmcnt(7)
    v_mfma_f32_16x16x32_bf16 v[56:59], v[112:115], v[172:175], v[56:59]
    ds_read_b64_tr_b16 v[132:133], v140 offset:7328
    ds_read_b64_tr_b16 v[134:135], v140 offset:10912
    v_mfma_f32_16x16x32_bf16 v[84:87], v[112:115], a[180:183], v[84:87]
    buffer_load_dwordx4 a[196:199], v147, s[4:7], s53 offen offset:1024 sc1
    s_waitcnt lgkmcnt(6)
    v_mfma_f32_16x16x32_bf16 v[60:63], v[116:119], v[172:175], v[60:63]
    ds_read_b64_tr_b16 v[136:137], v141 offset:7168
    ds_read_b64_tr_b16 v[138:139], v141 offset:10752
    v_mfma_f32_16x16x32_bf16 v[88:91], v[116:119], a[180:183], v[88:91]
    v_mov_b32 v157, v156
    v_mfma_f32_16x16x32_bf16 v[64:67], v[120:123], v[172:175], v[64:67]
    ds_read_b64_tr_b16 v[112:113], v140 offset:14336
    ds_read_b64_tr_b16 v[114:115], v140 offset:17920
    v_mfma_f32_16x16x32_bf16 v[92:95], v[120:123], a[180:183], v[92:95]
    buffer_load_dwordx4 v[192:195], v146, s[4:7], s53 offen offset:2048 sc1
    s_waitcnt lgkmcnt(6)
    v_mfma_f32_16x16x32_bf16 v[68:71], v[124:127], v[172:175], v[68:71]
    ds_read_b64_tr_b16 v[116:117], v140 offset:14368
    ds_read_b64_tr_b16 v[118:119], v140 offset:17952
    v_mfma_f32_16x16x32_bf16 v[96:99], v[124:127], a[180:183], v[96:99]
    v_permlane16_swap_b32 v156, v157
    v_mfma_f32_16x16x32_bf16 v[72:75], v[128:131], v[172:175], v[72:75]
    ds_read_b64_tr_b16 v[120:121], v140 offset:14400
    ds_read_b64_tr_b16 v[122:123], v140 offset:17984
    v_mfma_f32_16x16x32_bf16 v[100:103], v[128:131], a[180:183], v[100:103]
    buffer_load_dwordx4 a[200:203], v147, s[4:7], s53 offen offset:2048 sc1
    s_waitcnt lgkmcnt(6)
    v_mfma_f32_16x16x32_bf16 v[76:79], v[132:135], v[172:175], v[76:79]
    ds_read_b64_tr_b16 v[124:125], v140 offset:14432
    ds_read_b64_tr_b16 v[126:127], v140 offset:18016
    v_mfma_f32_16x16x32_bf16 v[104:107], v[132:135], a[180:183], v[104:107]
    v_add_f32 v156, v156, v157
    v_mfma_f32_16x16x32_bf16 v[80:83], v[136:139], v[172:175], v[80:83]
    ds_read_b64_tr_b16 v[128:129], v140 offset:14464
    ds_read_b64_tr_b16 v[130:131], v140 offset:18048
    v_mfma_f32_16x16x32_bf16 v[108:111], v[136:139], a[180:183], v[108:111]
    buffer_load_dwordx4 v[196:199], v146, s[4:7], s53 offen offset:3072 sc1
    s_waitcnt vmcnt(9) lgkmcnt(6)
    v_mfma_f32_16x16x32_bf16 v[56:59], v[112:115], v[176:179], v[56:59]
    ds_read_b64_tr_b16 v[132:133], v140 offset:14496
    ds_read_b64_tr_b16 v[134:135], v140 offset:18080
    v_mfma_f32_16x16x32_bf16 v[84:87], v[112:115], a[184:187], v[84:87]
    v_mov_b32 v157, v156
    v_mfma_f32_16x16x32_bf16 v[60:63], v[116:119], v[176:179], v[60:63]
    ds_read_b64_tr_b16 v[136:137], v141 offset:14336
    ds_read_b64_tr_b16 v[138:139], v141 offset:17920
    v_mfma_f32_16x16x32_bf16 v[88:91], v[116:119], a[184:187], v[88:91]
    buffer_load_dwordx4 a[204:207], v147, s[4:7], s53 offen offset:3072 sc1
    s_waitcnt lgkmcnt(6)
    v_mfma_f32_16x16x32_bf16 v[64:67], v[120:123], v[176:179], v[64:67]
    ds_read_b64_tr_b16 v[112:113], v140 offset:21504
    ds_read_b64_tr_b16 v[114:115], v140 offset:25088
    v_mfma_f32_16x16x32_bf16 v[92:95], v[120:123], a[184:187], v[92:95]
    v_permlane32_swap_b32 v156, v157
    v_mfma_f32_16x16x32_bf16 v[68:71], v[124:127], v[176:179], v[68:71]
    ds_read_b64_tr_b16 v[116:117], v140 offset:21536
    ds_read_b64_tr_b16 v[118:119], v140 offset:25120
    v_mfma_f32_16x16x32_bf16 v[96:99], v[124:127], a[184:187], v[96:99]
    buffer_load_dwordx4 v[200:203], v146, s[4:7], s54 offen offset:0 sc1
    s_waitcnt lgkmcnt(6)
    v_mfma_f32_16x16x32_bf16 v[72:75], v[128:131], v[176:179], v[72:75]
    ds_read_b64_tr_b16 v[120:121], v140 offset:21568
    ds_read_b64_tr_b16 v[122:123], v140 offset:25152
    v_mfma_f32_16x16x32_bf16 v[100:103], v[128:131], a[184:187], v[100:103]
    v_mul_f32 v241, 0xbb000000, v156
    v_mfma_f32_16x16x32_bf16 v[76:79], v[132:135], v[176:179], v[76:79]
    ds_read_b64_tr_b16 v[124:125], v140 offset:21600
    ds_read_b64_tr_b16 v[126:127], v140 offset:25184
    v_mfma_f32_16x16x32_bf16 v[104:107], v[132:135], a[184:187], v[104:107]
    buffer_load_dwordx4 a[208:211], v147, s[4:7], s54 offen offset:0 sc1
    s_waitcnt lgkmcnt(6)
    v_mfma_f32_16x16x32_bf16 v[80:83], v[136:139], v[176:179], v[80:83]
    ds_read_b64_tr_b16 v[128:129], v140 offset:21632
    ds_read_b64_tr_b16 v[130:131], v140 offset:25216
    v_mfma_f32_16x16x32_bf16 v[108:111], v[136:139], a[184:187], v[108:111]
    v_mul_f32 v157, 0x3b000000, v157
    s_waitcnt vmcnt(10)
    v_mfma_f32_16x16x32_bf16 v[56:59], v[112:115], v[180:183], v[56:59]
    ds_read_b64_tr_b16 v[132:133], v140 offset:21664
    ds_read_b64_tr_b16 v[134:135], v140 offset:25248
    v_mfma_f32_16x16x32_bf16 v[84:87], v[112:115], a[188:191], v[84:87]
    buffer_load_dwordx4 v[204:207], v146, s[4:7], s54 offen offset:1024 sc1
    s_waitcnt lgkmcnt(6)
    v_mfma_f32_16x16x32_bf16 v[60:63], v[116:119], v[180:183], v[60:63]
    ds_read_b64_tr_b16 v[136:137], v141 offset:21504
    ds_read_b64_tr_b16 v[138:139], v141 offset:25088
    v_mfma_f32_16x16x32_bf16 v[88:91], v[116:119], a[188:191], v[88:91]
    v_fma_f32 v157, -v241, v241, v157
    v_mfma_f32_16x16x32_bf16 v[64:67], v[120:123], v[180:183], v[64:67]
    ds_read_b64_tr_b16 v[112:113], v140 offset:28672
    ds_read_b64_tr_b16 v[114:115], v140 offset:32256
    v_mfma_f32_16x16x32_bf16 v[92:95], v[120:123], a[188:191], v[92:95]
    buffer_load_dwordx4 a[212:215], v147, s[4:7], s54 offen offset:1024 sc1
    s_waitcnt lgkmcnt(6)
    v_mfma_f32_16x16x32_bf16 v[68:71], v[124:127], v[180:183], v[68:71]
    ds_read_b64_tr_b16 v[116:117], v140 offset:28704
    ds_read_b64_tr_b16 v[118:119], v140 offset:32288
    v_mfma_f32_16x16x32_bf16 v[96:99], v[124:127], a[188:191], v[96:99]
    v_max_f32 v242, 0, v157
    v_mfma_f32_16x16x32_bf16 v[72:75], v[128:131], v[180:183], v[72:75]
    ds_read_b64_tr_b16 v[120:121], v140 offset:28736
    ds_read_b64_tr_b16 v[122:123], v140 offset:32320
    v_mfma_f32_16x16x32_bf16 v[100:103], v[128:131], a[188:191], v[100:103]
    buffer_load_dwordx4 v[208:211], v146, s[4:7], s54 offen offset:2048 sc1
    s_waitcnt lgkmcnt(6)
    v_mfma_f32_16x16x32_bf16 v[76:79], v[132:135], v[180:183], v[76:79]
    ds_read_b64_tr_b16 v[124:125], v140 offset:28768
    ds_read_b64_tr_b16 v[126:127], v140 offset:32352
    v_mfma_f32_16x16x32_bf16 v[104:107], v[132:135], a[188:191], v[104:107]
    v_add_f32 v157, 0x3727c5ac, v242
    v_mfma_f32_16x16x32_bf16 v[80:83], v[136:139], v[180:183], v[80:83]
    ds_read_b64_tr_b16 v[128:129], v140 offset:28800
    ds_read_b64_tr_b16 v[130:131], v140 offset:32384
    v_mfma_f32_16x16x32_bf16 v[108:111], v[136:139], a[188:191], v[108:111]
    buffer_load_dwordx4 a[216:219], v147, s[4:7], s54 offen offset:2048 sc1
    s_waitcnt vmcnt(12) lgkmcnt(6)
    v_mfma_f32_16x16x32_bf16 v[56:59], v[112:115], v[184:187], v[56:59]
    ds_read_b64_tr_b16 v[132:133], v140 offset:28832
    ds_read_b64_tr_b16 v[134:135], v140 offset:32416
    v_mfma_f32_16x16x32_bf16 v[84:87], v[112:115], a[192:195], v[84:87]
    v_rsq_f32 v240, v157
    v_mfma_f32_16x16x32_bf16 v[60:63], v[116:119], v[184:187], v[60:63]
    ds_read_b64_tr_b16 v[136:137], v141 offset:28672
    ds_read_b64_tr_b16 v[138:139], v141 offset:32256
    v_mfma_f32_16x16x32_bf16 v[88:91], v[116:119], a[192:195], v[88:91]
    buffer_load_dwordx4 v[212:215], v146, s[4:7], s54 offen offset:3072 sc1
    s_waitcnt lgkmcnt(6)
    v_mfma_f32_16x16x32_bf16 v[64:67], v[120:123], v[184:187], v[64:67]
    ds_read_b64_tr_b16 v[112:113], v140 offset:35840
    ds_read_b64_tr_b16 v[114:115], v140 offset:39424
    v_mfma_f32_16x16x32_bf16 v[92:95], v[120:123], a[192:195], v[92:95]
    v_rcp_f32 v150, v240
    v_mfma_f32_16x16x32_bf16 v[68:71], v[124:127], v[184:187], v[68:71]
    ds_read_b64_tr_b16 v[116:117], v140 offset:35872
    ds_read_b64_tr_b16 v[118:119], v140 offset:39456
    v_mfma_f32_16x16x32_bf16 v[96:99], v[124:127], a[192:195], v[96:99]
    buffer_load_dwordx4 a[220:223], v147, s[4:7], s54 offen offset:3072 sc1
    s_waitcnt lgkmcnt(6)
    v_mfma_f32_16x16x32_bf16 v[72:75], v[128:131], v[184:187], v[72:75]
    ds_read_b64_tr_b16 v[120:121], v140 offset:35904
    ds_read_b64_tr_b16 v[122:123], v140 offset:39488
    v_mfma_f32_16x16x32_bf16 v[100:103], v[128:131], a[192:195], v[100:103]
    v_mul_f32 v149, 0xc0135761, v240
    v_mfma_f32_16x16x32_bf16 v[76:79], v[132:135], v[184:187], v[76:79]
    ds_read_b64_tr_b16 v[124:125], v140 offset:35936
    ds_read_b64_tr_b16 v[126:127], v140 offset:39520
    v_mfma_f32_16x16x32_bf16 v[104:107], v[132:135], a[192:195], v[104:107]
    buffer_load_dwordx4 v[216:219], v146, s[4:7], s55 offen offset:0 sc1
    s_waitcnt lgkmcnt(6)
    v_mfma_f32_16x16x32_bf16 v[80:83], v[136:139], v[184:187], v[80:83]
    ds_read_b64_tr_b16 v[128:129], v140 offset:35968
    ds_read_b64_tr_b16 v[130:131], v140 offset:39552
    v_mfma_f32_16x16x32_bf16 v[108:111], v[136:139], a[192:195], v[108:111]
    v_mul_f32 v148, v240, v240
    s_waitcnt vmcnt(13)
    v_mfma_f32_16x16x32_bf16 v[56:59], v[112:115], v[188:191], v[56:59]
    ds_read_b64_tr_b16 v[132:133], v140 offset:36000
    ds_read_b64_tr_b16 v[134:135], v140 offset:39584
    v_mfma_f32_16x16x32_bf16 v[84:87], v[112:115], a[196:199], v[84:87]
    buffer_load_dwordx4 a[224:227], v147, s[4:7], s55 offen offset:0 sc1
    s_waitcnt lgkmcnt(6)
    v_mfma_f32_16x16x32_bf16 v[60:63], v[116:119], v[188:191], v[60:63]
    ds_read_b64_tr_b16 v[136:137], v141 offset:35840
    ds_read_b64_tr_b16 v[138:139], v141 offset:39424
    v_mfma_f32_16x16x32_bf16 v[88:91], v[116:119], a[196:199], v[88:91]
    v_mul_f32 v148, 0x3d372713, v148
    v_mfma_f32_16x16x32_bf16 v[64:67], v[120:123], v[188:191], v[64:67]
    ds_read_b64_tr_b16 v[112:113], v140 offset:43008
    ds_read_b64_tr_b16 v[114:115], v140 offset:46592
    v_mfma_f32_16x16x32_bf16 v[92:95], v[120:123], a[196:199], v[92:95]
    buffer_load_dwordx4 v[220:223], v146, s[4:7], s55 offen offset:1024 sc1
    s_waitcnt lgkmcnt(6)
    v_mfma_f32_16x16x32_bf16 v[68:71], v[124:127], v[188:191], v[68:71]
    ds_read_b64_tr_b16 v[116:117], v140 offset:43040
    ds_read_b64_tr_b16 v[118:119], v140 offset:46624
    v_mfma_f32_16x16x32_bf16 v[96:99], v[124:127], a[196:199], v[96:99]
    v_mul_f32 v148, v148, v149
    v_mfma_f32_16x16x32_bf16 v[72:75], v[128:131], v[188:191], v[72:75]
    ds_read_b64_tr_b16 v[120:121], v140 offset:43072
    ds_read_b64_tr_b16 v[122:123], v140 offset:46656
    v_mfma_f32_16x16x32_bf16 v[100:103], v[128:131], a[196:199], v[100:103]
    buffer_load_dwordx4 a[228:231], v147, s[4:7], s55 offen offset:1024 sc1
    s_waitcnt lgkmcnt(6)
    v_mfma_f32_16x16x32_bf16 v[76:79], v[132:135], v[188:191], v[76:79]
    ds_read_b64_tr_b16 v[124:125], v140 offset:43104
    ds_read_b64_tr_b16 v[126:127], v140 offset:46688
    v_mfma_f32_16x16x32_bf16 v[104:107], v[132:135], a[196:199], v[104:107]
    v_add_f32 v160, v160, v162
    v_mfma_f32_16x16x32_bf16 v[80:83], v[136:139], v[188:191], v[80:83]
    ds_read_b64_tr_b16 v[128:129], v140 offset:43136
    ds_read_b64_tr_b16 v[130:131], v140 offset:46720
    v_mfma_f32_16x16x32_bf16 v[108:111], v[136:139], a[196:199], v[108:111]
    buffer_load_dwordx4 v[224:227], v146, s[4:7], s55 offen offset:2048 sc1
    s_waitcnt vmcnt(15) lgkmcnt(6)
    v_mfma_f32_16x16x32_bf16 v[56:59], v[112:115], v[192:195], v[56:59]
    ds_read_b64_tr_b16 v[132:133], v140 offset:43168
    ds_read_b64_tr_b16 v[134:135], v140 offset:46752
    v_mfma_f32_16x16x32_bf16 v[84:87], v[112:115], a[200:203], v[84:87]
    v_add_f32 v161, v161, v163
    v_mfma_f32_16x16x32_bf16 v[60:63], v[116:119], v[192:195], v[60:63]
    ds_read_b64_tr_b16 v[136:137], v141 offset:43008
    ds_read_b64_tr_b16 v[138:139], v141 offset:46592
    v_mfma_f32_16x16x32_bf16 v[88:91], v[116:119], a[200:203], v[88:91]
    buffer_load_dwordx4 a[232:235], v147, s[4:7], s55 offen offset:2048 sc1
    s_waitcnt lgkmcnt(6)
    v_mfma_f32_16x16x32_bf16 v[64:67], v[120:123], v[192:195], v[64:67]
    ds_read_b64_tr_b16 v[112:113], v140 offset:50176
    ds_read_b64_tr_b16 v[114:115], v140 offset:53760
    v_mfma_f32_16x16x32_bf16 v[92:95], v[120:123], a[200:203], v[92:95]
    v_permlane32_swap_b32 v160, v161
    v_mfma_f32_16x16x32_bf16 v[68:71], v[124:127], v[192:195], v[68:71]
    ds_read_b64_tr_b16 v[116:117], v140 offset:50208
    ds_read_b64_tr_b16 v[118:119], v140 offset:53792
    v_mfma_f32_16x16x32_bf16 v[96:99], v[124:127], a[200:203], v[96:99]
    buffer_load_dwordx4 v[228:231], v146, s[4:7], s55 offen offset:3072 sc1
    s_waitcnt lgkmcnt(6)
    v_mfma_f32_16x16x32_bf16 v[72:75], v[128:131], v[192:195], v[72:75]
    ds_read_b64_tr_b16 v[120:121], v140 offset:50240
    ds_read_b64_tr_b16 v[122:123], v140 offset:53824
    v_mfma_f32_16x16x32_bf16 v[100:103], v[128:131], a[200:203], v[100:103]
    v_add_f32 v160, v160, v161
    v_mfma_f32_16x16x32_bf16 v[76:79], v[132:135], v[192:195], v[76:79]
    ds_read_b64_tr_b16 v[124:125], v140 offset:50272
    ds_read_b64_tr_b16 v[126:127], v140 offset:53856
    v_mfma_f32_16x16x32_bf16 v[104:107], v[132:135], a[200:203], v[104:107]
    buffer_load_dwordx4 a[236:239], v147, s[4:7], s55 offen offset:3072 sc1
    s_waitcnt lgkmcnt(6)
    v_mfma_f32_16x16x32_bf16 v[80:83], v[136:139], v[192:195], v[80:83]
    ds_read_b64_tr_b16 v[128:129], v140 offset:50304
    ds_read_b64_tr_b16 v[130:131], v140 offset:53888
    v_mfma_f32_16x16x32_bf16 v[108:111], v[136:139], a[200:203], v[108:111]
    v_mov_b32 v161, v160
    s_waitcnt vmcnt(16)
    v_mfma_f32_16x16x32_bf16 v[56:59], v[112:115], v[196:199], v[56:59]
    ds_read_b64_tr_b16 v[132:133], v140 offset:50336
    ds_read_b64_tr_b16 v[134:135], v140 offset:53920
    v_mfma_f32_16x16x32_bf16 v[84:87], v[112:115], a[204:207], v[84:87]
    s_add_u32 m0, s68, 0
    s_mov_b32 s58, 360448
    buffer_load_dwordx4 v6, s[32:35], s58 offen lds
    s_waitcnt lgkmcnt(6)
    v_mfma_f32_16x16x32_bf16 v[60:63], v[116:119], v[196:199], v[60:63]
    ds_read_b64_tr_b16 v[136:137], v141 offset:50176
    ds_read_b64_tr_b16 v[138:139], v141 offset:53760
    v_mfma_f32_16x16x32_bf16 v[88:91], v[116:119], a[204:207], v[88:91]
    v_permlane16_swap_b32 v160, v161
    v_mfma_f32_16x16x32_bf16 v[64:67], v[120:123], v[196:199], v[64:67]
    ds_read_b64_tr_b16 v[112:113], v142 offset:0
    ds_read_b64_tr_b16 v[114:115], v142 offset:3584
    v_mfma_f32_16x16x32_bf16 v[92:95], v[120:123], a[204:207], v[92:95]
    s_add_u32 m0, m0, s53
    s_add_u32 s58, s58, s56
    buffer_load_dwordx4 v6, s[32:35], s58 offen lds
    s_waitcnt lgkmcnt(6)
    v_mfma_f32_16x16x32_bf16 v[68:71], v[124:127], v[196:199], v[68:71]
    ds_read_b64_tr_b16 v[116:117], v142 offset:32
    ds_read_b64_tr_b16 v[118:119], v142 offset:3616
    v_mfma_f32_16x16x32_bf16 v[96:99], v[124:127], a[204:207], v[96:99]
    v_add_f32 v160, v160, v161
    v_mfma_f32_16x16x32_bf16 v[72:75], v[128:131], v[196:199], v[72:75]
    ds_read_b64_tr_b16 v[120:121], v142 offset:64
    ds_read_b64_tr_b16 v[122:123], v142 offset:3648
    v_mfma_f32_16x16x32_bf16 v[100:103], v[128:131], a[204:207], v[100:103]
    s_add_u32 m0, m0, s53
    s_add_u32 s58, s58, s56
    buffer_load_dwordx4 v6, s[32:35], s58 offen lds
    s_waitcnt lgkmcnt(6)
    v_mfma_f32_16x16x32_bf16 v[76:79], v[132:135], v[196:199], v[76:79]
    ds_read_b64_tr_b16 v[124:125], v142 offset:96
    ds_read_b64_tr_b16 v[126:127], v142 offset:3680
    v_mfma_f32_16x16x32_bf16 v[104:107], v[132:135], a[204:207], v[104:107]
    v_mov_b32 v161, v160
    v_mfma_f32_16x16x32_bf16 v[80:83], v[136:139], v[196:199], v[80:83]
    ds_read_b64_tr_b16 v[128:129], v142 offset:128
    ds_read_b64_tr_b16 v[130:131], v142 offset:3712
    v_mfma_f32_16x16x32_bf16 v[108:111], v[136:139], a[204:207], v[108:111]
    s_add_u32 m0, m0, s53
    s_add_u32 s58, s58, s56
    buffer_load_dwordx4 v6, s[32:35], s58 offen lds
    s_waitcnt vmcnt(18) lgkmcnt(6)
    v_mfma_f32_16x16x32_bf16 v[56:59], v[112:115], v[200:203], v[56:59]
    ds_read_b64_tr_b16 v[132:133], v142 offset:160
    ds_read_b64_tr_b16 v[134:135], v142 offset:3744
    v_mfma_f32_16x16x32_bf16 v[84:87], v[112:115], a[208:211], v[84:87]
    v_permlane32_swap_b32 v160, v161
    v_mfma_f32_16x16x32_bf16 v[60:63], v[116:119], v[200:203], v[60:63]
    ds_read_b64_tr_b16 v[136:137], v143 offset:0
    ds_read_b64_tr_b16 v[138:139], v143 offset:3584
    v_mfma_f32_16x16x32_bf16 v[88:91], v[116:119], a[208:211], v[88:91]
    s_add_u32 m0, m0, s53
    s_add_u32 s58, s58, s56
    buffer_load_dwordx4 v6, s[32:35], s58 offen lds
    s_waitcnt lgkmcnt(6)
    v_mfma_f32_16x16x32_bf16 v[64:67], v[120:123], v[200:203], v[64:67]
    ds_read_b64_tr_b16 v[112:113], v142 offset:7168
    ds_read_b64_tr_b16 v[114:115], v142 offset:10752
    v_mfma_f32_16x16x32_bf16 v[92:95], v[120:123], a[208:211], v[92:95]
    v_mul_f32 v245, 0xbb000000, v160
    v_mfma_f32_16x16x32_bf16 v[68:71], v[124:127], v[200:203], v[68:71]
    ds_read_b64_tr_b16 v[116:117], v142 offset:7200
    ds_read_b64_tr_b16 v[118:119], v142 offset:10784
    v_mfma_f32_16x16x32_bf16 v[96:99], v[124:127], a[208:211], v[96:99]
    s_add_u32 m0, m0, s53
    s_add_u32 s58, s58, s56
    buffer_load_dwordx4 v6, s[32:35], s58 offen lds
    s_waitcnt lgkmcnt(6)
    v_mfma_f32_16x16x32_bf16 v[72:75], v[128:131], v[200:203], v[72:75]
    ds_read_b64_tr_b16 v[120:121], v142 offset:7232
    ds_read_b64_tr_b16 v[122:123], v142 offset:10816
    v_mfma_f32_16x16x32_bf16 v[100:103], v[128:131], a[208:211], v[100:103]
    v_mul_f32 v161, 0x3b000000, v161
    v_mfma_f32_16x16x32_bf16 v[76:79], v[132:135], v[200:203], v[76:79]
    ds_read_b64_tr_b16 v[124:125], v142 offset:7264
    ds_read_b64_tr_b16 v[126:127], v142 offset:10848
    v_mfma_f32_16x16x32_bf16 v[104:107], v[132:135], a[208:211], v[104:107]
    s_add_u32 m0, m0, s53
    s_add_u32 s58, s58, s56
    buffer_load_dwordx4 v6, s[32:35], s58 offen lds
    s_waitcnt lgkmcnt(6)
    v_mfma_f32_16x16x32_bf16 v[80:83], v[136:139], v[200:203], v[80:83]
    ds_read_b64_tr_b16 v[128:129], v142 offset:7296
    ds_read_b64_tr_b16 v[130:131], v142 offset:10880
    v_mfma_f32_16x16x32_bf16 v[108:111], v[136:139], a[208:211], v[108:111]
    v_fma_f32 v161, -v245, v245, v161
    s_waitcnt vmcnt(19)
    v_mfma_f32_16x16x32_bf16 v[56:59], v[112:115], v[204:207], v[56:59]
    ds_read_b64_tr_b16 v[132:133], v142 offset:7328
    ds_read_b64_tr_b16 v[134:135], v142 offset:10912
    v_mfma_f32_16x16x32_bf16 v[84:87], v[112:115], a[212:215], v[84:87]
    s_add_u32 m0, m0, s53
    s_add_u32 s58, s58, s56
    buffer_load_dwordx4 v6, s[32:35], s58 offen lds
    s_waitcnt lgkmcnt(6)
    v_mfma_f32_16x16x32_bf16 v[60:63], v[116:119], v[204:207], v[60:63]
    ds_read_b64_tr_b16 v[136:137], v143 offset:7168
    ds_read_b64_tr_b16 v[138:139], v143 offset:10752
    v_mfma_f32_16x16x32_bf16 v[88:91], v[116:119], a[212:215], v[88:91]
    v_max_f32 v246, 0, v161
    v_mfma_f32_16x16x32_bf16 v[64:67], v[120:123], v[204:207], v[64:67]
    ds_read_b64_tr_b16 v[112:113], v142 offset:14336
    ds_read_b64_tr_b16 v[114:115], v142 offset:17920
    v_mfma_f32_16x16x32_bf16 v[92:95], v[120:123], a[212:215], v[92:95]
    s_add_u32 m0, m0, s53
    s_add_u32 s58, s58, s56
    buffer_load_dwordx4 v6, s[32:35], s58 offen lds
    s_waitcnt lgkmcnt(6)
    v_mfma_f32_16x16x32_bf16 v[68:71], v[124:127], v[204:207], v[68:71]
    ds_read_b64_tr_b16 v[116:117], v142 offset:14368
    ds_read_b64_tr_b16 v[118:119], v142 offset:17952
    v_mfma_f32_16x16x32_bf16 v[96:99], v[124:127], a[212:215], v[96:99]
    v_add_f32 v161, 0x3727c5ac, v246
    v_mfma_f32_16x16x32_bf16 v[72:75], v[128:131], v[204:207], v[72:75]
    ds_read_b64_tr_b16 v[120:121], v142 offset:14400
    ds_read_b64_tr_b16 v[122:123], v142 offset:17984
    v_mfma_f32_16x16x32_bf16 v[100:103], v[128:131], a[212:215], v[100:103]
    s_add_u32 m0, m0, s53
    s_add_u32 s58, s58, s56
    buffer_load_dwordx4 v6, s[32:35], s58 offen lds
    s_waitcnt lgkmcnt(6)
    v_mfma_f32_16x16x32_bf16 v[76:79], v[132:135], v[204:207], v[76:79]
    ds_read_b64_tr_b16 v[124:125], v142 offset:14432
    ds_read_b64_tr_b16 v[126:127], v142 offset:18016
    v_mfma_f32_16x16x32_bf16 v[104:107], v[132:135], a[212:215], v[104:107]
    v_rsq_f32 v244, v161
    v_mfma_f32_16x16x32_bf16 v[80:83], v[136:139], v[204:207], v[80:83]
    ds_read_b64_tr_b16 v[128:129], v142 offset:14464
    ds_read_b64_tr_b16 v[130:131], v142 offset:18048
    v_mfma_f32_16x16x32_bf16 v[108:111], v[136:139], a[212:215], v[108:111]
    s_add_u32 m0, m0, s53
    s_add_u32 s58, s58, s56
    buffer_load_dwordx4 v6, s[32:35], s58 offen lds
    s_waitcnt vmcnt(21) lgkmcnt(6)
    v_mfma_f32_16x16x32_bf16 v[56:59], v[112:115], v[208:211], v[56:59]
    ds_read_b64_tr_b16 v[132:133], v142 offset:14496
    ds_read_b64_tr_b16 v[134:135], v142 offset:18080
    v_mfma_f32_16x16x32_bf16 v[84:87], v[112:115], a[216:219], v[84:87]
    v_rcp_f32 v154, v244
    v_mfma_f32_16x16x32_bf16 v[60:63], v[116:119], v[208:211], v[60:63]
    ds_read_b64_tr_b16 v[136:137], v143 offset:14336
    ds_read_b64_tr_b16 v[138:139], v143 offset:17920
    v_mfma_f32_16x16x32_bf16 v[88:91], v[116:119], a[216:219], v[88:91]
    v_mad_u32_u24 v20, v0, s100, v1
    buffer_load_dword v255, v20, s[4:7], s99 offen sc1
    s_waitcnt lgkmcnt(6)
    v_mfma_f32_16x16x32_bf16 v[64:67], v[120:123], v[208:211], v[64:67]
    ds_read_b64_tr_b16 v[112:113], v142 offset:21504
    ds_read_b64_tr_b16 v[114:115], v142 offset:25088
    v_mfma_f32_16x16x32_bf16 v[92:95], v[120:123], a[216:219], v[92:95]
    v_mul_f32 v153, 0xc0135761, v244
    v_mfma_f32_16x16x32_bf16 v[68:71], v[124:127], v[208:211], v[68:71]
    ds_read_b64_tr_b16 v[116:117], v142 offset:21536
    ds_read_b64_tr_b16 v[118:119], v142 offset:25120
    v_mfma_f32_16x16x32_bf16 v[96:99], v[124:127], a[216:219], v[96:99]
    s_lshr_b32 s85, s2, 3
    s_lshl2_add_u32 s85, s85, s44
    s_mul_i32 s85, s85, 9216
    s_add_u32 s85, s85, 721280
    v_lshlrev_b32 v20, 10, v0
    v_add_u32 v20, s85, v20
    s_mov_b64 exec, 511
    buffer_load_dword v255, v20, s[32:35], 0 offen
    s_mov_b64 exec, -1
    s_waitcnt lgkmcnt(6)
    v_mfma_f32_16x16x32_bf16 v[72:75], v[128:131], v[208:211], v[72:75]
    ds_read_b64_tr_b16 v[120:121], v142 offset:21568
    ds_read_b64_tr_b16 v[122:123], v142 offset:25152
    v_mfma_f32_16x16x32_bf16 v[100:103], v[128:131], a[216:219], v[100:103]
    v_mul_f32 v152, v244, v244
    v_mfma_f32_16x16x32_bf16 v[76:79], v[132:135], v[208:211], v[76:79]
    ds_read_b64_tr_b16 v[124:125], v142 offset:21600
    ds_read_b64_tr_b16 v[126:127], v142 offset:25184
    v_mfma_f32_16x16x32_bf16 v[104:107], v[132:135], a[216:219], v[104:107]
    v_mul_f32 v152, 0x3d372713, v152
    v_mul_f32 v152, v152, v153
    s_waitcnt lgkmcnt(6)
    v_mfma_f32_16x16x32_bf16 v[80:83], v[136:139], v[208:211], v[80:83]
    ds_read_b64_tr_b16 v[128:129], v142 offset:21632
    ds_read_b64_tr_b16 v[130:131], v142 offset:25216
    v_mfma_f32_16x16x32_bf16 v[108:111], v[136:139], a[216:219], v[108:111]
    v_and_b32 v19, 0x30, v0
    s_waitcnt vmcnt(21)
    v_mfma_f32_16x16x32_bf16 v[56:59], v[112:115], v[212:215], v[56:59]
    ds_read_b64_tr_b16 v[132:133], v142 offset:21664
    ds_read_b64_tr_b16 v[134:135], v142 offset:25248
    v_mfma_f32_16x16x32_bf16 v[84:87], v[112:115], a[220:223], v[84:87]
    v_add_u32 v19, 162304, v19
    s_waitcnt lgkmcnt(6)
    v_mfma_f32_16x16x32_bf16 v[60:63], v[116:119], v[212:215], v[60:63]
    ds_read_b64_tr_b16 v[136:137], v143 offset:21504
    ds_read_b64_tr_b16 v[138:139], v143 offset:25088
    v_mfma_f32_16x16x32_bf16 v[88:91], v[116:119], a[220:223], v[88:91]
    v_mfma_f32_16x16x32_bf16 v[64:67], v[120:123], v[212:215], v[64:67]
    ds_read_b64_tr_b16 v[112:113], v142 offset:28672
    ds_read_b64_tr_b16 v[114:115], v142 offset:32256
    v_mfma_f32_16x16x32_bf16 v[92:95], v[120:123], a[220:223], v[92:95]
    s_waitcnt lgkmcnt(6)
    v_mfma_f32_16x16x32_bf16 v[68:71], v[124:127], v[212:215], v[68:71]
    ds_read_b64_tr_b16 v[116:117], v142 offset:28704
    ds_read_b64_tr_b16 v[118:119], v142 offset:32288
    v_mfma_f32_16x16x32_bf16 v[96:99], v[124:127], a[220:223], v[96:99]
    v_mfma_f32_16x16x32_bf16 v[72:75], v[128:131], v[212:215], v[72:75]
    ds_read_b64_tr_b16 v[120:121], v142 offset:28736
    ds_read_b64_tr_b16 v[122:123], v142 offset:32320
    v_mfma_f32_16x16x32_bf16 v[100:103], v[128:131], a[220:223], v[100:103]
    s_waitcnt lgkmcnt(6)
    v_mfma_f32_16x16x32_bf16 v[76:79], v[132:135], v[212:215], v[76:79]
    ds_read_b64_tr_b16 v[124:125], v142 offset:28768
    ds_read_b64_tr_b16 v[126:127], v142 offset:32352
    v_mfma_f32_16x16x32_bf16 v[104:107], v[132:135], a[220:223], v[104:107]
    v_mfma_f32_16x16x32_bf16 v[80:83], v[136:139], v[212:215], v[80:83]
    ds_read_b64_tr_b16 v[128:129], v142 offset:28800
    ds_read_b64_tr_b16 v[130:131], v142 offset:32384
    v_mfma_f32_16x16x32_bf16 v[108:111], v[136:139], a[220:223], v[108:111]
    s_waitcnt vmcnt(19) lgkmcnt(6)
    v_mfma_f32_16x16x32_bf16 v[56:59], v[112:115], v[216:219], v[56:59]
    ds_read_b64_tr_b16 v[132:133], v142 offset:28832
    ds_read_b64_tr_b16 v[134:135], v142 offset:32416
    v_mfma_f32_16x16x32_bf16 v[84:87], v[112:115], a[224:227], v[84:87]
    v_mfma_f32_16x16x32_bf16 v[60:63], v[116:119], v[216:219], v[60:63]
    ds_read_b64_tr_b16 v[136:137], v143 offset:28672
    ds_read_b64_tr_b16 v[138:139], v143 offset:32256
    v_mfma_f32_16x16x32_bf16 v[88:91], v[116:119], a[224:227], v[88:91]
    s_waitcnt lgkmcnt(6)
    v_mfma_f32_16x16x32_bf16 v[64:67], v[120:123], v[216:219], v[64:67]
    ds_read_b64_tr_b16 v[112:113], v142 offset:35840
    ds_read_b64_tr_b16 v[114:115], v142 offset:39424
    v_mfma_f32_16x16x32_bf16 v[92:95], v[120:123], a[224:227], v[92:95]
    v_mfma_f32_16x16x32_bf16 v[68:71], v[124:127], v[216:219], v[68:71]
    ds_read_b64_tr_b16 v[116:117], v142 offset:35872
    ds_read_b64_tr_b16 v[118:119], v142 offset:39456
    v_mfma_f32_16x16x32_bf16 v[96:99], v[124:127], a[224:227], v[96:99]
    s_waitcnt lgkmcnt(6)
    v_mfma_f32_16x16x32_bf16 v[72:75], v[128:131], v[216:219], v[72:75]
    ds_read_b64_tr_b16 v[120:121], v142 offset:35904
    ds_read_b64_tr_b16 v[122:123], v142 offset:39488
    v_mfma_f32_16x16x32_bf16 v[100:103], v[128:131], a[224:227], v[100:103]
    v_mfma_f32_16x16x32_bf16 v[76:79], v[132:135], v[216:219], v[76:79]
    ds_read_b64_tr_b16 v[124:125], v142 offset:35936
    ds_read_b64_tr_b16 v[126:127], v142 offset:39520
    v_mfma_f32_16x16x32_bf16 v[104:107], v[132:135], a[224:227], v[104:107]
    s_waitcnt lgkmcnt(6)
    v_mfma_f32_16x16x32_bf16 v[80:83], v[136:139], v[216:219], v[80:83]
    ds_read_b64_tr_b16 v[128:129], v142 offset:35968
    ds_read_b64_tr_b16 v[130:131], v142 offset:39552
    v_mfma_f32_16x16x32_bf16 v[108:111], v[136:139], a[224:227], v[108:111]
    s_waitcnt vmcnt(17)
    v_mfma_f32_16x16x32_bf16 v[56:59], v[112:115], v[220:223], v[56:59]
    ds_read_b64_tr_b16 v[132:133], v142 offset:36000
    ds_read_b64_tr_b16 v[134:135], v142 offset:39584
    v_mfma_f32_16x16x32_bf16 v[84:87], v[112:115], a[228:231], v[84:87]
    s_waitcnt lgkmcnt(6)
    v_mfma_f32_16x16x32_bf16 v[60:63], v[116:119], v[220:223], v[60:63]
    ds_read_b64_tr_b16 v[136:137], v143 offset:35840
    ds_read_b64_tr_b16 v[138:139], v143 offset:39424
    v_mfma_f32_16x16x32_bf16 v[88:91], v[116:119], a[228:231], v[88:91]
    v_mfma_f32_16x16x32_bf16 v[64:67], v[120:123], v[220:223], v[64:67]
    ds_read_b64_tr_b16 v[112:113], v142 offset:43008
    ds_read_b64_tr_b16 v[114:115], v142 offset:46592
    v_mfma_f32_16x16x32_bf16 v[92:95], v[120:123], a[228:231], v[92:95]
    s_waitcnt lgkmcnt(6)
    v_mfma_f32_16x16x32_bf16 v[68:71], v[124:127], v[220:223], v[68:71]
    ds_read_b64_tr_b16 v[116:117], v142 offset:43040
    ds_read_b64_tr_b16 v[118:119], v142 offset:46624
    v_mfma_f32_16x16x32_bf16 v[96:99], v[124:127], a[228:231], v[96:99]
    v_mfma_f32_16x16x32_bf16 v[72:75], v[128:131], v[220:223], v[72:75]
    ds_read_b64_tr_b16 v[120:121], v142 offset:43072
    ds_read_b64_tr_b16 v[122:123], v142 offset:46656
    v_mfma_f32_16x16x32_bf16 v[100:103], v[128:131], a[228:231], v[100:103]
    s_waitcnt lgkmcnt(6)
    v_mfma_f32_16x16x32_bf16 v[76:79], v[132:135], v[220:223], v[76:79]
    ds_read_b64_tr_b16 v[124:125], v142 offset:43104
    ds_read_b64_tr_b16 v[126:127], v142 offset:46688
    v_mfma_f32_16x16x32_bf16 v[104:107], v[132:135], a[228:231], v[104:107]
    v_mfma_f32_16x16x32_bf16 v[80:83], v[136:139], v[220:223], v[80:83]
    ds_read_b64_tr_b16 v[128:129], v142 offset:43136
    ds_read_b64_tr_b16 v[130:131], v142 offset:46720
    v_mfma_f32_16x16x32_bf16 v[108:111], v[136:139], a[228:231], v[108:111]
    s_waitcnt vmcnt(15) lgkmcnt(6)
    v_mfma_f32_16x16x32_bf16 v[56:59], v[112:115], v[224:227], v[56:59]
    ds_read_b64_tr_b16 v[132:133], v142 offset:43168
    ds_read_b64_tr_b16 v[134:135], v142 offset:46752
    v_mfma_f32_16x16x32_bf16 v[84:87], v[112:115], a[232:235], v[84:87]
    v_mfma_f32_16x16x32_bf16 v[60:63], v[116:119], v[224:227], v[60:63]
    ds_read_b64_tr_b16 v[136:137], v143 offset:43008
    ds_read_b64_tr_b16 v[138:139], v143 offset:46592
    v_mfma_f32_16x16x32_bf16 v[88:91], v[116:119], a[232:235], v[88:91]
    s_waitcnt lgkmcnt(6)
    v_mfma_f32_16x16x32_bf16 v[64:67], v[120:123], v[224:227], v[64:67]
    ds_read_b64_tr_b16 v[112:113], v142 offset:50176
    ds_read_b64_tr_b16 v[114:115], v142 offset:53760
    v_mfma_f32_16x16x32_bf16 v[92:95], v[120:123], a[232:235], v[92:95]
    v_mfma_f32_16x16x32_bf16 v[68:71], v[124:127], v[224:227], v[68:71]
    ds_read_b64_tr_b16 v[116:117], v142 offset:50208
    ds_read_b64_tr_b16 v[118:119], v142 offset:53792
    v_mfma_f32_16x16x32_bf16 v[96:99], v[124:127], a[232:235], v[96:99]
    s_waitcnt lgkmcnt(6)
    v_mfma_f32_16x16x32_bf16 v[72:75], v[128:131], v[224:227], v[72:75]
    ds_read_b64_tr_b16 v[120:121], v142 offset:50240
    ds_read_b64_tr_b16 v[122:123], v142 offset:53824
    v_mfma_f32_16x16x32_bf16 v[100:103], v[128:131], a[232:235], v[100:103]
    v_mfma_f32_16x16x32_bf16 v[76:79], v[132:135], v[224:227], v[76:79]
    ds_read_b64_tr_b16 v[124:125], v142 offset:50272
    ds_read_b64_tr_b16 v[126:127], v142 offset:53856
    v_mfma_f32_16x16x32_bf16 v[104:107], v[132:135], a[232:235], v[104:107]
    s_waitcnt lgkmcnt(6)
    v_mfma_f32_16x16x32_bf16 v[80:83], v[136:139], v[224:227], v[80:83]
    ds_read_b64_tr_b16 v[128:129], v142 offset:50304
    ds_read_b64_tr_b16 v[130:131], v142 offset:53888
    v_mfma_f32_16x16x32_bf16 v[108:111], v[136:139], a[232:235], v[108:111]
    s_waitcnt vmcnt(13)
    v_mfma_f32_16x16x32_bf16 v[56:59], v[112:115], v[228:231], v[56:59]
    ds_read_b64_tr_b16 v[132:133], v142 offset:50336
    ds_read_b64_tr_b16 v[134:135], v142 offset:53920
    v_mfma_f32_16x16x32_bf16 v[84:87], v[112:115], a[236:239], v[84:87]
    s_waitcnt lgkmcnt(6)
    v_mfma_f32_16x16x32_bf16 v[60:63], v[116:119], v[228:231], v[60:63]
    ds_read_b64_tr_b16 v[136:137], v143 offset:50176
    ds_read_b64_tr_b16 v[138:139], v143 offset:53760
    v_mfma_f32_16x16x32_bf16 v[88:91], v[116:119], a[236:239], v[88:91]
    v_mfma_f32_16x16x32_bf16 v[64:67], v[120:123], v[228:231], v[64:67]
    v_mfma_f32_16x16x32_bf16 v[92:95], v[120:123], a[236:239], v[92:95]
    s_waitcnt lgkmcnt(4)
    v_mfma_f32_16x16x32_bf16 v[68:71], v[124:127], v[228:231], v[68:71]
    v_mfma_f32_16x16x32_bf16 v[96:99], v[124:127], a[236:239], v[96:99]
    v_mfma_f32_16x16x32_bf16 v[72:75], v[128:131], v[228:231], v[72:75]
    v_mfma_f32_16x16x32_bf16 v[100:103], v[128:131], a[236:239], v[100:103]
    s_waitcnt lgkmcnt(0)
    v_mfma_f32_16x16x32_bf16 v[76:79], v[132:135], v[228:231], v[76:79]
    v_mfma_f32_16x16x32_bf16 v[104:107], v[132:135], a[236:239], v[104:107]
    v_mfma_f32_16x16x32_bf16 v[80:83], v[136:139], v[228:231], v[80:83]
    v_mfma_f32_16x16x32_bf16 v[108:111], v[136:139], a[236:239], v[108:111]
    v_add_u32 v146, 173056, v4
    ds_read_b128 v[112:115], v19 offset:0
    ds_read_b128 v[116:119], v19 offset:64
    ds_read_b128 v[120:123], v19 offset:128
    ds_read_b128 v[124:127], v19 offset:192
    ds_read_b128 v[128:131], v19 offset:256
    ds_read_b128 v[132:135], v19 offset:320
    ds_read_b128 v[136:139], v19 offset:384
    s_waitcnt vmcnt(2)
    s_waitcnt lgkmcnt(0)
    s_barrier
    s_add_u32 m0, s68, 45056
    s_mov_b32 s58, 720896
    buffer_load_dwordx4 v6, s[32:35], s58 offen lds
    v_pk_fma_f32 v[56:57], v[112:113], v[240:241], v[56:57] op_sel:[0,1,0] op_sel_hi:[1,1,1]
    v_pk_fma_f32 v[58:59], v[114:115], v[240:241], v[58:59] op_sel:[0,1,0] op_sel_hi:[1,1,1]
    v_pk_fma_f32 v[60:61], v[116:117], v[240:241], v[60:61] op_sel:[0,1,0] op_sel_hi:[1,1,1]
    v_pk_fma_f32 v[62:63], v[118:119], v[240:241], v[62:63] op_sel:[0,1,0] op_sel_hi:[1,1,1]
    v_pk_fma_f32 v[64:65], v[120:121], v[240:241], v[64:65] op_sel:[0,1,0] op_sel_hi:[1,1,1]
    v_pk_fma_f32 v[66:67], v[122:123], v[240:241], v[66:67] op_sel:[0,1,0] op_sel_hi:[1,1,1]
    v_pk_fma_f32 v[68:69], v[124:125], v[240:241], v[68:69] op_sel:[0,1,0] op_sel_hi:[1,1,1]
    v_pk_fma_f32 v[70:71], v[126:127], v[240:241], v[70:71] op_sel:[0,1,0] op_sel_hi:[1,1,1]
    v_pk_fma_f32 v[72:73], v[128:129], v[240:241], v[72:73] op_sel:[0,1,0] op_sel_hi:[1,1,1]
    v_pk_fma_f32 v[74:75], v[130:131], v[240:241], v[74:75] op_sel:[0,1,0] op_sel_hi:[1,1,1]
    v_pk_fma_f32 v[76:77], v[132:133], v[240:241], v[76:77] op_sel:[0,1,0] op_sel_hi:[1,1,1]
    v_pk_fma_f32 v[78:79], v[134:135], v[240:241], v[78:79] op_sel:[0,1,0] op_sel_hi:[1,1,1]
    s_add_u32 m0, m0, s53
    s_add_u32 s58, s58, s56
    buffer_load_dwordx4 v6, s[32:35], s58 offen lds
    v_pk_fma_f32 v[80:81], v[136:137], v[240:241], v[80:81] op_sel:[0,1,0] op_sel_hi:[1,1,1]
    v_pk_fma_f32 v[82:83], v[138:139], v[240:241], v[82:83] op_sel:[0,1,0] op_sel_hi:[1,1,1]
    v_pk_mul_f32 v[168:169], v[56:57], v[56:57]
    v_pk_mul_f32 v[170:171], v[58:59], v[58:59]
    v_pk_mul_f32 v[172:173], v[60:61], v[60:61]
    v_pk_mul_f32 v[174:175], v[62:63], v[62:63]
    v_pk_mul_f32 v[176:177], v[64:65], v[64:65]
    v_pk_mul_f32 v[178:179], v[66:67], v[66:67]
    v_pk_mul_f32 v[180:181], v[68:69], v[68:69]
    v_pk_mul_f32 v[182:183], v[70:71], v[70:71]
    v_pk_mul_f32 v[184:185], v[72:73], v[72:73]
    v_pk_mul_f32 v[186:187], v[74:75], v[74:75]
    s_add_u32 m0, m0, s53
    s_add_u32 s58, s58, s56
    buffer_load_dwordx4 v6, s[32:35], s58 offen lds
    v_pk_mul_f32 v[188:189], v[76:77], v[76:77]
    v_pk_mul_f32 v[190:191], v[78:79], v[78:79]
    v_pk_mul_f32 v[192:193], v[80:81], v[80:81]
    v_pk_mul_f32 v[194:195], v[82:83], v[82:83]
    v_pk_fma_f32 v[168:169], v[168:169], v[148:149], v[148:149] op_sel:[0,0,1] op_sel_hi:[1,0,1]
    v_pk_fma_f32 v[170:171], v[170:171], v[148:149], v[148:149] op_sel:[0,0,1] op_sel_hi:[1,0,1]
    v_pk_fma_f32 v[172:173], v[172:173], v[148:149], v[148:149] op_sel:[0,0,1] op_sel_hi:[1,0,1]
    v_pk_fma_f32 v[174:175], v[174:175], v[148:149], v[148:149] op_sel:[0,0,1] op_sel_hi:[1,0,1]
    v_pk_fma_f32 v[176:177], v[176:177], v[148:149], v[148:149] op_sel:[0,0,1] op_sel_hi:[1,0,1]
    v_pk_fma_f32 v[178:179], v[178:179], v[148:149], v[148:149] op_sel:[0,0,1] op_sel_hi:[1,0,1]
    v_pk_fma_f32 v[180:181], v[180:181], v[148:149], v[148:149] op_sel:[0,0,1] op_sel_hi:[1,0,1]
    v_pk_fma_f32 v[182:183], v[182:183], v[148:149], v[148:149] op_sel:[0,0,1] op_sel_hi:[1,0,1]
    s_add_u32 m0, m0, s53
    s_add_u32 s58, s58, s56
    buffer_load_dwordx4 v6, s[32:35], s58 offen lds
    v_pk_fma_f32 v[184:185], v[184:185], v[148:149], v[148:149] op_sel:[0,0,1] op_sel_hi:[1,0,1]
    v_pk_fma_f32 v[186:187], v[186:187], v[148:149], v[148:149] op_sel:[0,0,1] op_sel_hi:[1,0,1]
    v_pk_fma_f32 v[188:189], v[188:189], v[148:149], v[148:149] op_sel:[0,0,1] op_sel_hi:[1,0,1]
    v_pk_fma_f32 v[190:191], v[190:191], v[148:149], v[148:149] op_sel:[0,0,1] op_sel_hi:[1,0,1]
    v_pk_fma_f32 v[192:193], v[192:193], v[148:149], v[148:149] op_sel:[0,0,1] op_sel_hi:[1,0,1]
    v_pk_fma_f32 v[194:195], v[194:195], v[148:149], v[148:149] op_sel:[0,0,1] op_sel_hi:[1,0,1]
    v_pk_mul_f32 v[168:169], v[168:169], v[56:57]
    v_pk_mul_f32 v[170:171], v[170:171], v[58:59]
    v_pk_mul_f32 v[172:173], v[172:173], v[60:61]
    v_pk_mul_f32 v[174:175], v[174:175], v[62:63]
    v_pk_mul_f32 v[176:177], v[176:177], v[64:65]
    v_pk_mul_f32 v[178:179], v[178:179], v[66:67]
    s_add_u32 m0, m0, s53
    s_add_u32 s58, s58, s56
    buffer_load_dwordx4 v6, s[32:35], s58 offen lds
    v_pk_mul_f32 v[180:181], v[180:181], v[68:69]
    v_pk_mul_f32 v[182:183], v[182:183], v[70:71]
    v_pk_mul_f32 v[184:185], v[184:185], v[72:73]
    v_pk_mul_f32 v[186:187], v[186:187], v[74:75]
    v_pk_mul_f32 v[188:189], v[188:189], v[76:77]
    v_pk_mul_f32 v[190:191], v[190:191], v[78:79]
    v_pk_mul_f32 v[192:193], v[192:193], v[80:81]
    v_pk_mul_f32 v[194:195], v[194:195], v[82:83]
    v_exp_f32 v168, v168
    v_exp_f32 v169, v169
    v_exp_f32 v170, v170
    v_exp_f32 v171, v171
    s_add_u32 m0, m0, s53
    s_add_u32 s58, s58, s56
    buffer_load_dwordx4 v6, s[32:35], s58 offen lds
    v_exp_f32 v172, v172
    v_exp_f32 v173, v173
    v_exp_f32 v174, v174
    v_exp_f32 v175, v175
    v_exp_f32 v176, v176
    v_exp_f32 v177, v177
    v_exp_f32 v178, v178
    v_exp_f32 v179, v179
    v_exp_f32 v180, v180
    v_exp_f32 v181, v181
    v_exp_f32 v182, v182
    v_exp_f32 v183, v183
    s_add_u32 m0, m0, s53
    s_add_u32 s58, s58, s56
    buffer_load_dwordx4 v6, s[32:35], s58 offen lds
    v_exp_f32 v184, v184
    v_exp_f32 v185, v185
    v_exp_f32 v186, v186
    v_exp_f32 v187, v187
    v_exp_f32 v188, v188
    v_exp_f32 v189, v189
    v_exp_f32 v190, v190
    v_exp_f32 v191, v191
    v_exp_f32 v192, v192
    v_exp_f32 v193, v193
    v_exp_f32 v194, v194
    v_exp_f32 v195, v195
    s_add_u32 m0, m0, s53
    s_add_u32 s58, s58, s56
    buffer_load_dwordx4 v6, s[32:35], s58 offen lds
    v_pk_fma_f32 v[168:169], v[168:169], v[150:151], v[150:151] op_sel:[0,0,0] op_sel_hi:[1,0,0]
    v_pk_fma_f32 v[170:171], v[170:171], v[150:151], v[150:151] op_sel:[0,0,0] op_sel_hi:[1,0,0]
    v_pk_fma_f32 v[172:173], v[172:173], v[150:151], v[150:151] op_sel:[0,0,0] op_sel_hi:[1,0,0]
    v_pk_fma_f32 v[174:175], v[174:175], v[150:151], v[150:151] op_sel:[0,0,0] op_sel_hi:[1,0,0]
    v_pk_fma_f32 v[176:177], v[176:177], v[150:151], v[150:151] op_sel:[0,0,0] op_sel_hi:[1,0,0]
    v_pk_fma_f32 v[178:179], v[178:179], v[150:151], v[150:151] op_sel:[0,0,0] op_sel_hi:[1,0,0]
    v_pk_fma_f32 v[180:181], v[180:181], v[150:151], v[150:151] op_sel:[0,0,0] op_sel_hi:[1,0,0]
    v_pk_fma_f32 v[182:183], v[182:183], v[150:151], v[150:151] op_sel:[0,0,0] op_sel_hi:[1,0,0]
    v_pk_fma_f32 v[184:185], v[184:185], v[150:151], v[150:151] op_sel:[0,0,0] op_sel_hi:[1,0,0]
    v_pk_fma_f32 v[186:187], v[186:187], v[150:151], v[150:151] op_sel:[0,0,0] op_sel_hi:[1,0,0]
    v_pk_fma_f32 v[188:189], v[188:189], v[150:151], v[150:151] op_sel:[0,0,0] op_sel_hi:[1,0,0]
    v_pk_fma_f32 v[190:191], v[190:191], v[150:151], v[150:151] op_sel:[0,0,0] op_sel_hi:[1,0,0]
    s_add_u32 m0, m0, s53
    s_add_u32 s58, s58, s56
    buffer_load_dwordx4 v6, s[32:35], s58 offen lds
    v_pk_fma_f32 v[192:193], v[192:193], v[150:151], v[150:151] op_sel:[0,0,0] op_sel_hi:[1,0,0]
    v_pk_fma_f32 v[194:195], v[194:195], v[150:151], v[150:151] op_sel:[0,0,0] op_sel_hi:[1,0,0]
    v_rcp_f32 v168, v168
    v_rcp_f32 v169, v169
    v_rcp_f32 v170, v170
    v_rcp_f32 v171, v171
    v_rcp_f32 v172, v172
    v_rcp_f32 v173, v173
    v_rcp_f32 v174, v174
    v_rcp_f32 v175, v175
    v_rcp_f32 v176, v176
    v_rcp_f32 v177, v177
    s_add_u32 m0, m0, s53
    s_add_u32 s58, s58, s56
    buffer_load_dwordx4 v6, s[32:35], s58 offen lds
    v_rcp_f32 v178, v178
    v_rcp_f32 v179, v179
    v_rcp_f32 v180, v180
    v_rcp_f32 v181, v181
    v_rcp_f32 v182, v182
    v_rcp_f32 v183, v183
    v_rcp_f32 v184, v184
    v_rcp_f32 v185, v185
    v_rcp_f32 v186, v186
    v_rcp_f32 v187, v187
    v_rcp_f32 v188, v188
    v_rcp_f32 v189, v189
    s_add_u32 m0, m0, s53
    s_add_u32 s58, s58, s56
    buffer_load_dwordx4 v6, s[32:35], s58 offen lds
    v_rcp_f32 v190, v190
    v_rcp_f32 v191, v191
    v_rcp_f32 v192, v192
    v_rcp_f32 v193, v193
    v_rcp_f32 v194, v194
    v_rcp_f32 v195, v195
    v_pk_mul_f32 v[56:57], v[56:57], v[168:169]
    v_pk_mul_f32 v[58:59], v[58:59], v[170:171]
    v_pk_mul_f32 v[60:61], v[60:61], v[172:173]
    v_pk_mul_f32 v[62:63], v[62:63], v[174:175]
    v_pk_mul_f32 v[64:65], v[64:65], v[176:177]
    v_pk_mul_f32 v[66:67], v[66:67], v[178:179]
    s_add_u32 m0, m0, s53
    s_add_u32 s58, s58, s56
    buffer_load_dwordx4 v6, s[32:35], s58 offen lds
    v_pk_mul_f32 v[68:69], v[68:69], v[180:181]
    v_pk_mul_f32 v[70:71], v[70:71], v[182:183]
    v_pk_mul_f32 v[72:73], v[72:73], v[184:185]
    v_pk_mul_f32 v[74:75], v[74:75], v[186:187]
    v_pk_mul_f32 v[76:77], v[76:77], v[188:189]
    v_pk_mul_f32 v[78:79], v[78:79], v[190:191]
    v_pk_mul_f32 v[80:81], v[80:81], v[192:193]
    v_pk_mul_f32 v[82:83], v[82:83], v[194:195]
    v_cvt_pk_bf16_f32 v196, v56, v57
    v_cvt_pk_bf16_f32 v197, v58, v59
    v_cvt_pk_bf16_f32 v198, v60, v61
    v_cvt_pk_bf16_f32 v199, v62, v63
    v_cvt_pk_bf16_f32 v200, v64, v65
    v_cvt_pk_bf16_f32 v201, v66, v67
    v_cvt_pk_bf16_f32 v202, v68, v69
    v_cvt_pk_bf16_f32 v203, v70, v71
    v_cvt_pk_bf16_f32 v204, v72, v73
    v_cvt_pk_bf16_f32 v205, v74, v75
    v_cvt_pk_bf16_f32 v206, v76, v77
    v_cvt_pk_bf16_f32 v207, v78, v79
    v_cvt_pk_bf16_f32 v208, v80, v81
    v_cvt_pk_bf16_f32 v209, v82, v83
    s_cmp_eq_u32 s51, 0
    s_cbranch_scc1 sc_50
    buffer_store_dwordx4 v[196:199], v4, s[4:7], s78 offen offset:0
    buffer_store_dwordx4 v[200:203], v4, s[4:7], s78 offen offset:1024
    buffer_store_dwordx4 v[204:207], v4, s[4:7], s78 offen offset:2048
    buffer_store_dwordx2 v[208:209], v4, s[4:7], s79 offen
scb_51:
    s_add_u32 m0, m0, s53
    s_add_u32 s58, s58, s56
    buffer_load_dwordx4 v6, s[32:35], s58 offen lds
    v_pk_fma_f32 v[84:85], v[112:113], v[244:245], v[84:85] op_sel:[0,1,0] op_sel_hi:[1,1,1]
    v_pk_fma_f32 v[86:87], v[114:115], v[244:245], v[86:87] op_sel:[0,1,0] op_sel_hi:[1,1,1]
    v_pk_fma_f32 v[88:89], v[116:117], v[244:245], v[88:89] op_sel:[0,1,0] op_sel_hi:[1,1,1]
    v_pk_fma_f32 v[90:91], v[118:119], v[244:245], v[90:91] op_sel:[0,1,0] op_sel_hi:[1,1,1]
    v_pk_fma_f32 v[92:93], v[120:121], v[244:245], v[92:93] op_sel:[0,1,0] op_sel_hi:[1,1,1]
    v_pk_fma_f32 v[94:95], v[122:123], v[244:245], v[94:95] op_sel:[0,1,0] op_sel_hi:[1,1,1]
    v_pk_fma_f32 v[96:97], v[124:125], v[244:245], v[96:97] op_sel:[0,1,0] op_sel_hi:[1,1,1]
    v_pk_fma_f32 v[98:99], v[126:127], v[244:245], v[98:99] op_sel:[0,1,0] op_sel_hi:[1,1,1]
    v_pk_fma_f32 v[100:101], v[128:129], v[244:245], v[100:101] op_sel:[0,1,0] op_sel_hi:[1,1,1]
    v_pk_fma_f32 v[102:103], v[130:131], v[244:245], v[102:103] op_sel:[0,1,0] op_sel_hi:[1,1,1]
    v_pk_fma_f32 v[104:105], v[132:133], v[244:245], v[104:105] op_sel:[0,1,0] op_sel_hi:[1,1,1]
    v_pk_fma_f32 v[106:107], v[134:135], v[244:245], v[106:107] op_sel:[0,1,0] op_sel_hi:[1,1,1]
    s_add_u32 m0, m0, s53
    s_add_u32 s58, s58, s56
    buffer_load_dwordx4 v6, s[32:35], s58 offen lds
    v_pk_fma_f32 v[108:109], v[136:137], v[244:245], v[108:109] op_sel:[0,1,0] op_sel_hi:[1,1,1]
    v_pk_fma_f32 v[110:111], v[138:139], v[244:245], v[110:111] op_sel:[0,1,0] op_sel_hi:[1,1,1]
    v_pk_mul_f32 v[168:169], v[84:85], v[84:85]
    v_pk_mul_f32 v[170:171], v[86:87], v[86:87]
    v_pk_mul_f32 v[172:173], v[88:89], v[88:89]
    v_pk_mul_f32 v[174:175], v[90:91], v[90:91]
    v_pk_mul_f32 v[176:177], v[92:93], v[92:93]
    v_pk_mul_f32 v[178:179], v[94:95], v[94:95]
    v_pk_mul_f32 v[180:181], v[96:97], v[96:97]
    v_pk_mul_f32 v[182:183], v[98:99], v[98:99]
    v_pk_mul_f32 v[184:185], v[100:101], v[100:101]
    v_pk_mul_f32 v[186:187], v[102:103], v[102:103]
    s_add_u32 m0, m0, s53
    s_add_u32 s58, s58, s56
    buffer_load_dwordx4 v6, s[32:35], s58 offen lds
    v_pk_mul_f32 v[188:189], v[104:105], v[104:105]
    v_pk_mul_f32 v[190:191], v[106:107], v[106:107]
    v_pk_mul_f32 v[192:193], v[108:109], v[108:109]
    v_pk_mul_f32 v[194:195], v[110:111], v[110:111]
    v_pk_fma_f32 v[168:169], v[168:169], v[152:153], v[152:153] op_sel:[0,0,1] op_sel_hi:[1,0,1]
    v_pk_fma_f32 v[170:171], v[170:171], v[152:153], v[152:153] op_sel:[0,0,1] op_sel_hi:[1,0,1]
    v_pk_fma_f32 v[172:173], v[172:173], v[152:153], v[152:153] op_sel:[0,0,1] op_sel_hi:[1,0,1]
    v_pk_fma_f32 v[174:175], v[174:175], v[152:153], v[152:153] op_sel:[0,0,1] op_sel_hi:[1,0,1]
    v_pk_fma_f32 v[176:177], v[176:177], v[152:153], v[152:153] op_sel:[0,0,1] op_sel_hi:[1,0,1]
    v_pk_fma_f32 v[178:179], v[178:179], v[152:153], v[152:153] op_sel:[0,0,1] op_sel_hi:[1,0,1]
    v_pk_fma_f32 v[180:181], v[180:181], v[152:153], v[152:153] op_sel:[0,0,1] op_sel_hi:[1,0,1]
    v_pk_fma_f32 v[182:183], v[182:183], v[152:153], v[152:153] op_sel:[0,0,1] op_sel_hi:[1,0,1]
    s_add_u32 m0, m0, s53
    s_add_u32 s58, s58, s56
    buffer_load_dwordx4 v6, s[32:35], s58 offen lds
    v_pk_fma_f32 v[184:185], v[184:185], v[152:153], v[152:153] op_sel:[0,0,1] op_sel_hi:[1,0,1]
    v_pk_fma_f32 v[186:187], v[186:187], v[152:153], v[152:153] op_sel:[0,0,1] op_sel_hi:[1,0,1]
    v_pk_fma_f32 v[188:189], v[188:189], v[152:153], v[152:153] op_sel:[0,0,1] op_sel_hi:[1,0,1]
    v_pk_fma_f32 v[190:191], v[190:191], v[152:153], v[152:153] op_sel:[0,0,1] op_sel_hi:[1,0,1]
    v_pk_fma_f32 v[192:193], v[192:193], v[152:153], v[152:153] op_sel:[0,0,1] op_sel_hi:[1,0,1]
    v_pk_fma_f32 v[194:195], v[194:195], v[152:153], v[152:153] op_sel:[0,0,1] op_sel_hi:[1,0,1]
    v_pk_mul_f32 v[168:169], v[168:169], v[84:85]
    v_pk_mul_f32 v[170:171], v[170:171], v[86:87]
    v_pk_mul_f32 v[172:173], v[172:173], v[88:89]
    v_pk_mul_f32 v[174:175], v[174:175], v[90:91]
    v_pk_mul_f32 v[176:177], v[176:177], v[92:93]
    v_pk_mul_f32 v[178:179], v[178:179], v[94:95]
    s_add_u32 m0, m0, s53
    s_add_u32 s58, s58, s56
    buffer_load_dwordx4 v6, s[32:35], s58 offen lds
    v_pk_mul_f32 v[180:181], v[180:181], v[96:97]
    v_pk_mul_f32 v[182:183], v[182:183], v[98:99]
    v_pk_mul_f32 v[184:185], v[184:185], v[100:101]
    v_pk_mul_f32 v[186:187], v[186:187], v[102:103]
    v_pk_mul_f32 v[188:189], v[188:189], v[104:105]
    v_pk_mul_f32 v[190:191], v[190:191], v[106:107]
    v_pk_mul_f32 v[192:193], v[192:193], v[108:109]
    v_pk_mul_f32 v[194:195], v[194:195], v[110:111]
    v_exp_f32 v168, v168
    v_exp_f32 v169, v169
    v_exp_f32 v170, v170
    v_exp_f32 v171, v171
    s_add_u32 m0, m0, s53
    s_add_u32 s58, s58, s56
    buffer_load_dwordx4 v6, s[32:35], s58 offen lds
    v_exp_f32 v172, v172
    v_exp_f32 v173, v173
    v_exp_f32 v174, v174
    v_exp_f32 v175, v175
    v_exp_f32 v176, v176
    v_exp_f32 v177, v177
    v_exp_f32 v178, v178
    v_exp_f32 v179, v179
    v_exp_f32 v180, v180
    v_exp_f32 v181, v181
    v_exp_f32 v182, v182
    v_exp_f32 v183, v183
    s_add_u32 m0, m0, s53
    s_add_u32 s58, s58, s56
    buffer_load_dwordx4 v6, s[32:35], s58 offen lds
    v_exp_f32 v184, v184
    v_exp_f32 v185, v185
    v_exp_f32 v186, v186
    v_exp_f32 v187, v187
    v_exp_f32 v188, v188
    v_exp_f32 v189, v189
    v_exp_f32 v190, v190
    v_exp_f32 v191, v191
    v_exp_f32 v192, v192
    v_exp_f32 v193, v193
    v_exp_f32 v194, v194
    v_exp_f32 v195, v195
    s_add_u32 m0, m0, s53
    s_add_u32 s58, s58, s56
    buffer_load_dwordx4 v6, s[32:35], s58 offen lds
    v_pk_fma_f32 v[168:169], v[168:169], v[154:155], v[154:155] op_sel:[0,0,0] op_sel_hi:[1,0,0]
    v_pk_fma_f32 v[170:171], v[170:171], v[154:155], v[154:155] op_sel:[0,0,0] op_sel_hi:[1,0,0]
    v_pk_fma_f32 v[172:173], v[172:173], v[154:155], v[154:155] op_sel:[0,0,0] op_sel_hi:[1,0,0]
    v_pk_fma_f32 v[174:175], v[174:175], v[154:155], v[154:155] op_sel:[0,0,0] op_sel_hi:[1,0,0]
    v_pk_fma_f32 v[176:177], v[176:177], v[154:155], v[154:155] op_sel:[0,0,0] op_sel_hi:[1,0,0]
    v_pk_fma_f32 v[178:179], v[178:179], v[154:155], v[154:155] op_sel:[0,0,0] op_sel_hi:[1,0,0]
    v_pk_fma_f32 v[180:181], v[180:181], v[154:155], v[154:155] op_sel:[0,0,0] op_sel_hi:[1,0,0]
    v_pk_fma_f32 v[182:183], v[182:183], v[154:155], v[154:155] op_sel:[0,0,0] op_sel_hi:[1,0,0]
    v_pk_fma_f32 v[184:185], v[184:185], v[154:155], v[154:155] op_sel:[0,0,0] op_sel_hi:[1,0,0]
    v_pk_fma_f32 v[186:187], v[186:187], v[154:155], v[154:155] op_sel:[0,0,0] op_sel_hi:[1,0,0]
    v_pk_fma_f32 v[188:189], v[188:189], v[154:155], v[154:155] op_sel:[0,0,0] op_sel_hi:[1,0,0]
    v_pk_fma_f32 v[190:191], v[190:191], v[154:155], v[154:155] op_sel:[0,0,0] op_sel_hi:[1,0,0]
    v_pk_fma_f32 v[192:193], v[192:193], v[154:155], v[154:155] op_sel:[0,0,0] op_sel_hi:[1,0,0]
    v_pk_fma_f32 v[194:195], v[194:195], v[154:155], v[154:155] op_sel:[0,0,0] op_sel_hi:[1,0,0]
    v_rcp_f32 v168, v168
    v_rcp_f32 v169, v169
    v_rcp_f32 v170, v170
    v_rcp_f32 v171, v171
    v_rcp_f32 v172, v172
    v_rcp_f32 v173, v173
    v_rcp_f32 v174, v174
    v_rcp_f32 v175, v175
    v_rcp_f32 v176, v176
    v_rcp_f32 v177, v177
    v_rcp_f32 v178, v178
    v_rcp_f32 v179, v179
    v_rcp_f32 v180, v180
    v_rcp_f32 v181, v181
    v_rcp_f32 v182, v182
    v_rcp_f32 v183, v183
    v_rcp_f32 v184, v184
    v_rcp_f32 v185, v185
    v_rcp_f32 v186, v186
    v_rcp_f32 v187, v187
    v_rcp_f32 v188, v188
    v_rcp_f32 v189, v189
    v_rcp_f32 v190, v190
    v_rcp_f32 v191, v191
    v_rcp_f32 v192, v192
    v_rcp_f32 v193, v193
    v_rcp_f32 v194, v194
    v_rcp_f32 v195, v195
    v_pk_mul_f32 v[84:85], v[84:85], v[168:169]
    v_pk_mul_f32 v[86:87], v[86:87], v[170:171]
    v_pk_mul_f32 v[88:89], v[88:89], v[172:173]
    v_pk_mul_f32 v[90:91], v[90:91], v[174:175]
    v_pk_mul_f32 v[92:93], v[92:93], v[176:177]
    v_pk_mul_f32 v[94:95], v[94:95], v[178:179]
    v_pk_mul_f32 v[96:97], v[96:97], v[180:181]
    v_pk_mul_f32 v[98:99], v[98:99], v[182:183]
    v_pk_mul_f32 v[100:101], v[100:101], v[184:185]
    v_pk_mul_f32 v[102:103], v[102:103], v[186:187]
    v_pk_mul_f32 v[104:105], v[104:105], v[188:189]
    v_pk_mul_f32 v[106:107], v[106:107], v[190:191]
    v_pk_mul_f32 v[108:109], v[108:109], v[192:193]
    v_pk_mul_f32 v[110:111], v[110:111], v[194:195]
    v_cvt_pk_bf16_f32 v212, v84, v85
    v_cvt_pk_bf16_f32 v213, v86, v87
    v_cvt_pk_bf16_f32 v214, v88, v89
    v_cvt_pk_bf16_f32 v215, v90, v91
    v_cvt_pk_bf16_f32 v216, v92, v93
    v_cvt_pk_bf16_f32 v217, v94, v95
    v_cvt_pk_bf16_f32 v218, v96, v97
    v_cvt_pk_bf16_f32 v219, v98, v99
    v_cvt_pk_bf16_f32 v220, v100, v101
    v_cvt_pk_bf16_f32 v221, v102, v103
    v_cvt_pk_bf16_f32 v222, v104, v105
    v_cvt_pk_bf16_f32 v223, v106, v107
    v_cvt_pk_bf16_f32 v224, v108, v109
    v_cvt_pk_bf16_f32 v225, v110, v111
    s_cmp_eq_u32 s51, 0
    s_cbranch_scc1 sc_52
    buffer_store_dwordx4 v[212:215], v146, s[4:7], s78 offen offset:0
    buffer_store_dwordx4 v[216:219], v146, s[4:7], s78 offen offset:1024
    buffer_store_dwordx4 v[220:223], v146, s[4:7], s78 offen offset:2048
    buffer_store_dwordx2 v[224:225], v146, s[4:7], s79 offen
scb_53:
    s_add_u32 m0, m0, s53
    s_add_u32 s58, s58, s56
    buffer_load_dwordx4 v6, s[32:35], s58 offen lds
    ds_read_b64_tr_b16 a[176:177], v8 offset:0
    ds_read_b64_tr_b16 a[178:179], v8 offset:2048
    ds_read_b64_tr_b16 a[180:181], v9 offset:0
    ds_read_b64_tr_b16 a[182:183], v9 offset:2048
    ds_read_b64_tr_b16 a[184:185], v10 offset:0
    ds_read_b64_tr_b16 a[186:187], v10 offset:2048
    ds_read_b64_tr_b16 a[188:189], v11 offset:0
    ds_read_b64_tr_b16 a[190:191], v11 offset:2048
    ds_read_b64_tr_b16 a[192:193], v8 offset:4096
    ds_read_b64_tr_b16 a[194:195], v8 offset:6144
    ds_read_b64_tr_b16 a[196:197], v9 offset:4096
    ds_read_b64_tr_b16 a[198:199], v9 offset:6144
    s_add_u32 m0, m0, s53
    s_add_u32 s58, s58, s56
    buffer_load_dwordx4 v6, s[32:35], s58 offen lds
    ds_read_b64_tr_b16 a[200:201], v10 offset:4096
    ds_read_b64_tr_b16 a[202:203], v10 offset:6144
    ds_read_b64_tr_b16 a[204:205], v11 offset:4096
    ds_read_b64_tr_b16 a[206:207], v11 offset:6144
    ds_read_b64_tr_b16 a[208:209], v8 offset:8192
    ds_read_b64_tr_b16 a[210:211], v8 offset:10240
    ds_read_b64_tr_b16 a[212:213], v9 offset:8192
    ds_read_b64_tr_b16 a[214:215], v9 offset:10240
    ds_read_b64_tr_b16 a[216:217], v10 offset:8192
    ds_read_b64_tr_b16 a[218:219], v10 offset:10240
    ds_read_b64_tr_b16 a[220:221], v11 offset:8192
    ds_read_b64_tr_b16 a[222:223], v11 offset:10240
    s_add_u32 m0, m0, s53
    s_add_u32 s58, s58, s56
    buffer_load_dwordx4 v6, s[32:35], s58 offen lds
    ds_read_b64_tr_b16 a[224:225], v8 offset:12288
    ds_read_b64_tr_b16 a[226:227], v8 offset:14336
    ds_read_b64_tr_b16 a[228:229], v9 offset:12288
    ds_read_b64_tr_b16 a[230:231], v9 offset:14336
    ds_read_b64_tr_b16 a[232:233], v10 offset:12288
    ds_read_b64_tr_b16 a[234:235], v10 offset:14336
    ds_read_b64_tr_b16 a[236:237], v11 offset:12288
    ds_read_b64_tr_b16 a[238:239], v11 offset:14336
    ds_read_b64_tr_b16 a[240:241], v8 offset:16384
    ds_read_b64_tr_b16 a[242:243], v8 offset:18432
    ds_read_b64_tr_b16 a[244:245], v9 offset:16384
    ds_read_b64_tr_b16 a[246:247], v9 offset:18432
    s_add_u32 m0, m0, s53
    s_add_u32 s58, s58, s56
    buffer_load_dwordx4 v6, s[32:35], s58 offen lds
    ds_read_b64_tr_b16 a[248:249], v10 offset:16384
    ds_read_b64_tr_b16 a[250:251], v10 offset:18432
    ds_read_b64_tr_b16 a[252:253], v11 offset:16384
    ds_read_b64_tr_b16 a[254:255], v11 offset:18432
    ds_read_b64_tr_b16 v[40:41], v8 offset:20480
    ds_read_b64_tr_b16 v[42:43], v8 offset:22528
    ds_read_b64_tr_b16 v[44:45], v9 offset:20480
    ds_read_b64_tr_b16 v[46:47], v9 offset:22528
    ds_read_b64_tr_b16 v[48:49], v10 offset:20480
    ds_read_b64_tr_b16 v[50:51], v10 offset:22528
    ds_read_b64_tr_b16 v[52:53], v11 offset:20480
    ds_read_b64_tr_b16 v[54:55], v11 offset:22528
    ds_read_b64_tr_b16 v[56:57], v8 offset:24576
    ds_read_b64_tr_b16 v[58:59], v8 offset:26624
    ds_read_b64_tr_b16 v[60:61], v9 offset:24576
    ds_read_b64_tr_b16 v[62:63], v9 offset:26624
    ds_read_b64_tr_b16 v[64:65], v10 offset:24576
    ds_read_b64_tr_b16 v[66:67], v10 offset:26624
    ds_read_b64_tr_b16 v[68:69], v11 offset:24576
    ds_read_b64_tr_b16 v[70:71], v11 offset:26624
    ds_read_b64_tr_b16 v[72:73], v8 offset:28672
    ds_read_b64_tr_b16 v[74:75], v8 offset:30720
    ds_read_b64_tr_b16 v[76:77], v9 offset:28672
    ds_read_b64_tr_b16 v[78:79], v9 offset:30720
    ds_read_b64_tr_b16 v[80:81], v10 offset:28672
    ds_read_b64_tr_b16 v[82:83], v10 offset:30720
    ds_read_b64_tr_b16 v[84:85], v11 offset:28672
    ds_read_b64_tr_b16 v[86:87], v11 offset:30720
    v_add_u32 v240, 17408, v1
    v_add_u32 v241, 33792, v1
    v_add_u32 v242, 50176, v1
    v_add_u32 v243, 66560, v1
    s_add_u32 s64, s64, 1
    v_mov_b32 v21, s65
    v_mov_b32 v20, s64
    s_mov_b64 exec, 1
    s_waitcnt vmcnt(4)
    s_cmp_eq_u32 s51, 0
    s_cbranch_scc1 sc_54
    buffer_store_dwordx2 v[20:21], off, s[8:11], s71
scb_55:
    s_mov_b64 exec, -1
    s_add_u32 m0, m0, s53
    s_add_u32 s58, s58, s56
    buffer_load_dwordx4 v6, s[32:35], s58 offen lds
    ds_read_b64_tr_b16 v[88:89], v8 offset:32768
    ds_read_b64_tr_b16 v[90:91], v8 offset:34816
    ds_read_b64_tr_b16 v[92:93], v9 offset:32768
    ds_read_b64_tr_b16 v[94:95], v9 offset:34816
    ds_read_b64_tr_b16 v[96:97], v10 offset:32768
    ds_read_b64_tr_b16 v[98:99], v10 offset:34816
    ds_read_b64_tr_b16 v[100:101], v11 offset:32768
    ds_read_b64_tr_b16 v[102:103], v11 offset:34816
    s_add_u32 m0, m0, s53
    s_add_u32 s58, s58, s56
    buffer_load_dwordx4 v6, s[32:35], s58 offen lds
    ds_read_b64_tr_b16 v[104:105], v8 offset:36864
    ds_read_b64_tr_b16 v[106:107], v8 offset:38912
    ds_read_b64_tr_b16 v[108:109], v9 offset:36864
    ds_read_b64_tr_b16 v[110:111], v9 offset:38912
    ds_read_b64_tr_b16 v[112:113], v10 offset:36864
    ds_read_b64_tr_b16 v[114:115], v10 offset:38912
    ds_read_b64_tr_b16 v[116:117], v11 offset:36864
    ds_read_b64_tr_b16 v[118:119], v11 offset:38912
    s_add_u32 m0, m0, s53
    s_add_u32 s58, s58, s56
    buffer_load_dwordx4 v6, s[32:35], s58 offen lds
    ds_read_b64_tr_b16 v[120:121], v8 offset:40960
    ds_read_b64_tr_b16 v[122:123], v8 offset:43008
    ds_read_b64_tr_b16 v[124:125], v9 offset:40960
    ds_read_b64_tr_b16 v[126:127], v9 offset:43008
    ds_read_b64_tr_b16 v[128:129], v10 offset:40960
    ds_read_b64_tr_b16 v[130:131], v10 offset:43008
    ds_read_b64_tr_b16 v[132:133], v11 offset:40960
    ds_read_b64_tr_b16 v[134:135], v11 offset:43008
    s_add_u32 m0, m0, s53
    s_add_u32 s58, s58, s56
    buffer_load_dwordx4 v6, s[32:35], s58 offen lds
    s_waitcnt lgkmcnt(0)
    s_barrier
    s_add_u32 m0, s68, 0
    s_mov_b32 s58, 1638400
    buffer_load_dwordx4 v6, s[32:35], s58 offen lds
    s_add_u32 m0, m0, s53
    s_add_u32 s58, s58, s56
    buffer_load_dwordx4 v6, s[32:35], s58 offen lds
    s_add_u32 m0, m0, s53
    s_add_u32 s58, s58, s56
    buffer_load_dwordx4 v6, s[32:35], s58 offen lds
    s_add_u32 m0, m0, s53
    s_add_u32 s58, s58, s56
    buffer_load_dwordx4 v6, s[32:35], s58 offen lds
    s_add_u32 m0, m0, s53
    s_add_u32 s58, s58, s56
    buffer_load_dwordx4 v6, s[32:35], s58 offen lds
    s_add_u32 m0, m0, s53
    s_add_u32 s58, s58, s56
    buffer_load_dwordx4 v6, s[32:35], s58 offen lds
    s_lshr_b32 s76, s2, 3
    s_lshl2_add_u32 s76, s76, s44
    s_mul_i32 s76, s76, 12288
    v_lshl_add_u32 v244, v0, 4, s76
    s_mov_b32 s59, 0x8000
poll_56:
    buffer_load_dwordx2 v[20:21], v16, s[8:11], 0 offen sc1
    s_sub_u32 s59, s59, 1
    s_cbranch_scc1 bail
    s_waitcnt vmcnt(0)
    v_cmp_ne_u64 vcc, s[64:65], v[20:21]
    s_cbranch_vccnz poll_56
    buffer_load_dwordx4 v[136:139], v240, s[4:7], 0 offen offset:0 sc1
    buffer_load_dwordx4 v[140:143], v240, s[4:7], 0 offen offset:1024 sc1
    buffer_load_dwordx4 v[144:147], v241, s[4:7], s53 offen offset:2048 sc1
    buffer_load_dwordx4 v[148:151], v240, s[4:7], 0 offen offset:2048 sc1
    buffer_load_dwordx4 v[152:155], v241, s[4:7], s53 offen offset:3072 sc1
    buffer_load_dwordx4 v[156:159], v241, s[4:7], s54 offen offset:0 sc1
    buffer_load_dwordx4 v[160:163], v240, s[4:7], 0 offen offset:3072 sc1
    buffer_load_dwordx4 v[164:167], v241, s[4:7], s54 offen offset:1024 sc1
    buffer_load_dwordx4 v[168:171], v240, s[4:7], s53 offen offset:0 sc1
    buffer_load_dwordx4 v[172:175], v241, s[4:7], s54 offen offset:2048 sc1
    buffer_load_dwordx4 v[176:179], v243, s[4:7], 0 offen offset:2048 sc1
    buffer_load_dwordx4 v[180:183], v240, s[4:7], s53 offen offset:1024 sc1
    s_barrier
    s_waitcnt vmcnt(11)
    v_mfma_f32_16x16x32_bf16 v[24:27], a[0:3], v[136:139], v[24:27]
    buffer_load_dwordx4 v[184:187], v243, s[4:7], 0 offen offset:3072 sc1
    ds_read_b64_tr_b16 v[200:201], v8 offset:45056
    ds_read_b64_tr_b16 v[202:203], v8 offset:47104
    v_mfma_f32_16x16x32_bf16 v[28:31], a[4:7], v[136:139], v[28:31]
    ds_read_b64_tr_b16 v[204:205], v9 offset:45056
    ds_read_b64_tr_b16 v[206:207], v9 offset:47104
    v_mfma_f32_16x16x32_bf16 v[32:35], a[8:11], v[136:139], v[32:35]
    ds_read_b64_tr_b16 v[208:209], v10 offset:45056
    ds_read_b64_tr_b16 v[210:211], v10 offset:47104
    v_mfma_f32_16x16x32_bf16 v[36:39], a[12:15], v[136:139], v[36:39]
    ds_read_b64_tr_b16 v[212:213], v11 offset:45056
    ds_read_b64_tr_b16 v[214:215], v11 offset:47104
    s_waitcnt vmcnt(11)
    v_mfma_f32_16x16x32_bf16 v[24:27], a[16:19], v[140:143], v[24:27]
    buffer_load_dwordx4 v[188:191], v240, s[4:7], s53 offen offset:2048 sc1
    ds_read_b64_tr_b16 v[216:217], v8 offset:49152
    ds_read_b64_tr_b16 v[218:219], v8 offset:51200
    v_mfma_f32_16x16x32_bf16 v[28:31], a[20:23], v[140:143], v[28:31]
    ds_read_b64_tr_b16 v[220:221], v9 offset:49152
    ds_read_b64_tr_b16 v[222:223], v9 offset:51200
    v_mfma_f32_16x16x32_bf16 v[32:35], a[24:27], v[140:143], v[32:35]
    buffer_load_dword v255, v244, s[12:15], 0 offen offset:1024
    ds_read_b64_tr_b16 v[224:225], v10 offset:49152
    ds_read_b64_tr_b16 v[226:227], v10 offset:51200
    v_mfma_f32_16x16x32_bf16 v[36:39], a[28:31], v[140:143], v[36:39]
    s_waitcnt vmcnt(12) lgkmcnt(10)
    v_mfma_f32_16x16x32_bf16 v[24:27], v[200:203], v[144:147], v[24:27]
    buffer_load_dwordx4 v[192:195], v243, s[4:7], s53 offen offset:0 sc1
    v_mfma_f32_16x16x32_bf16 v[28:31], v[204:207], v[144:147], v[28:31]
    ds_read_b64_tr_b16 v[228:229], v11 offset:49152
    ds_read_b64_tr_b16 v[230:231], v11 offset:51200
    s_waitcnt lgkmcnt(8)
    v_mfma_f32_16x16x32_bf16 v[32:35], v[208:211], v[144:147], v[32:35]
    ds_read_b64_tr_b16 v[200:201], v8 offset:53248
    ds_read_b64_tr_b16 v[202:203], v8 offset:55296
    v_mfma_f32_16x16x32_bf16 v[36:39], v[212:215], v[144:147], v[36:39]
    ds_read_b64_tr_b16 v[204:205], v9 offset:53248
    ds_read_b64_tr_b16 v[206:207], v9 offset:55296
    s_waitcnt vmcnt(12)
    v_mfma_f32_16x16x32_bf16 v[24:27], a[32:35], v[148:151], v[24:27]
    buffer_load_dwordx4 v[196:199], v243, s[4:7], s53 offen offset:1024 sc1
    ds_read_b64_tr_b16 v[208:209], v10 offset:53248
    ds_read_b64_tr_b16 v[210:211], v10 offset:55296
    v_mfma_f32_16x16x32_bf16 v[28:31], a[36:39], v[148:151], v[28:31]
    v_mfma_f32_16x16x32_bf16 v[32:35], a[40:43], v[148:151], v[32:35]
    v_mfma_f32_16x16x32_bf16 v[36:39], a[44:47], v[148:151], v[36:39]
    s_waitcnt vmcnt(12) lgkmcnt(10)
    v_mfma_f32_16x16x32_bf16 v[24:27], v[216:219], v[152:155], v[24:27]
    buffer_load_dwordx4 v[136:139], v240, s[4:7], s53 offen offset:3072 sc1
    v_mfma_f32_16x16x32_bf16 v[28:31], v[220:223], v[152:155], v[28:31]
    ds_read_b64_tr_b16 v[212:213], v11 offset:53248
    ds_read_b64_tr_b16 v[214:215], v11 offset:55296
    s_waitcnt lgkmcnt(8)
    v_mfma_f32_16x16x32_bf16 v[32:35], v[224:227], v[152:155], v[32:35]
    ds_read_b64_tr_b16 v[216:217], v8 offset:57344
    ds_read_b64_tr_b16 v[218:219], v8 offset:59392
    v_mfma_f32_16x16x32_bf16 v[36:39], v[228:231], v[152:155], v[36:39]
    ds_read_b64_tr_b16 v[220:221], v9 offset:57344
    ds_read_b64_tr_b16 v[222:223], v9 offset:59392
    s_waitcnt vmcnt(12) lgkmcnt(8)
    v_mfma_f32_16x16x32_bf16 v[24:27], v[200:203], v[156:159], v[24:27]
    buffer_load_dwordx4 v[140:143], v243, s[4:7], s53 offen offset:2048 sc1
    ds_read_b64_tr_b16 v[224:225], v10 offset:57344
    ds_read_b64_tr_b16 v[226:227], v10 offset:59392
    v_mfma_f32_16x16x32_bf16 v[28:31], v[204:207], v[156:159], v[28:31]
    ds_read_b64_tr_b16 v[228:229], v11 offset:57344
    ds_read_b64_tr_b16 v[230:231], v11 offset:59392
    s_waitcnt lgkmcnt(8)
    v_mfma_f32_16x16x32_bf16 v[32:35], v[208:211], v[156:159], v[32:35]
    buffer_load_dword v255, v244, s[12:15], 0 offen offset:2048
    ds_read_b64_tr_b16 v[200:201], v8 offset:61440
    ds_read_b64_tr_b16 v[202:203], v8 offset:63488
    v_mfma_f32_16x16x32_bf16 v[36:39], v[212:215], v[156:159], v[36:39]
    ds_read_b64_tr_b16 v[204:205], v9 offset:61440
    ds_read_b64_tr_b16 v[206:207], v9 offset:63488
    s_waitcnt vmcnt(13)
    v_mfma_f32_16x16x32_bf16 v[24:27], a[48:51], v[160:163], v[24:27]
    buffer_load_dwordx4 v[144:147], v240, s[4:7], s54 offen offset:0 sc1
    ds_read_b64_tr_b16 v[208:209], v10 offset:61440
    ds_read_b64_tr_b16 v[210:211], v10 offset:63488
    v_mfma_f32_16x16x32_bf16 v[28:31], a[52:55], v[160:163], v[28:31]
    v_mfma_f32_16x16x32_bf16 v[32:35], a[56:59], v[160:163], v[32:35]
    v_mfma_f32_16x16x32_bf16 v[36:39], a[60:63], v[160:163], v[36:39]
    s_waitcnt vmcnt(13) lgkmcnt(10)
    v_mfma_f32_16x16x32_bf16 v[24:27], v[216:219], v[164:167], v[24:27]
    buffer_load_dwordx4 v[148:151], v243, s[4:7], s53 offen offset:3072 sc1
    v_mfma_f32_16x16x32_bf16 v[28:31], v[220:223], v[164:167], v[28:31]
    ds_read_b64_tr_b16 v[212:213], v11 offset:61440
    ds_read_b64_tr_b16 v[214:215], v11 offset:63488
    s_waitcnt lgkmcnt(8)
    v_mfma_f32_16x16x32_bf16 v[32:35], v[224:227], v[164:167], v[32:35]
    ds_read_b64_tr_b16 v[216:217], v8 offset:0
    ds_read_b64_tr_b16 v[218:219], v8 offset:2048
    v_mfma_f32_16x16x32_bf16 v[36:39], v[228:231], v[164:167], v[36:39]
    ds_read_b64_tr_b16 v[220:221], v9 offset:0
    ds_read_b64_tr_b16 v[222:223], v9 offset:2048
    s_waitcnt vmcnt(13)
    v_mfma_f32_16x16x32_bf16 v[24:27], a[64:67], v[168:171], v[24:27]
    buffer_load_dwordx4 v[152:155], v241, s[4:7], s54 offen offset:3072 sc1
    ds_read_b64_tr_b16 v[224:225], v10 offset:0
    ds_read_b64_tr_b16 v[226:227], v10 offset:2048
    v_mfma_f32_16x16x32_bf16 v[28:31], a[68:71], v[168:171], v[28:31]
    v_mfma_f32_16x16x32_bf16 v[32:35], a[72:75], v[168:171], v[32:35]
    v_mfma_f32_16x16x32_bf16 v[36:39], a[76:79], v[168:171], v[36:39]
    s_waitcnt vmcnt(13) lgkmcnt(10)
    v_mfma_f32_16x16x32_bf16 v[24:27], v[200:203], v[172:175], v[24:27]
    buffer_load_dwordx4 v[156:159], v240, s[4:7], s54 offen offset:1024 sc1
    v_mfma_f32_16x16x32_bf16 v[28:31], v[204:207], v[172:175], v[28:31]
    ds_read_b64_tr_b16 v[228:229], v11 offset:0
    ds_read_b64_tr_b16 v[230:231], v11 offset:2048
    s_waitcnt lgkmcnt(8)
    v_mfma_f32_16x16x32_bf16 v[32:35], v[208:211], v[172:175], v[32:35]
    buffer_load_dword v255, v244, s[12:15], s53 offen offset:0
    ds_read_b64_tr_b16 v[200:201], v8 offset:4096
    ds_read_b64_tr_b16 v[202:203], v8 offset:6144
    v_mfma_f32_16x16x32_bf16 v[36:39], v[212:215], v[172:175], v[36:39]
    ds_read_b64_tr_b16 v[204:205], v9 offset:4096
    ds_read_b64_tr_b16 v[206:207], v9 offset:6144
    s_waitcnt vmcnt(14) lgkmcnt(8)
    v_mfma_f32_16x16x32_bf16 v[24:27], v[216:219], v[176:179], v[24:27]
    buffer_load_dwordx4 v[160:163], v241, s[4:7], s55 offen offset:0 sc1
    ds_read_b64_tr_b16 v[208:209], v10 offset:4096
    ds_read_b64_tr_b16 v[210:211], v10 offset:6144
    v_mfma_f32_16x16x32_bf16 v[28:31], v[220:223], v[176:179], v[28:31]
    ds_read_b64_tr_b16 v[212:213], v11 offset:4096
    ds_read_b64_tr_b16 v[214:215], v11 offset:6144
    s_waitcnt lgkmcnt(8)
    v_mfma_f32_16x16x32_bf16 v[32:35], v[224:227], v[176:179], v[32:35]
    ds_read_b64_tr_b16 v[216:217], v8 offset:8192
    ds_read_b64_tr_b16 v[218:219], v8 offset:10240
    v_mfma_f32_16x16x32_bf16 v[36:39], v[228:231], v[176:179], v[36:39]
    ds_read_b64_tr_b16 v[220:221], v9 offset:8192
    ds_read_b64_tr_b16 v[222:223], v9 offset:10240
    s_waitcnt vmcnt(14)
    v_mfma_f32_16x16x32_bf16 v[24:27], a[80:83], v[180:183], v[24:27]
    buffer_load_dwordx4 v[164:167], v240, s[4:7], s54 offen offset:2048 sc1
    ds_read_b64_tr_b16 v[224:225], v10 offset:8192
    ds_read_b64_tr_b16 v[226:227], v10 offset:10240
    v_mfma_f32_16x16x32_bf16 v[28:31], a[84:87], v[180:183], v[28:31]
    v_mfma_f32_16x16x32_bf16 v[32:35], a[88:91], v[180:183], v[32:35]
    v_mfma_f32_16x16x32_bf16 v[36:39], a[92:95], v[180:183], v[36:39]
    s_waitcnt vmcnt(14) lgkmcnt(10)
    v_mfma_f32_16x16x32_bf16 v[24:27], v[200:203], v[184:187], v[24:27]
    buffer_load_dwordx4 v[168:171], v241, s[4:7], s55 offen offset:1024 sc1
    v_mfma_f32_16x16x32_bf16 v[28:31], v[204:207], v[184:187], v[28:31]
    ds_read_b64_tr_b16 v[228:229], v11 offset:8192
    ds_read_b64_tr_b16 v[230:231], v11 offset:10240
    s_waitcnt lgkmcnt(8)
    v_mfma_f32_16x16x32_bf16 v[32:35], v[208:211], v[184:187], v[32:35]
    ds_read_b64_tr_b16 v[200:201], v8 offset:12288
    ds_read_b64_tr_b16 v[202:203], v8 offset:14336
    v_mfma_f32_16x16x32_bf16 v[36:39], v[212:215], v[184:187], v[36:39]
    ds_read_b64_tr_b16 v[204:205], v9 offset:12288
    ds_read_b64_tr_b16 v[206:207], v9 offset:14336
    s_waitcnt vmcnt(14)
    v_mfma_f32_16x16x32_bf16 v[24:27], a[96:99], v[188:191], v[24:27]
    buffer_load_dwordx4 v[172:175], v241, s[4:7], s55 offen offset:2048 sc1
    ds_read_b64_tr_b16 v[208:209], v10 offset:12288
    ds_read_b64_tr_b16 v[210:211], v10 offset:14336
    v_mfma_f32_16x16x32_bf16 v[28:31], a[100:103], v[188:191], v[28:31]
    v_mfma_f32_16x16x32_bf16 v[32:35], a[104:107], v[188:191], v[32:35]
    buffer_load_dword v255, v244, s[12:15], s53 offen offset:1024
    v_mfma_f32_16x16x32_bf16 v[36:39], a[108:111], v[188:191], v[36:39]
    s_waitcnt vmcnt(14) lgkmcnt(10)
    v_mfma_f32_16x16x32_bf16 v[24:27], v[216:219], v[192:195], v[24:27]
    buffer_load_dwordx4 v[176:179], v240, s[4:7], s54 offen offset:3072 sc1
    v_mfma_f32_16x16x32_bf16 v[28:31], v[220:223], v[192:195], v[28:31]
    ds_read_b64_tr_b16 v[212:213], v11 offset:12288
    ds_read_b64_tr_b16 v[214:215], v11 offset:14336
    s_waitcnt lgkmcnt(8)
    v_mfma_f32_16x16x32_bf16 v[32:35], v[224:227], v[192:195], v[32:35]
    ds_read_b64_tr_b16 v[216:217], v8 offset:16384
    ds_read_b64_tr_b16 v[218:219], v8 offset:18432
    v_mfma_f32_16x16x32_bf16 v[36:39], v[228:231], v[192:195], v[36:39]
    ds_read_b64_tr_b16 v[220:221], v9 offset:16384
    ds_read_b64_tr_b16 v[222:223], v9 offset:18432
    s_waitcnt vmcnt(14) lgkmcnt(8)
    v_mfma_f32_16x16x32_bf16 v[24:27], v[200:203], v[196:199], v[24:27]
    buffer_load_dwordx4 v[180:183], v241, s[4:7], s55 offen offset:3072 sc1
    ds_read_b64_tr_b16 v[224:225], v10 offset:16384
    ds_read_b64_tr_b16 v[226:227], v10 offset:18432
    v_mfma_f32_16x16x32_bf16 v[28:31], v[204:207], v[196:199], v[28:31]
    ds_read_b64_tr_b16 v[228:229], v11 offset:16384
    ds_read_b64_tr_b16 v[230:231], v11 offset:18432
    s_waitcnt lgkmcnt(8)
    v_mfma_f32_16x16x32_bf16 v[32:35], v[208:211], v[196:199], v[32:35]
    ds_read_b64_tr_b16 v[200:201], v8 offset:20480
    ds_read_b64_tr_b16 v[202:203], v8 offset:22528
    v_mfma_f32_16x16x32_bf16 v[36:39], v[212:215], v[196:199], v[36:39]
    ds_read_b64_tr_b16 v[204:205], v9 offset:20480
    ds_read_b64_tr_b16 v[206:207], v9 offset:22528
    s_waitcnt vmcnt(14)
    v_mfma_f32_16x16x32_bf16 v[24:27], a[112:115], v[136:139], v[24:27]
    buffer_load_dwordx4 v[184:187], v240, s[4:7], s55 offen offset:0 sc1
    ds_read_b64_tr_b16 v[208:209], v10 offset:20480
    ds_read_b64_tr_b16 v[210:211], v10 offset:22528
    v_mfma_f32_16x16x32_bf16 v[28:31], a[116:119], v[136:139], v[28:31]
    v_mfma_f32_16x16x32_bf16 v[32:35], a[120:123], v[136:139], v[32:35]
    v_mfma_f32_16x16x32_bf16 v[36:39], a[124:127], v[136:139], v[36:39]
    s_waitcnt vmcnt(14) lgkmcnt(10)
    v_mfma_f32_16x16x32_bf16 v[24:27], v[216:219], v[140:143], v[24:27]
    buffer_load_dwordx4 v[188:191], v242, s[4:7], 0 offen offset:0 sc1
    v_mfma_f32_16x16x32_bf16 v[28:31], v[220:223], v[140:143], v[28:31]
    ds_read_b64_tr_b16 v[212:213], v11 offset:20480
    ds_read_b64_tr_b16 v[214:215], v11 offset:22528
    s_waitcnt lgkmcnt(8)
    v_mfma_f32_16x16x32_bf16 v[32:35], v[224:227], v[140:143], v[32:35]
    buffer_load_dword v255, v244, s[12:15], s53 offen offset:3072
    ds_read_b64_tr_b16 v[216:217], v232 offset:0
    ds_read_b64_tr_b16 v[218:219], v232 offset:2048
    v_mfma_f32_16x16x32_bf16 v[36:39], v[228:231], v[140:143], v[36:39]
    ds_read_b64_tr_b16 v[220:221], v233 offset:0
    ds_read_b64_tr_b16 v[222:223], v233 offset:2048
    s_waitcnt vmcnt(14)
    v_mfma_f32_16x16x32_bf16 v[24:27], a[128:131], v[144:147], v[24:27]
    buffer_load_dwordx4 v[192:195], v242, s[4:7], 0 offen offset:1024 sc1
    ds_read_b64_tr_b16 v[224:225], v234 offset:0
    ds_read_b64_tr_b16 v[226:227], v234 offset:2048
    v_mfma_f32_16x16x32_bf16 v[28:31], a[132:135], v[144:147], v[28:31]
    v_mfma_f32_16x16x32_bf16 v[32:35], a[136:139], v[144:147], v[32:35]
    v_mfma_f32_16x16x32_bf16 v[36:39], a[140:143], v[144:147], v[36:39]
    s_waitcnt vmcnt(14) lgkmcnt(10)
    v_mfma_f32_16x16x32_bf16 v[24:27], v[200:203], v[148:151], v[24:27]
    buffer_load_dwordx4 v[196:199], v240, s[4:7], s55 offen offset:1024 sc1
    v_mfma_f32_16x16x32_bf16 v[28:31], v[204:207], v[148:151], v[28:31]
    ds_read_b64_tr_b16 v[228:229], v235 offset:0
    ds_read_b64_tr_b16 v[230:231], v235 offset:2048
    s_waitcnt lgkmcnt(8)
    v_mfma_f32_16x16x32_bf16 v[32:35], v[208:211], v[148:151], v[32:35]
    ds_read_b64_tr_b16 v[200:201], v232 offset:4096
    ds_read_b64_tr_b16 v[202:203], v232 offset:6144
    v_mfma_f32_16x16x32_bf16 v[36:39], v[212:215], v[148:151], v[36:39]
    ds_read_b64_tr_b16 v[204:205], v233 offset:4096
    ds_read_b64_tr_b16 v[206:207], v233 offset:6144
    s_waitcnt vmcnt(14) lgkmcnt(8)
    v_mfma_f32_16x16x32_bf16 v[24:27], v[216:219], v[152:155], v[24:27]
    buffer_load_dwordx4 v[136:139], v242, s[4:7], 0 offen offset:2048 sc1
    ds_read_b64_tr_b16 v[208:209], v234 offset:4096
    ds_read_b64_tr_b16 v[210:211], v234 offset:6144
    v_mfma_f32_16x16x32_bf16 v[28:31], v[220:223], v[152:155], v[28:31]
    ds_read_b64_tr_b16 v[212:213], v235 offset:4096
    ds_read_b64_tr_b16 v[214:215], v235 offset:6144
    s_waitcnt lgkmcnt(8)
    v_mfma_f32_16x16x32_bf16 v[32:35], v[224:227], v[152:155], v[32:35]
    ds_read_b64_tr_b16 v[216:217], v232 offset:8192
    ds_read_b64_tr_b16 v[218:219], v232 offset:10240
    v_mfma_f32_16x16x32_bf16 v[36:39], v[228:231], v[152:155], v[36:39]
    ds_read_b64_tr_b16 v[220:221], v233 offset:8192
    ds_read_b64_tr_b16 v[222:223], v233 offset:10240
    s_waitcnt vmcnt(14)
    v_mfma_f32_16x16x32_bf16 v[24:27], a[144:147], v[156:159], v[24:27]
    buffer_load_dwordx4 v[140:143], v240, s[4:7], s55 offen offset:2048 sc1
    ds_read_b64_tr_b16 v[224:225], v234 offset:8192
    ds_read_b64_tr_b16 v[226:227], v234 offset:10240
    v_mfma_f32_16x16x32_bf16 v[28:31], a[148:151], v[156:159], v[28:31]
    v_mfma_f32_16x16x32_bf16 v[32:35], a[152:155], v[156:159], v[32:35]
    buffer_load_dword v255, v244, s[12:15], s54 offen offset:0
    v_mfma_f32_16x16x32_bf16 v[36:39], a[156:159], v[156:159], v[36:39]
    s_waitcnt vmcnt(14) lgkmcnt(10)
    v_mfma_f32_16x16x32_bf16 v[24:27], v[200:203], v[160:163], v[24:27]
    buffer_load_dwordx4 v[144:147], v242, s[4:7], 0 offen offset:3072 sc1
    v_mfma_f32_16x16x32_bf16 v[28:31], v[204:207], v[160:163], v[28:31]
    ds_read_b64_tr_b16 v[228:229], v235 offset:8192
    ds_read_b64_tr_b16 v[230:231], v235 offset:10240
    s_waitcnt lgkmcnt(8)
    v_mfma_f32_16x16x32_bf16 v[32:35], v[208:211], v[160:163], v[32:35]
    ds_read_b64_tr_b16 v[200:201], v232 offset:12288
    ds_read_b64_tr_b16 v[202:203], v232 offset:14336
    v_mfma_f32_16x16x32_bf16 v[36:39], v[212:215], v[160:163], v[36:39]
    ds_read_b64_tr_b16 v[204:205], v233 offset:12288
    ds_read_b64_tr_b16 v[206:207], v233 offset:14336
    s_waitcnt vmcnt(14)
    v_mfma_f32_16x16x32_bf16 v[24:27], a[160:163], v[164:167], v[24:27]
    buffer_load_dwordx4 v[148:151], v242, s[4:7], s53 offen offset:0 sc1
    ds_read_b64_tr_b16 v[208:209], v234 offset:12288
    ds_read_b64_tr_b16 v[210:211], v234 offset:14336
    v_mfma_f32_16x16x32_bf16 v[28:31], a[164:167], v[164:167], v[28:31]
    v_mfma_f32_16x16x32_bf16 v[32:35], a[168:171], v[164:167], v[32:35]
    v_mfma_f32_16x16x32_bf16 v[36:39], a[172:175], v[164:167], v[36:39]
    s_waitcnt vmcnt(14) lgkmcnt(10)
    v_mfma_f32_16x16x32_bf16 v[24:27], v[216:219], v[168:171], v[24:27]
    buffer_load_dwordx4 v[152:155], v240, s[4:7], s55 offen offset:3072 sc1
    v_mfma_f32_16x16x32_bf16 v[28:31], v[220:223], v[168:171], v[28:31]
    ds_read_b64_tr_b16 v[212:213], v235 offset:12288
    ds_read_b64_tr_b16 v[214:215], v235 offset:14336
    s_waitcnt lgkmcnt(8)
    v_mfma_f32_16x16x32_bf16 v[32:35], v[224:227], v[168:171], v[32:35]
    ds_read_b64_tr_b16 v[216:217], v232 offset:16384
    ds_read_b64_tr_b16 v[218:219], v232 offset:18432
    v_mfma_f32_16x16x32_bf16 v[36:39], v[228:231], v[168:171], v[36:39]
    ds_read_b64_tr_b16 v[220:221], v233 offset:16384
    ds_read_b64_tr_b16 v[222:223], v233 offset:18432
    s_waitcnt vmcnt(14) lgkmcnt(8)
    v_mfma_f32_16x16x32_bf16 v[24:27], v[200:203], v[172:175], v[24:27]
    buffer_load_dwordx4 v[156:159], v242, s[4:7], s53 offen offset:1024 sc1
    ds_read_b64_tr_b16 v[224:225], v234 offset:16384
    ds_read_b64_tr_b16 v[226:227], v234 offset:18432
    v_mfma_f32_16x16x32_bf16 v[28:31], v[204:207], v[172:175], v[28:31]
    ds_read_b64_tr_b16 v[228:229], v235 offset:16384
    ds_read_b64_tr_b16 v[230:231], v235 offset:18432
    s_waitcnt lgkmcnt(8)
    v_mfma_f32_16x16x32_bf16 v[32:35], v[208:211], v[172:175], v[32:35]
    buffer_load_dword v255, v244, s[12:15], s54 offen offset:2048
    ds_read_b64_tr_b16 v[200:201], v232 offset:20480
    ds_read_b64_tr_b16 v[202:203], v232 offset:22528
    v_mfma_f32_16x16x32_bf16 v[36:39], v[212:215], v[172:175], v[36:39]
    ds_read_b64_tr_b16 v[204:205], v233 offset:20480
    ds_read_b64_tr_b16 v[206:207], v233 offset:22528
    s_waitcnt vmcnt(14)
    v_mfma_f32_16x16x32_bf16 v[24:27], a[176:179], v[176:179], v[24:27]
    buffer_load_dwordx4 v[160:163], v241, s[4:7], 0 offen offset:0 sc1
    ds_read_b64_tr_b16 v[208:209], v234 offset:20480
    ds_read_b64_tr_b16 v[210:211], v234 offset:22528
    v_mfma_f32_16x16x32_bf16 v[28:31], a[180:183], v[176:179], v[28:31]
    v_mfma_f32_16x16x32_bf16 v[32:35], a[184:187], v[176:179], v[32:35]
    v_mfma_f32_16x16x32_bf16 v[36:39], a[188:191], v[176:179], v[36:39]
    s_waitcnt vmcnt(14) lgkmcnt(10)
    v_mfma_f32_16x16x32_bf16 v[24:27], v[216:219], v[180:183], v[24:27]
    buffer_load_dwordx4 v[164:167], v242, s[4:7], s53 offen offset:2048 sc1
    v_mfma_f32_16x16x32_bf16 v[28:31], v[220:223], v[180:183], v[28:31]
    ds_read_b64_tr_b16 v[212:213], v235 offset:20480
    ds_read_b64_tr_b16 v[214:215], v235 offset:22528
    s_waitcnt lgkmcnt(8)
    v_mfma_f32_16x16x32_bf16 v[32:35], v[224:227], v[180:183], v[32:35]
    ds_read_b64_tr_b16 v[216:217], v232 offset:24576
    ds_read_b64_tr_b16 v[218:219], v232 offset:26624
    v_mfma_f32_16x16x32_bf16 v[36:39], v[228:231], v[180:183], v[36:39]
    ds_read_b64_tr_b16 v[220:221], v233 offset:24576
    ds_read_b64_tr_b16 v[222:223], v233 offset:26624
    s_waitcnt vmcnt(14)
    v_mfma_f32_16x16x32_bf16 v[24:27], a[192:195], v[184:187], v[24:27]
    buffer_load_dwordx4 v[168:171], v242, s[4:7], s53 offen offset:3072 sc1
    ds_read_b64_tr_b16 v[224:225], v234 offset:24576
    ds_read_b64_tr_b16 v[226:227], v234 offset:26624
    v_mfma_f32_16x16x32_bf16 v[28:31], a[196:199], v[184:187], v[28:31]
    v_mfma_f32_16x16x32_bf16 v[32:35], a[200:203], v[184:187], v[32:35]
    v_mfma_f32_16x16x32_bf16 v[36:39], a[204:207], v[184:187], v[36:39]
    s_waitcnt vmcnt(14) lgkmcnt(10)
    v_mfma_f32_16x16x32_bf16 v[24:27], v[200:203], v[188:191], v[24:27]
    buffer_load_dwordx4 v[172:175], v241, s[4:7], 0 offen offset:1024 sc1
    v_mfma_f32_16x16x32_bf16 v[28:31], v[204:207], v[188:191], v[28:31]
    ds_read_b64_tr_b16 v[228:229], v235 offset:24576
    ds_read_b64_tr_b16 v[230:231], v235 offset:26624
    s_waitcnt lgkmcnt(8)
    v_mfma_f32_16x16x32_bf16 v[32:35], v[208:211], v[188:191], v[32:35]
    buffer_load_dword v255, v244, s[12:15], s54 offen offset:3072
    ds_read_b64_tr_b16 v[200:201], v232 offset:28672
    ds_read_b64_tr_b16 v[202:203], v232 offset:30720
    v_mfma_f32_16x16x32_bf16 v[36:39], v[212:215], v[188:191], v[36:39]
    ds_read_b64_tr_b16 v[204:205], v233 offset:28672
    ds_read_b64_tr_b16 v[206:207], v233 offset:30720
    s_waitcnt vmcnt(14) lgkmcnt(8)
    v_mfma_f32_16x16x32_bf16 v[24:27], v[216:219], v[192:195], v[24:27]
    buffer_load_dwordx4 v[176:179], v242, s[4:7], s54 offen offset:0 sc1
    ds_read_b64_tr_b16 v[208:209], v234 offset:28672
    ds_read_b64_tr_b16 v[210:211], v234 offset:30720
    v_mfma_f32_16x16x32_bf16 v[28:31], v[220:223], v[192:195], v[28:31]
    ds_read_b64_tr_b16 v[212:213], v235 offset:28672
    ds_read_b64_tr_b16 v[214:215], v235 offset:30720
    s_waitcnt lgkmcnt(8)
    v_mfma_f32_16x16x32_bf16 v[32:35], v[224:227], v[192:195], v[32:35]
    ds_read_b64_tr_b16 v[216:217], v232 offset:32768
    ds_read_b64_tr_b16 v[218:219], v232 offset:34816
    v_mfma_f32_16x16x32_bf16 v[36:39], v[228:231], v[192:195], v[36:39]
    ds_read_b64_tr_b16 v[220:221], v233 offset:32768
    ds_read_b64_tr_b16 v[222:223], v233 offset:34816
    s_waitcnt vmcnt(14)
    v_mfma_f32_16x16x32_bf16 v[24:27], a[208:211], v[196:199], v[24:27]
    buffer_load_dwordx4 v[180:183], v241, s[4:7], 0 offen offset:2048 sc1
    ds_read_b64_tr_b16 v[224:225], v234 offset:32768
    ds_read_b64_tr_b16 v[226:227], v234 offset:34816
    v_mfma_f32_16x16x32_bf16 v[28:31], a[212:215], v[196:199], v[28:31]
    v_mfma_f32_16x16x32_bf16 v[32:35], a[216:219], v[196:199], v[32:35]
    v_mfma_f32_16x16x32_bf16 v[36:39], a[220:223], v[196:199], v[36:39]
    s_waitcnt vmcnt(14) lgkmcnt(10)
    v_mfma_f32_16x16x32_bf16 v[24:27], v[200:203], v[136:139], v[24:27]
    buffer_load_dwordx4 v[184:187], v242, s[4:7], s54 offen offset:1024 sc1
    v_mfma_f32_16x16x32_bf16 v[28:31], v[204:207], v[136:139], v[28:31]
    ds_read_b64_tr_b16 v[228:229], v235 offset:32768
    ds_read_b64_tr_b16 v[230:231], v235 offset:34816
    s_waitcnt lgkmcnt(8)
    v_mfma_f32_16x16x32_bf16 v[32:35], v[208:211], v[136:139], v[32:35]
    ds_read_b64_tr_b16 v[200:201], v232 offset:36864
    ds_read_b64_tr_b16 v[202:203], v232 offset:38912
    v_mfma_f32_16x16x32_bf16 v[36:39], v[212:215], v[136:139], v[36:39]
    ds_read_b64_tr_b16 v[204:205], v233 offset:36864
    ds_read_b64_tr_b16 v[206:207], v233 offset:38912
    s_waitcnt vmcnt(14)
    v_mfma_f32_16x16x32_bf16 v[24:27], a[224:227], v[140:143], v[24:27]
    buffer_load_dwordx4 v[188:191], v242, s[4:7], s54 offen offset:2048 sc1
    ds_read_b64_tr_b16 v[208:209], v234 offset:36864
    ds_read_b64_tr_b16 v[210:211], v234 offset:38912
    v_mfma_f32_16x16x32_bf16 v[28:31], a[228:231], v[140:143], v[28:31]
    v_mfma_f32_16x16x32_bf16 v[32:35], a[232:235], v[140:143], v[32:35]
    buffer_load_dword v255, v244, s[12:15], 0 offen offset:0
    v_mfma_f32_16x16x32_bf16 v[36:39], a[236:239], v[140:143], v[36:39]
    s_waitcnt vmcnt(14) lgkmcnt(10)
    v_mfma_f32_16x16x32_bf16 v[24:27], v[216:219], v[144:147], v[24:27]
    buffer_load_dwordx4 v[192:195], v241, s[4:7], 0 offen offset:3072 sc1
    v_mfma_f32_16x16x32_bf16 v[28:31], v[220:223], v[144:147], v[28:31]
    ds_read_b64_tr_b16 v[212:213], v235 offset:36864
    ds_read_b64_tr_b16 v[214:215], v235 offset:38912
    s_waitcnt lgkmcnt(8)
    v_mfma_f32_16x16x32_bf16 v[32:35], v[224:227], v[144:147], v[32:35]
    ds_read_b64_tr_b16 v[216:217], v232 offset:40960
    ds_read_b64_tr_b16 v[218:219], v232 offset:43008
    v_mfma_f32_16x16x32_bf16 v[36:39], v[228:231], v[144:147], v[36:39]
    ds_read_b64_tr_b16 v[220:221], v233 offset:40960
    ds_read_b64_tr_b16 v[222:223], v233 offset:43008
    s_waitcnt vmcnt(14) lgkmcnt(8)
    v_mfma_f32_16x16x32_bf16 v[24:27], v[200:203], v[148:151], v[24:27]
    buffer_load_dwordx4 v[196:199], v242, s[4:7], s54 offen offset:3072 sc1
    ds_read_b64_tr_b16 v[224:225], v234 offset:40960
    ds_read_b64_tr_b16 v[226:227], v234 offset:43008
    v_mfma_f32_16x16x32_bf16 v[28:31], v[204:207], v[148:151], v[28:31]
    ds_read_b64_tr_b16 v[228:229], v235 offset:40960
    ds_read_b64_tr_b16 v[230:231], v235 offset:43008
    s_waitcnt lgkmcnt(8)
    v_mfma_f32_16x16x32_bf16 v[32:35], v[208:211], v[148:151], v[32:35]
    ds_read_b64_tr_b16 v[200:201], v232 offset:45056
    ds_read_b64_tr_b16 v[202:203], v232 offset:47104
    v_mfma_f32_16x16x32_bf16 v[36:39], v[212:215], v[148:151], v[36:39]
    ds_read_b64_tr_b16 v[204:205], v233 offset:45056
    ds_read_b64_tr_b16 v[206:207], v233 offset:47104
    s_waitcnt vmcnt(14)
    v_mfma_f32_16x16x32_bf16 v[24:27], a[240:243], v[152:155], v[24:27]
    buffer_load_dwordx4 v[136:139], v241, s[4:7], s53 offen offset:0 sc1
    ds_read_b64_tr_b16 v[208:209], v234 offset:45056
    ds_read_b64_tr_b16 v[210:211], v234 offset:47104
    v_mfma_f32_16x16x32_bf16 v[28:31], a[244:247], v[152:155], v[28:31]
    v_mfma_f32_16x16x32_bf16 v[32:35], a[248:251], v[152:155], v[32:35]
    v_mfma_f32_16x16x32_bf16 v[36:39], a[252:255], v[152:155], v[36:39]
    s_waitcnt vmcnt(14) lgkmcnt(10)
    v_mfma_f32_16x16x32_bf16 v[24:27], v[216:219], v[156:159], v[24:27]
    buffer_load_dwordx4 v[140:143], v242, s[4:7], s55 offen offset:0 sc1
    v_mfma_f32_16x16x32_bf16 v[28:31], v[220:223], v[156:159], v[28:31]
    ds_read_b64_tr_b16 v[212:213], v235 offset:45056
    ds_read_b64_tr_b16 v[214:215], v235 offset:47104
    s_waitcnt lgkmcnt(8)
    v_mfma_f32_16x16x32_bf16 v[32:35], v[224:227], v[156:159], v[32:35]
    buffer_load_dword v255, v244, s[12:15], 0 offen offset:3072
    ds_read_b64_tr_b16 v[216:217], v232 offset:49152
    ds_read_b64_tr_b16 v[218:219], v232 offset:51200
    v_mfma_f32_16x16x32_bf16 v[36:39], v[228:231], v[156:159], v[36:39]
    ds_read_b64_tr_b16 v[220:221], v233 offset:49152
    ds_read_b64_tr_b16 v[222:223], v233 offset:51200
    s_waitcnt vmcnt(14)
    v_mfma_f32_16x16x32_bf16 v[24:27], v[40:43], v[160:163], v[24:27]
    buffer_load_dwordx4 v[144:147], v242, s[4:7], s55 offen offset:1024 sc1
    ds_read_b64_tr_b16 v[224:225], v234 offset:49152
    ds_read_b64_tr_b16 v[226:227], v234 offset:51200
    v_mfma_f32_16x16x32_bf16 v[28:31], v[44:47], v[160:163], v[28:31]
    v_mfma_f32_16x16x32_bf16 v[32:35], v[48:51], v[160:163], v[32:35]
    v_mfma_f32_16x16x32_bf16 v[36:39], v[52:55], v[160:163], v[36:39]
    s_waitcnt vmcnt(14) lgkmcnt(10)
    v_mfma_f32_16x16x32_bf16 v[24:27], v[200:203], v[164:167], v[24:27]
    buffer_load_dwordx4 v[148:151], v241, s[4:7], s53 offen offset:1024 sc1
    v_mfma_f32_16x16x32_bf16 v[28:31], v[204:207], v[164:167], v[28:31]
    ds_read_b64_tr_b16 v[228:229], v235 offset:49152
    ds_read_b64_tr_b16 v[230:231], v235 offset:51200
    s_waitcnt lgkmcnt(8)
    v_mfma_f32_16x16x32_bf16 v[32:35], v[208:211], v[164:167], v[32:35]
    ds_read_b64_tr_b16 v[200:201], v232 offset:53248
    ds_read_b64_tr_b16 v[202:203], v232 offset:55296
    v_mfma_f32_16x16x32_bf16 v[36:39], v[212:215], v[164:167], v[36:39]
    ds_read_b64_tr_b16 v[204:205], v233 offset:53248
    ds_read_b64_tr_b16 v[206:207], v233 offset:55296
    s_barrier
    s_waitcnt vmcnt(14) lgkmcnt(8)
    v_mfma_f32_16x16x32_bf16 v[24:27], v[216:219], v[168:171], v[24:27]
    buffer_load_dwordx4 v[152:155], v242, s[4:7], s55 offen offset:2048 sc1
    ds_read_b64_tr_b16 v[208:209], v234 offset:53248
    ds_read_b64_tr_b16 v[210:211], v234 offset:55296
    v_mfma_f32_16x16x32_bf16 v[28:31], v[220:223], v[168:171], v[28:31]
    ds_read_b64_tr_b16 v[212:213], v235 offset:53248
    ds_read_b64_tr_b16 v[214:215], v235 offset:55296
    s_waitcnt lgkmcnt(8)
    v_mfma_f32_16x16x32_bf16 v[32:35], v[224:227], v[168:171], v[32:35]
    ds_read_b64_tr_b16 v[216:217], v232 offset:57344
    ds_read_b64_tr_b16 v[218:219], v232 offset:59392
    v_mfma_f32_16x16x32_bf16 v[36:39], v[228:231], v[168:171], v[36:39]
    ds_read_b64_tr_b16 v[220:221], v233 offset:57344
    ds_read_b64_tr_b16 v[222:223], v233 offset:59392
    s_waitcnt vmcnt(14)
    v_mfma_f32_16x16x32_bf16 v[24:27], v[56:59], v[172:175], v[24:27]
    buffer_load_dwordx4 v[156:159], v242, s[4:7], s55 offen offset:3072 sc1
    ds_read_b64_tr_b16 v[224:225], v234 offset:57344
    ds_read_b64_tr_b16 v[226:227], v234 offset:59392
    v_mfma_f32_16x16x32_bf16 v[28:31], v[60:63], v[172:175], v[28:31]
    v_mfma_f32_16x16x32_bf16 v[32:35], v[64:67], v[172:175], v[32:35]
    buffer_load_dword v255, v244, s[12:15], s53 offen offset:2048
    v_mfma_f32_16x16x32_bf16 v[36:39], v[68:71], v[172:175], v[36:39]
    s_waitcnt vmcnt(14) lgkmcnt(10)
    v_mfma_f32_16x16x32_bf16 v[24:27], v[200:203], v[176:179], v[24:27]
    buffer_load_dwordx4 v[160:163], v243, s[4:7], 0 offen offset:0 sc1
    v_mfma_f32_16x16x32_bf16 v[28:31], v[204:207], v[176:179], v[28:31]
    ds_read_b64_tr_b16 v[228:229], v235 offset:57344
    ds_read_b64_tr_b16 v[230:231], v235 offset:59392
    s_waitcnt lgkmcnt(8)
    v_mfma_f32_16x16x32_bf16 v[32:35], v[208:211], v[176:179], v[32:35]
    ds_read_b64_tr_b16 v[200:201], v232 offset:61440
    ds_read_b64_tr_b16 v[202:203], v232 offset:63488
    v_mfma_f32_16x16x32_bf16 v[36:39], v[212:215], v[176:179], v[36:39]
    ds_read_b64_tr_b16 v[204:205], v233 offset:61440
    ds_read_b64_tr_b16 v[206:207], v233 offset:63488
    s_waitcnt vmcnt(14)
    v_mfma_f32_16x16x32_bf16 v[24:27], v[72:75], v[180:183], v[24:27]
    buffer_load_dwordx4 v[164:167], v243, s[4:7], 0 offen offset:1024 sc1
    ds_read_b64_tr_b16 v[208:209], v234 offset:61440
    ds_read_b64_tr_b16 v[210:211], v234 offset:63488
    v_mfma_f32_16x16x32_bf16 v[28:31], v[76:79], v[180:183], v[28:31]
    v_mfma_f32_16x16x32_bf16 v[32:35], v[80:83], v[180:183], v[32:35]
    v_mfma_f32_16x16x32_bf16 v[36:39], v[84:87], v[180:183], v[36:39]
    s_waitcnt vmcnt(14) lgkmcnt(10)
    v_mfma_f32_16x16x32_bf16 v[24:27], v[216:219], v[184:187], v[24:27]
    s_xor_b32 m0, s83, 0
    s_xor_b32 s58, s82, 0
    s_mul_i32 s58, s58, 196608
    s_bitset1_b32 s58, 10
    buffer_load_dwordx4 v7, s[12:15], s58 offen lds
    v_mfma_f32_16x16x32_bf16 v[28:31], v[220:223], v[184:187], v[28:31]
    ds_read_b64_tr_b16 v[212:213], v235 offset:61440
    ds_read_b64_tr_b16 v[214:215], v235 offset:63488
    s_waitcnt lgkmcnt(8)
    v_mfma_f32_16x16x32_bf16 v[32:35], v[224:227], v[184:187], v[32:35]
    s_lshr_b32 s85, s2, 3
    s_add_u32 s85, s85, s44
    s_cmp_ge_u32 s85, s50
    s_cbranch_scc1 wb_57
    buffer_wbl2 sc1
wb_57:
    ds_read_b64_tr_b16 v[216:217], v236 offset:0
    ds_read_b64_tr_b16 v[218:219], v236 offset:2048
    v_mfma_f32_16x16x32_bf16 v[36:39], v[228:231], v[184:187], v[36:39]
    ds_read_b64_tr_b16 v[220:221], v237 offset:0
    ds_read_b64_tr_b16 v[222:223], v237 offset:2048
    s_waitcnt vmcnt(14) lgkmcnt(8)
    v_mfma_f32_16x16x32_bf16 v[24:27], v[200:203], v[188:191], v[24:27]
    ds_read_b64_tr_b16 v[224:225], v238 offset:0
    ds_read_b64_tr_b16 v[226:227], v238 offset:2048
    v_mfma_f32_16x16x32_bf16 v[28:31], v[204:207], v[188:191], v[28:31]
    ds_read_b64_tr_b16 v[228:229], v239 offset:0
    ds_read_b64_tr_b16 v[230:231], v239 offset:2048
    s_waitcnt lgkmcnt(8)
    v_mfma_f32_16x16x32_bf16 v[32:35], v[208:211], v[188:191], v[32:35]
    buffer_load_dword v255, v244, s[12:15], s54 offen offset:1024
    ds_read_b64_tr_b16 v[200:201], v236 offset:4096
    ds_read_b64_tr_b16 v[202:203], v236 offset:6144
    v_mfma_f32_16x16x32_bf16 v[36:39], v[212:215], v[188:191], v[36:39]
    ds_read_b64_tr_b16 v[204:205], v237 offset:4096
    ds_read_b64_tr_b16 v[206:207], v237 offset:6144
    s_waitcnt vmcnt(13)
    v_mfma_f32_16x16x32_bf16 v[24:27], v[88:91], v[192:195], v[24:27]
    buffer_load_dwordx4 v7, s[12:15], s58 offen offset:1024 lds
    ds_read_b64_tr_b16 v[208:209], v238 offset:4096
    ds_read_b64_tr_b16 v[210:211], v238 offset:6144
    v_mfma_f32_16x16x32_bf16 v[28:31], v[92:95], v[192:195], v[28:31]
    v_mfma_f32_16x16x32_bf16 v[32:35], v[96:99], v[192:195], v[32:35]
    v_mfma_f32_16x16x32_bf16 v[36:39], v[100:103], v[192:195], v[36:39]
    s_waitcnt vmcnt(13) lgkmcnt(10)
    v_mfma_f32_16x16x32_bf16 v[24:27], v[216:219], v[196:199], v[24:27]
    v_mfma_f32_16x16x32_bf16 v[28:31], v[220:223], v[196:199], v[28:31]
    ds_read_b64_tr_b16 v[212:213], v239 offset:4096
    ds_read_b64_tr_b16 v[214:215], v239 offset:6144
    s_waitcnt lgkmcnt(8)
    v_mfma_f32_16x16x32_bf16 v[32:35], v[224:227], v[196:199], v[32:35]
    ds_read_b64_tr_b16 v[216:217], v236 offset:8192
    ds_read_b64_tr_b16 v[218:219], v236 offset:10240
    v_mfma_f32_16x16x32_bf16 v[36:39], v[228:231], v[196:199], v[36:39]
    ds_read_b64_tr_b16 v[220:221], v237 offset:8192
    ds_read_b64_tr_b16 v[222:223], v237 offset:10240
    s_waitcnt vmcnt(12)
    v_mfma_f32_16x16x32_bf16 v[24:27], v[104:107], v[136:139], v[24:27]
    s_xor_b32 m0, s83, 8192
    s_xor_b32 s58, s82, 1
    s_mul_i32 s58, s58, 196608
    s_bitset1_b32 s58, 10
    buffer_load_dwordx4 v7, s[12:15], s58 offen lds
    ds_read_b64_tr_b16 v[224:225], v238 offset:8192
    ds_read_b64_tr_b16 v[226:227], v238 offset:10240
    v_mfma_f32_16x16x32_bf16 v[28:31], v[108:111], v[136:139], v[28:31]
    v_mfma_f32_16x16x32_bf16 v[32:35], v[112:115], v[136:139], v[32:35]
    v_mfma_f32_16x16x32_bf16 v[36:39], v[116:119], v[136:139], v[36:39]
    s_waitcnt vmcnt(12) lgkmcnt(10)
    v_mfma_f32_16x16x32_bf16 v[24:27], v[200:203], v[140:143], v[24:27]
    v_mfma_f32_16x16x32_bf16 v[28:31], v[204:207], v[140:143], v[28:31]
    ds_read_b64_tr_b16 v[228:229], v239 offset:8192
    ds_read_b64_tr_b16 v[230:231], v239 offset:10240
    s_waitcnt lgkmcnt(8)
    v_mfma_f32_16x16x32_bf16 v[32:35], v[208:211], v[140:143], v[32:35]
    ds_read_b64_tr_b16 v[200:201], v236 offset:12288
    ds_read_b64_tr_b16 v[202:203], v236 offset:14336
    v_mfma_f32_16x16x32_bf16 v[36:39], v[212:215], v[140:143], v[36:39]
    ds_read_b64_tr_b16 v[204:205], v237 offset:12288
    ds_read_b64_tr_b16 v[206:207], v237 offset:14336
    s_waitcnt vmcnt(10) lgkmcnt(8)
    v_mfma_f32_16x16x32_bf16 v[24:27], v[216:219], v[144:147], v[24:27]
    buffer_load_dwordx4 v7, s[12:15], s58 offen offset:1024 lds
    ds_read_b64_tr_b16 v[208:209], v238 offset:12288
    ds_read_b64_tr_b16 v[210:211], v238 offset:14336
    v_mfma_f32_16x16x32_bf16 v[28:31], v[220:223], v[144:147], v[28:31]
    ds_read_b64_tr_b16 v[212:213], v239 offset:12288
    ds_read_b64_tr_b16 v[214:215], v239 offset:14336
    s_waitcnt lgkmcnt(8)
    v_mfma_f32_16x16x32_bf16 v[32:35], v[224:227], v[144:147], v[32:35]
    ds_read_b64_tr_b16 v[216:217], v236 offset:16384
    ds_read_b64_tr_b16 v[218:219], v236 offset:18432
    v_mfma_f32_16x16x32_bf16 v[36:39], v[228:231], v[144:147], v[36:39]
    ds_read_b64_tr_b16 v[220:221], v237 offset:16384
    ds_read_b64_tr_b16 v[222:223], v237 offset:18432
    s_waitcnt vmcnt(10)
    v_mfma_f32_16x16x32_bf16 v[24:27], v[120:123], v[148:151], v[24:27]
    ds_read_b64_tr_b16 v[224:225], v238 offset:16384
    ds_read_b64_tr_b16 v[226:227], v238 offset:18432
    v_mfma_f32_16x16x32_bf16 v[28:31], v[124:127], v[148:151], v[28:31]
    v_mfma_f32_16x16x32_bf16 v[32:35], v[128:131], v[148:151], v[32:35]
    v_mfma_f32_16x16x32_bf16 v[36:39], v[132:135], v[148:151], v[36:39]
    s_waitcnt vmcnt(9) lgkmcnt(10)
    v_mfma_f32_16x16x32_bf16 v[24:27], v[200:203], v[152:155], v[24:27]
    s_xor_b32 m0, s83, 16384
    s_xor_b32 s58, s82, 2
    s_mul_i32 s58, s58, 196608
    s_bitset1_b32 s58, 10
    buffer_load_dwordx4 v7, s[12:15], s58 offen lds
    v_mfma_f32_16x16x32_bf16 v[28:31], v[204:207], v[152:155], v[28:31]
    ds_read_b64_tr_b16 v[228:229], v239 offset:16384
    ds_read_b64_tr_b16 v[230:231], v239 offset:18432
    s_waitcnt lgkmcnt(8)
    v_mfma_f32_16x16x32_bf16 v[32:35], v[208:211], v[152:155], v[32:35]
    ds_read_b64_tr_b16 v[200:201], v236 offset:20480
    ds_read_b64_tr_b16 v[202:203], v236 offset:22528
    v_mfma_f32_16x16x32_bf16 v[36:39], v[212:215], v[152:155], v[36:39]
    ds_read_b64_tr_b16 v[204:205], v237 offset:20480
    ds_read_b64_tr_b16 v[206:207], v237 offset:22528
    s_waitcnt vmcnt(9) lgkmcnt(8)
    v_mfma_f32_16x16x32_bf16 v[24:27], v[216:219], v[156:159], v[24:27]
    ds_read_b64_tr_b16 v[208:209], v238 offset:20480
    ds_read_b64_tr_b16 v[210:211], v238 offset:22528
    v_mfma_f32_16x16x32_bf16 v[28:31], v[220:223], v[156:159], v[28:31]
    ds_read_b64_tr_b16 v[212:213], v239 offset:20480
    ds_read_b64_tr_b16 v[214:215], v239 offset:22528
    s_waitcnt lgkmcnt(8)
    v_mfma_f32_16x16x32_bf16 v[32:35], v[224:227], v[156:159], v[32:35]
    ds_read_b64_tr_b16 v[216:217], v236 offset:24576
    ds_read_b64_tr_b16 v[218:219], v236 offset:26624
    v_mfma_f32_16x16x32_bf16 v[36:39], v[228:231], v[156:159], v[36:39]
    ds_read_b64_tr_b16 v[220:221], v237 offset:24576
    ds_read_b64_tr_b16 v[222:223], v237 offset:26624
    s_waitcnt vmcnt(7) lgkmcnt(8)
    v_mfma_f32_16x16x32_bf16 v[24:27], v[200:203], v[160:163], v[24:27]
    buffer_load_dwordx4 v7, s[12:15], s58 offen offset:1024 lds
    ds_read_b64_tr_b16 v[224:225], v238 offset:24576
    ds_read_b64_tr_b16 v[226:227], v238 offset:26624
    v_mfma_f32_16x16x32_bf16 v[28:31], v[204:207], v[160:163], v[28:31]
    ds_read_b64_tr_b16 v[228:229], v239 offset:24576
    ds_read_b64_tr_b16 v[230:231], v239 offset:26624
    s_waitcnt lgkmcnt(8)
    v_mfma_f32_16x16x32_bf16 v[32:35], v[208:211], v[160:163], v[32:35]
    v_mfma_f32_16x16x32_bf16 v[36:39], v[212:215], v[160:163], v[36:39]
    s_waitcnt vmcnt(7) lgkmcnt(4)
    v_mfma_f32_16x16x32_bf16 v[24:27], v[216:219], v[164:167], v[24:27]
    v_mfma_f32_16x16x32_bf16 v[28:31], v[220:223], v[164:167], v[28:31]
    s_waitcnt lgkmcnt(0)
    v_mfma_f32_16x16x32_bf16 v[32:35], v[224:227], v[164:167], v[32:35]
    v_mfma_f32_16x16x32_bf16 v[36:39], v[228:231], v[164:167], v[36:39]
    s_cmp_lg_u32 s50, 0
    s_cbranch_scc1 done
    s_mov_b32 s50, 1
    s_bitset1_b32 s70, 18
    s_bitset1_b32 s72, 18
    v_or_b32 v17, 0x40000, v17
    v_or_b32 v18, 0x40000, v18
    s_add_u32 s98, s98, 0x4000
    s_add_u32 s73, s73, s56
    s_add_u32 s74, s74, s56
    s_add_u32 s81, s81, s56
    s_branch layer
done:
    v_and_b32 v57, 15, v0
    v_lshrrev_b32 v58, 4, v0
    s_lshl_b32 s60, s49, 14
    s_lshl_b32 s61, s47, 7
    s_add_u32 s60, s60, s61
    v_lshlrev_b32 v56, 10, v57
    v_lshl_add_u32 v56, v58, 3, v56
    v_cvt_pk_bf16_f32 v64, v24, v25
    v_cvt_pk_bf16_f32 v65, v26, v27
    v_cvt_pk_bf16_f32 v66, v28, v29
    v_cvt_pk_bf16_f32 v67, v30, v31
    v_cvt_pk_bf16_f32 v68, v32, v33
    v_cvt_pk_bf16_f32 v69, v34, v35
    v_cvt_pk_bf16_f32 v70, v36, v37
    v_cvt_pk_bf16_f32 v71, v38, v39
    buffer_store_dwordx2 v[64:65], v56, s[36:39], s60 offen offset:0
    buffer_store_dwordx2 v[66:67], v56, s[36:39], s60 offen offset:32
    buffer_store_dwordx2 v[68:69], v56, s[36:39], s60 offen offset:64
    buffer_store_dwordx2 v[70:71], v56, s[36:39], s60 offen offset:96
    s_waitcnt vmcnt(0)
bail:
    s_endpgm
sc_2:
    buffer_store_dwordx4 v[56:59], v2, s[4:7], s60 offen offset:0 sc1
    buffer_store_dwordx4 v[60:63], v2, s[4:7], s60 offen offset:1024 sc1
    s_branch scb_3
sc_4:
    buffer_store_dword v64, v5, s[4:7], s61 offen sc1
    s_branch scb_5
sc_6:
    buffer_store_dwordx2 v[20:21], off, s[8:11], s69 sc1
    s_branch scb_7
att_p:
    s_mov_b32 s59, 0x8000
poll_15:
    buffer_load_dwordx2 v[20:21], v18, s[8:11], 0 offen sc1
    s_sub_u32 s59, s59, 1
    s_cbranch_scc1 bail
    s_waitcnt vmcnt(0)
    v_cmp_ne_u64 vcc, s[64:65], v[20:21]
    s_cbranch_vccnz poll_15
    s_branch att_pb
epoch:
    s_mov_b32 s59, 0x8000
epoch_l:
    buffer_load_dwordx2 v[120:121], v19, s[40:43], 0 offen sc1
    s_sub_u32 s59, s59, 1
    s_cbranch_scc1 bail
    s_waitcnt vmcnt(0)
    v_sad_u8 v120, v120, 0, 0
    v_sad_u8 v120, v121, 0, v120
    v_cmp_ne_u32 vcc, 32, v120
    s_and_b32 s60, vcc_lo, 0xff
    s_cbranch_scc1 epoch_l
    s_add_u32 s60, s64, 7
    v_mov_b32 v120, s60
    s_mov_b32 s60, 524288
    s_mov_b64 exec, 1
    buffer_store_dword v120, off, s[8:11], s60 sc1
    s_mov_b64 exec, -1
    s_branch epoch_b
att_e8:
    v_mfma_f32_32x32x16_bf16 v[176:191], v[220:223], v[228:231], v[176:191]
    s_barrier
    s_branch att_r8
att_e12:
    v_mfma_f32_32x32x16_bf16 v[176:191], v[232:235], v[228:231], v[176:191]
    s_branch att_r12
att_e24:
    v_mfma_f32_32x32x16_bf16 v[176:191], v[220:223], v[228:231], v[176:191]
    s_barrier
    s_branch att_r24
att_e28:
    v_mfma_f32_32x32x16_bf16 v[176:191], v[232:235], v[228:231], v[176:191]
    s_branch att_r28
att_r8:
att_r12:
    s_add_u32 m0, s68, 40960
    s_mov_b32 s58, 327680
    buffer_load_dwordx4 v6, s[16:19], s58 offen lds
    s_add_u32 m0, m0, s53
    s_add_u32 s58, s58, s56
    buffer_load_dwordx4 v6, s[16:19], s58 offen lds
    s_add_u32 m0, m0, s53
    s_add_u32 s58, s58, s56
    buffer_load_dwordx4 v6, s[16:19], s58 offen lds
    s_add_u32 m0, m0, s53
    s_add_u32 s58, s58, s56
    buffer_load_dwordx4 v6, s[16:19], s58 offen lds
    s_add_u32 m0, m0, s53
    s_add_u32 s58, s58, s56
    buffer_load_dwordx4 v6, s[16:19], s58 offen lds
    s_add_u32 m0, m0, s53
    s_add_u32 s58, s58, s56
    buffer_load_dwordx4 v6, s[16:19], s58 offen lds
    s_add_u32 m0, s68, 98304
    s_mov_b32 s58, 262144
    buffer_load_dwordx4 v6, s[20:23], s58 offen lds
    s_add_u32 m0, m0, s53
    s_add_u32 s58, s58, s56
    buffer_load_dwordx4 v6, s[20:23], s58 offen lds
att_r24:
    s_add_u32 m0, m0, s53
    s_add_u32 s58, s58, s56
    buffer_load_dwordx4 v6, s[20:23], s58 offen lds
    s_add_u32 m0, s68, 65536
    s_mov_b32 s58, 0
    buffer_load_dwordx4 v6, s[20:23], s58 offen lds
    s_add_u32 m0, m0, s53
    s_add_u32 s58, s58, s56
    buffer_load_dwordx4 v6, s[20:23], s58 offen lds
    s_add_u32 m0, m0, s53
    s_add_u32 s58, s58, s56
    buffer_load_dwordx4 v6, s[20:23], s58 offen lds
att_r28:
    s_add_u32 m0, m0, s53
    s_add_u32 s58, s58, s56
    buffer_load_dwordx4 v6, s[20:23], s58 offen lds
    s_add_u32 m0, m0, s53
    s_add_u32 s58, s58, s56
    buffer_load_dwordx4 v6, s[20:23], s58 offen lds
    s_add_u32 m0, m0, s53
    s_add_u32 s58, s58, s56
    buffer_load_dwordx4 v6, s[20:23], s58 offen lds
    s_add_u32 m0, m0, s53
    s_add_u32 s58, s58, s56
    buffer_load_dwordx4 v6, s[20:23], s58 offen lds
    s_add_u32 m0, m0, s53
    s_add_u32 s58, s58, s56
    buffer_load_dwordx4 v6, s[20:23], s58 offen lds
    s_waitcnt lgkmcnt(0)
    s_branch att_rb
att_x:
    s_mov_b32 s59, 0
    v_mov_b32 v120, 4051697664
    v_mov_b32 v121, 4051697664
    v_mov_b32 v122, 0
    v_mov_b32 v123, 0
    v_mov_b32 v160, 0
    v_mov_b32 v161, 0
    v_mov_b32 v162, 0
    v_mov_b32 v163, 0
    v_mov_b32 v164, 0
    v_mov_b32 v165, 0
    v_mov_b32 v166, 0
    v_mov_b32 v167, 0
    v_mov_b32 v168, 0
    v_mov_b32 v169, 0
    v_mov_b32 v170, 0
    v_mov_b32 v171, 0
    v_mov_b32 v172, 0
    v_mov_b32 v173, 0
    v_mov_b32 v174, 0
    v_mov_b32 v175, 0
    v_mov_b32 v176, 0
    v_mov_b32 v177, 0
    v_mov_b32 v178, 0
    v_mov_b32 v179, 0
    v_mov_b32 v180, 0
    v_mov_b32 v181, 0
    v_mov_b32 v182, 0
    v_mov_b32 v183, 0
    v_mov_b32 v184, 0
    v_mov_b32 v185, 0
    v_mov_b32 v186, 0
    v_mov_b32 v187, 0
    v_mov_b32 v188, 0
    v_mov_b32 v189, 0
    v_mov_b32 v190, 0
    v_mov_b32 v191, 0
att_xp:
    s_mov_b32 s80, 0
    v_add_u32 v244, 40960, v192
    v_add_u32 v245, 0, v193
    v_add_u32 v246, 0, v194
att_xl:
    ds_read_b128 v[208:211], v244 offset:0
    ds_read_b64_tr_b16 v[216:217], v245 offset:0
    ds_read_b64_tr_b16 v[218:219], v246 offset:0
    ds_read_b64_tr_b16 v[220:221], v245 offset:256
    ds_read_b64_tr_b16 v[222:223], v246 offset:256
    s_bitcmp1_b32 257, s80
    s_cselect_b32 s76, -1, 0
    s_bitcmp1_b32 1792, s80
    s_cselect_b32 s77, 4051697664, 0
    v_and_b32 v88, s76, v40
    v_xor_b32 v88, s77, v88
    v_add_f32 v88, v88, v122
    v_and_b32 v89, s76, v41
    v_xor_b32 v89, s77, v89
    v_add_f32 v89, v89, v122
    v_and_b32 v90, s76, v42
    v_xor_b32 v90, s77, v90
    v_add_f32 v90, v90, v122
    v_and_b32 v91, s76, v43
    v_xor_b32 v91, s77, v91
    v_add_f32 v91, v91, v122
    v_and_b32 v92, s76, v44
    v_xor_b32 v92, s77, v92
    v_add_f32 v92, v92, v122
    v_and_b32 v93, s76, v45
    v_xor_b32 v93, s77, v93
    v_add_f32 v93, v93, v122
    v_and_b32 v94, s76, v46
    v_xor_b32 v94, s77, v94
    v_add_f32 v94, v94, v122
    v_and_b32 v95, s76, v47
    v_xor_b32 v95, s77, v95
    v_add_f32 v95, v95, v122
    v_and_b32 v96, s76, v48
    v_xor_b32 v96, s77, v96
    v_add_f32 v96, v96, v122
    v_and_b32 v97, s76, v49
    v_xor_b32 v97, s77, v97
    v_add_f32 v97, v97, v122
    v_and_b32 v98, s76, v50
    v_xor_b32 v98, s77, v98
    v_add_f32 v98, v98, v122
    v_and_b32 v99, s76, v51
    v_xor_b32 v99, s77, v99
    v_add_f32 v99, v99, v122
    v_and_b32 v100, s76, v52
    v_xor_b32 v100, s77, v100
    v_add_f32 v100, v100, v122
    v_and_b32 v101, s76, v53
    v_xor_b32 v101, s77, v101
    v_add_f32 v101, v101, v122
    v_and_b32 v102, s76, v54
    v_xor_b32 v102, s77, v102
    v_add_f32 v102, v102, v122
    v_and_b32 v103, s76, v55
    v_xor_b32 v103, s77, v103
    v_add_f32 v103, v103, v122
    s_bitcmp1_b32 1028, s80
    s_cselect_b32 s76, -1, 0
    s_bitcmp1_b32 1027, s80
    s_cselect_b32 s77, 4051697664, 0
    v_and_b32 v104, s76, v40
    v_xor_b32 v104, s77, v104
    v_add_f32 v104, v104, v123
    v_and_b32 v105, s76, v41
    v_xor_b32 v105, s77, v105
    v_add_f32 v105, v105, v123
    v_and_b32 v106, s76, v42
    v_xor_b32 v106, s77, v106
    v_add_f32 v106, v106, v123
    v_and_b32 v107, s76, v43
    v_xor_b32 v107, s77, v107
    v_add_f32 v107, v107, v123
    v_and_b32 v108, s76, v44
    v_xor_b32 v108, s77, v108
    v_add_f32 v108, v108, v123
    v_and_b32 v109, s76, v45
    v_xor_b32 v109, s77, v109
    v_add_f32 v109, v109, v123
    v_and_b32 v110, s76, v46
    v_xor_b32 v110, s77, v110
    v_add_f32 v110, v110, v123
    v_and_b32 v111, s76, v47
    v_xor_b32 v111, s77, v111
    v_add_f32 v111, v111, v123
    v_and_b32 v112, s76, v48
    v_xor_b32 v112, s77, v112
    v_add_f32 v112, v112, v123
    v_and_b32 v113, s76, v49
    v_xor_b32 v113, s77, v113
    v_add_f32 v113, v113, v123
    v_and_b32 v114, s76, v50
    v_xor_b32 v114, s77, v114
    v_add_f32 v114, v114, v123
    v_and_b32 v115, s76, v51
    v_xor_b32 v115, s77, v115
    v_add_f32 v115, v115, v123
    v_and_b32 v116, s76, v52
    v_xor_b32 v116, s77, v116
    v_add_f32 v116, v116, v123
    v_and_b32 v117, s76, v53
    v_xor_b32 v117, s77, v117
    v_add_f32 v117, v117, v123
    v_and_b32 v118, s76, v54
    v_xor_b32 v118, s77, v118
    v_add_f32 v118, v118, v123
    v_and_b32 v119, s76, v55
    v_xor_b32 v119, s77, v119
    v_add_f32 v119, v119, v123
    v_subrev_u32 v244, s53, v244
    v_sub_u32 v245, v245, v236
    v_sub_u32 v246, v246, v236
    s_waitcnt lgkmcnt(0)
    v_mfma_f32_32x32x16_bf16 v[56:71], v[208:211], v[204:207], v[88:103]
    v_mfma_f32_32x32x16_bf16 v[72:87], v[208:211], v[200:203], v[104:119]
    s_cmp_lg_u32 s59, 0
    s_cbranch_scc1 att_x2
    s_nop 8
    v_max3_f32 v120, v120, v56, v57
    v_max3_f32 v120, v120, v58, v59
    v_max3_f32 v120, v120, v60, v61
    v_max3_f32 v120, v120, v62, v63
    v_max3_f32 v120, v120, v64, v65
    v_max3_f32 v120, v120, v66, v67
    v_max3_f32 v120, v120, v68, v69
    v_max3_f32 v120, v120, v70, v71
    v_max3_f32 v121, v121, v72, v73
    v_max3_f32 v121, v121, v74, v75
    v_max3_f32 v121, v121, v76, v77
    v_max3_f32 v121, v121, v78, v79
    v_max3_f32 v121, v121, v80, v81
    v_max3_f32 v121, v121, v82, v83
    v_max3_f32 v121, v121, v84, v85
    v_max3_f32 v121, v121, v86, v87
    s_branch att_xn
att_x2:
    s_nop 8
    v_exp_f32 v56, v56
    v_exp_f32 v57, v57
    v_exp_f32 v58, v58
    v_exp_f32 v59, v59
    v_exp_f32 v60, v60
    v_exp_f32 v61, v61
    v_exp_f32 v62, v62
    v_exp_f32 v63, v63
    v_cvt_pk_bf16_f32 v224, v56, v57
    v_cvt_pk_bf16_f32 v225, v58, v59
    v_cvt_pk_bf16_f32 v226, v60, v61
    v_cvt_pk_bf16_f32 v227, v62, v63
    s_nop 1
    v_mfma_f32_32x32x16_bf16 v[160:175], v[216:219], v[224:227], v[160:175]
    v_exp_f32 v64, v64
    v_exp_f32 v65, v65
    v_exp_f32 v66, v66
    v_exp_f32 v67, v67
    v_exp_f32 v68, v68
    v_exp_f32 v69, v69
    v_exp_f32 v70, v70
    v_exp_f32 v71, v71
    v_cvt_pk_bf16_f32 v228, v64, v65
    v_cvt_pk_bf16_f32 v229, v66, v67
    v_cvt_pk_bf16_f32 v230, v68, v69
    v_cvt_pk_bf16_f32 v231, v70, v71
    s_nop 1
    v_mfma_f32_32x32x16_bf16 v[160:175], v[220:223], v[228:231], v[160:175]
    v_exp_f32 v72, v72
    v_exp_f32 v73, v73
    v_exp_f32 v74, v74
    v_exp_f32 v75, v75
    v_exp_f32 v76, v76
    v_exp_f32 v77, v77
    v_exp_f32 v78, v78
    v_exp_f32 v79, v79
    v_cvt_pk_bf16_f32 v224, v72, v73
    v_cvt_pk_bf16_f32 v225, v74, v75
    v_cvt_pk_bf16_f32 v226, v76, v77
    v_cvt_pk_bf16_f32 v227, v78, v79
    s_nop 1
    v_mfma_f32_32x32x16_bf16 v[176:191], v[216:219], v[224:227], v[176:191]
    v_exp_f32 v80, v80
    v_exp_f32 v81, v81
    v_exp_f32 v82, v82
    v_exp_f32 v83, v83
    v_exp_f32 v84, v84
    v_exp_f32 v85, v85
    v_exp_f32 v86, v86
    v_exp_f32 v87, v87
    v_cvt_pk_bf16_f32 v228, v80, v81
    v_cvt_pk_bf16_f32 v229, v82, v83
    v_cvt_pk_bf16_f32 v230, v84, v85
    v_cvt_pk_bf16_f32 v231, v86, v87
    s_nop 1
    v_mfma_f32_32x32x16_bf16 v[176:191], v[220:223], v[228:231], v[176:191]
att_xn:
    s_add_u32 s80, s80, 1
    s_add_u32 s76, s75, 2
    s_cmp_le_u32 s80, s76
    s_cbranch_scc1 att_xl
    s_cmp_lg_u32 s59, 0
    s_cbranch_scc1 att_xb
    s_mov_b32 s59, 1
    v_permlane32_swap_b32 v120, v121
    v_max_f32 v120, v120, v121
    v_sub_f32 v122, 0, v120
    v_mov_b32 v123, v122
    s_nop 1
    v_permlane32_swap_b32 v122, v123
    s_branch att_xp
sc_18:
    buffer_store_dwordx2 v[224:225], v19, s[4:7], s60 offen offset:0 sc1
    buffer_store_dwordx2 v[226:227], v19, s[4:7], s60 offen offset:256 sc1
    buffer_store_dwordx2 v[228:229], v19, s[4:7], s61 offen offset:0 sc1
    buffer_store_dwordx2 v[230:231], v19, s[4:7], s61 offen offset:256 sc1
    s_branch scb_19
sc_20:
    buffer_store_dwordx2 v[20:21], off, s[8:11], s71 sc1
    s_branch scb_21
sc_23:
    buffer_store_dwordx4 v[128:131], v2, s[4:7], s60 offen offset:0 sc1
    buffer_store_dwordx4 v[132:135], v2, s[4:7], s60 offen offset:1024 sc1
    s_branch scb_24
sc_25:
    buffer_store_dword v136, v5, s[4:7], s61 offen sc1
    s_branch scb_26
sc_27:
    buffer_store_dwordx2 v[20:21], off, s[8:11], s69 sc1
    s_branch scb_28
sc_36:
    buffer_store_dwordx4 v[128:131], v2, s[4:7], s98 offen offset:0 sc1
    buffer_store_dwordx4 v[132:135], v2, s[4:7], s98 offen offset:1024 sc1
    s_branch scb_37
sc_38:
    buffer_store_dwordx2 v[20:21], v19, s[8:11], s70 offen sc1
    s_branch scb_39
sc_41:
    buffer_store_dwordx4 v[128:131], v2, s[4:7], s60 offen offset:0 sc1
    buffer_store_dwordx4 v[132:135], v2, s[4:7], s60 offen offset:1024 sc1
    s_branch scb_42
sc_43:
    buffer_store_dword v136, v5, s[4:7], s61 offen sc1
    s_branch scb_44
sc_45:
    buffer_store_dwordx2 v[20:21], off, s[8:11], s69 sc1
    s_branch scb_46
sc_50:
    buffer_store_dwordx4 v[196:199], v4, s[4:7], s78 offen offset:0 sc1
    buffer_store_dwordx4 v[200:203], v4, s[4:7], s78 offen offset:1024 sc1
    buffer_store_dwordx4 v[204:207], v4, s[4:7], s78 offen offset:2048 sc1
    buffer_store_dwordx2 v[208:209], v4, s[4:7], s79 offen sc1
    s_branch scb_51
sc_52:
    buffer_store_dwordx4 v[212:215], v146, s[4:7], s78 offen offset:0 sc1
    buffer_store_dwordx4 v[216:219], v146, s[4:7], s78 offen offset:1024 sc1
    buffer_store_dwordx4 v[220:223], v146, s[4:7], s78 offen offset:2048 sc1
    buffer_store_dwordx2 v[224:225], v146, s[4:7], s79 offen sc1
    s_branch scb_53
sc_54:
    buffer_store_dwordx2 v[20:21], off, s[8:11], s71 sc1
    s_branch scb_55
text_end:
.section .rodata,"a"
.p2align 6
.amdhsa_kernel interleave_layers__sliding_block__mixer_s_mlp__prompt_kernel
  .amdhsa_next_free_vgpr 512
  .amdhsa_next_free_sgpr 102
  .amdhsa_accum_offset 256
  .amdhsa_group_segment_fixed_size 0
  .amdhsa_kernarg_size 88
  .amdhsa_user_sgpr_count 2
  .amdhsa_user_sgpr_kernarg_segment_ptr 1
  .amdhsa_system_sgpr_workgroup_id_x 1
.end_amdhsa_kernel
```
